```python
import torch

def _softmax(x, axis=-1):
    return torch.softmax(x, dim=axis)

def _gelu(x):
    return torch.nn.functional.gelu(x, approximate='tanh')

def _silu(x):
    return torch.nn.functional.silu(x)

def _sigmoid(x):
    return torch.sigmoid(x)

def _layernorm(x, axis=-1, eps=1e-05):
    m = x.mean(dim=axis, keepdim=True)
    v = x.var(dim=axis, keepdim=True, unbiased=False)
    return (x - m) / torch.sqrt(v + eps)

def _scatter_add(tgt, idx, src, axis=0):
    return tgt.clone().index_add_(axis, idx, src)

def _segment_sum(src, seg, n):
    out = torch.zeros((n,) + src.shape[1:], dtype=src.dtype)
    return out.index_add_(0, seg, src)

def _pad(x, pw):
    flat = tuple((v for pair in reversed(pw) for v in pair))
    return torch.nn.functional.pad(x, flat)
kernel_name = 'recurrent_scan__sliding_local_dilated__mixer_gmlp__prompt'

def setup_inputs():

    _w = lambda a: (lambda t: t.to(torch.bfloat16) if t.is_floating_point() else t)(torch.as_tensor(a))

    def _A_setup():
        B, S, D = (1, 2048, 640)
        return {'x': _w((lambda *s: torch.randn(*s, dtype=torch.bfloat16) * 0.05)(B, S, D)), 'wqkv': _w((lambda *s: torch.randn(*s, dtype=torch.bfloat16) * 0.05)(D, 3 * D)), 'wo': _w((lambda *s: torch.randn(*s, dtype=torch.bfloat16) * 0.05)(D, D))}
    _A_in = _A_setup()

    def _B_setup():
        B, S, D, F = (1, 2048, 640, 1728)
        Fh = F // 2
        return {'x': _w((lambda *s: torch.randn(*s, dtype=torch.bfloat16) * 0.05)(B, S, D)), 'w_in': _w((lambda *s: torch.randn(*s, dtype=torch.bfloat16) * 0.4)(D, 2 * Fh)), 'w_sp': _w(0.01 * (lambda *s: torch.randn(*s, dtype=torch.bfloat16) * 0.4)(S, S)), 'b_sp': _w(1.0 + 0.01 * (lambda *s: torch.randn(*s, dtype=torch.bfloat16) * 0.05)(S)), 'w_out': _w((lambda *s: torch.randn(*s, dtype=torch.bfloat16) * 0.05)(Fh, D))}
    _B_in = _B_setup()
    return {'A_x': _A_in['x'], 'A_wqkv': _A_in['wqkv'], 'A_wo': _A_in['wo'], 'B_x': _B_in['x'], 'B_w_in': _B_in['w_in'], 'B_w_sp': _B_in['w_sp'], 'B_b_sp': _B_in['b_sp'], 'B_w_out': _B_in['w_out']}

def reference(A_x, A_wqkv, A_wo, B_x, B_w_in, B_w_sp, B_b_sp, B_w_out):

    def _A_ref(x, wqkv, wo):
        B, S, D = x.shape
        H = 32
        Dh = D // H
        W, dil = (8, 2)
        qkv = (lambda x, *d: x.permute(*d))((x @ wqkv).reshape(B, S, 3, H, Dh), 2, 0, 3, 1, 4)
        q, k, v = (qkv[0], qkv[1], qkv[2])
        scale = Dh ** (-0.5)
        pos = torch.arange(S)
        off = torch.arange(W) * dil
        idx = pos[:, None] - off[None, :]
        mask = idx >= 0
        idx_c = torch.where(mask, idx, 0).reshape(-1)
        kg = k[:, :, idx_c, :].reshape(B, H, S, W, Dh)
        vg = v[:, :, idx_c, :].reshape(B, H, S, W, Dh)
        logits = torch.einsum('bhsd,bhswd->bhsw', q, kg) * scale
        logits = torch.where(mask[None, None, :, :], logits, -1000000000.0)
        attn = _softmax(logits, axis=-1)
        o = torch.einsum('bhsw,bhswd->bhsd', attn, vg)
        return (lambda x, *d: x.permute(*d))(o, 0, 2, 1, 3).reshape(B, S, D) @ wo

    def _B_ref(x, w_in, w_sp, b_sp, w_out):
        B, S, D = x.shape
        F = w_in.shape[-1]
        Fh = F // 2
        z = _gelu(torch.einsum('bsd,df->bsf', x, w_in))
        z1 = z[..., :Fh].clone()
        z2 = _layernorm(z[..., Fh:], axis=-1)
        g = torch.einsum('ts,bsf->btf', w_sp, z2) + b_sp[None, :, None]
        return torch.einsum('bsf,fd->bsd', z1 * g, w_out)
    x = A_x
    xn = _layernorm(x, axis=-1)
    s = _A_ref(xn, A_wqkv, A_wo)
    g = _silu(_B_ref(xn, B_w_in, B_w_sp, B_b_sp, B_w_out))
    return x + s * g
```

```asm
; @launch grid=(256,1,1) block=(512,1,1) lds=163840
.amdgcn_target "amdgcn-amd-amdhsa--gfx950"
.text
.globl recurrent_scan__sliding_local_dilated__mixer_gmlp__prompt_kernel
.p2align 8
.type recurrent_scan__sliding_local_dilated__mixer_gmlp__prompt_kernel,@function
recurrent_scan__sliding_local_dilated__mixer_gmlp__prompt_kernel:
s_cmp_ge_u32 s2, 256
s_cbranch_scc1 L_end
s_load_dwordx16 s[64:79], s[0:1], 0
s_load_dwordx4 s[80:83], s[0:1], 64
s_load_dwordx2 s[84:85], s[0:1], 80
v_lshrrev_b32 v1, 6, v0
v_and_b32 v250, 63, v0
v_readfirstlane_b32 s3, v1
s_and_b32 s20, s2, 7
s_lshr_b32 s21, s2, 3
s_lshr_b32 s22, s21, 2
s_and_b32 s23, s21, 3
s_and_b32 s24, s20, 1
s_lshr_b32 s25, s20, 1
s_lshl_b32 s32, s24, 3
s_add_u32 s32, s32, s22
s_lshl_b32 s33, s25, 2
s_add_u32 s33, s33, s23
s_lshl_b32 s36, s25, 3
s_add_u32 s36, s36, s22
s_lshl_b32 s37, s24, 2
s_add_u32 s37, s37, s23
s_and_b32 s35, s3, 1
s_cmp_ge_u32 s3, 6
s_cbranch_scc1 L_side
s_cmp_lt_u32 s3, 4
s_cbranch_scc1 L_cons
L_dma:
s_lshl_b32 s41, s35, 10
v_lshrrev_b32 v80, 3, v250
v_lshrrev_b32 v81, 4, v250
v_and_b32 v83, 7, v250
s_lshl_b32 s21, s35, 2
v_add_u32 v82, s21, v81
v_xor_b32 v82, v82, v83
s_lshl_b32 s21, s32, 7
s_lshl_b32 s22, s35, 3
s_add_u32 s21, s21, s22
v_add_u32 v84, s21, v80
v_mul_u32_u24 v84, 1280, v84
v_lshl_add_u32 v10, v82, 4, v84
v_add_u32 v11, 20480, v10
v_add_u32 v12, 40960, v10
v_add_u32 v13, 61440, v10
v_add_u32 v14, 81920, v10
v_add_u32 v15, 102400, v10
v_add_u32 v16, 122880, v10
v_add_u32 v17, 143360, v10
v_and_b32 v82, 1, v81
s_lshl_b32 s21, s35, 1
v_or_b32 v82, s21, v82
v_lshlrev_b32 v82, 1, v82
v_xor_b32 v82, v82, v83
v_lshlrev_b32 v82, 4, v82
v_add_u32 v84, s22, v80
v_mul_u32_u24 v85, 3456, v84
v_add_u32 v18, v85, v82
v_mul_u32_u24 v85, 3840, v84
v_add_u32 v22, v85, v82
v_add_u32 v19, 55296, v18
v_add_u32 v23, 61440, v22
v_add_u32 v20, 110592, v18
v_add_u32 v24, 122880, v22
v_add_u32 v21, 165888, v18
v_add_u32 v25, 184320, v22
s_add_u32 s38, s33, 13
s_min_u32 s38, s38, 26
s_lshl_b32 s38, s38, 7
s_min_u32 s39, s33, 12
s_lshl_b32 s39, s39, 7
s_lshl_b32 s40, s33, 8
s_and_b32 s43, s32, 7
s_waitcnt lgkmcnt(0)
s_add_u32 s20, s84, 31457280
s_addc_u32 s21, s85, 0
s_load_dword s34, s[20:21], 0
s_mov_b32 s4, s64
s_mov_b32 s5, s65
s_mov_b32 s6, 0x280000
s_mov_b32 s7, 0x20000
s_cmp_lt_u32 s33, 14
s_cselect_b32 s20, 2211840, 0
s_mov_b32 s12, s72
s_mov_b32 s13, s73
s_mov_b32 s14, s20
s_mov_b32 s15, 0x20000
s_mov_b32 s22, 0
s_lshl_b32 s42, s22, 7
s_mul_i32 s22, s22, 221184
s_add_u32 s20, s38, s22
s_add_u32 s21, s39, s22
s_add_u32 m0, s41, 0
s_nop 0
buffer_load_dwordx4 v10, s[4:7], s42 offen lds
s_add_u32 m0, s41, 16384
s_nop 0
buffer_load_dwordx4 v18, s[12:15], s20 offen lds
s_add_u32 m0, s41, 2048
s_nop 0
buffer_load_dwordx4 v11, s[4:7], s42 offen lds
s_add_u32 m0, s41, 18432
s_nop 0
buffer_load_dwordx4 v19, s[12:15], s20 offen lds
s_add_u32 m0, s41, 4096
s_nop 0
buffer_load_dwordx4 v12, s[4:7], s42 offen lds
s_add_u32 m0, s41, 20480
s_nop 0
buffer_load_dwordx4 v20, s[12:15], s20 offen lds
s_add_u32 m0, s41, 6144
s_nop 0
buffer_load_dwordx4 v13, s[4:7], s42 offen lds
s_add_u32 m0, s41, 22528
s_nop 0
buffer_load_dwordx4 v21, s[12:15], s20 offen lds
s_add_u32 m0, s41, 8192
s_nop 0
buffer_load_dwordx4 v14, s[4:7], s42 offen lds
s_add_u32 m0, s41, 24576
s_nop 0
buffer_load_dwordx4 v18, s[12:15], s21 offen lds
s_add_u32 m0, s41, 10240
s_nop 0
buffer_load_dwordx4 v15, s[4:7], s42 offen lds
s_add_u32 m0, s41, 26624
s_nop 0
buffer_load_dwordx4 v19, s[12:15], s21 offen lds
s_add_u32 m0, s41, 12288
s_nop 0
buffer_load_dwordx4 v16, s[4:7], s42 offen lds
s_add_u32 m0, s41, 28672
s_nop 0
buffer_load_dwordx4 v20, s[12:15], s21 offen lds
s_add_u32 m0, s41, 14336
s_nop 0
buffer_load_dwordx4 v17, s[4:7], s42 offen lds
s_add_u32 m0, s41, 30720
s_nop 0
buffer_load_dwordx4 v21, s[12:15], s21 offen lds
s_add_u32 s22, s43, 0
s_cmp_ge_u32 s22, 9
s_cselect_b32 s23, 9, 0
s_sub_u32 s22, s22, s23
s_add_u32 s22, s22, 1
s_lshl_b32 s42, s22, 7
s_mul_i32 s22, s22, 221184
s_add_u32 s20, s38, s22
s_add_u32 s21, s39, s22
s_add_u32 m0, s41, 32768
s_nop 0
buffer_load_dwordx4 v10, s[4:7], s42 offen lds
s_add_u32 m0, s41, 49152
s_nop 0
buffer_load_dwordx4 v18, s[12:15], s20 offen lds
s_add_u32 m0, s41, 34816
s_nop 0
buffer_load_dwordx4 v11, s[4:7], s42 offen lds
s_add_u32 m0, s41, 51200
s_nop 0
buffer_load_dwordx4 v19, s[12:15], s20 offen lds
s_add_u32 m0, s41, 36864
s_nop 0
buffer_load_dwordx4 v12, s[4:7], s42 offen lds
s_add_u32 m0, s41, 53248
s_nop 0
buffer_load_dwordx4 v20, s[12:15], s20 offen lds
s_add_u32 m0, s41, 38912
s_nop 0
buffer_load_dwordx4 v13, s[4:7], s42 offen lds
s_add_u32 m0, s41, 55296
s_nop 0
buffer_load_dwordx4 v21, s[12:15], s20 offen lds
s_add_u32 m0, s41, 40960
s_nop 0
buffer_load_dwordx4 v14, s[4:7], s42 offen lds
s_add_u32 m0, s41, 57344
s_nop 0
buffer_load_dwordx4 v18, s[12:15], s21 offen lds
s_add_u32 m0, s41, 43008
s_nop 0
buffer_load_dwordx4 v15, s[4:7], s42 offen lds
s_add_u32 m0, s41, 59392
s_nop 0
buffer_load_dwordx4 v19, s[12:15], s21 offen lds
s_add_u32 m0, s41, 45056
s_nop 0
buffer_load_dwordx4 v16, s[4:7], s42 offen lds
s_add_u32 m0, s41, 61440
s_nop 0
buffer_load_dwordx4 v20, s[12:15], s21 offen lds
s_add_u32 m0, s41, 47104
s_nop 0
buffer_load_dwordx4 v17, s[4:7], s42 offen lds
s_add_u32 m0, s41, 63488
s_nop 0
buffer_load_dwordx4 v21, s[12:15], s21 offen lds
s_mov_b32 s8, s84
s_mov_b32 s9, s85
s_mov_b32 s10, 0x10000000
s_mov_b32 s11, 0x20000
s_waitcnt lgkmcnt(0)
s_mul_i32 s34, s34, 1664525
s_add_u32 s34, s34, 1013904223
s_waitcnt vmcnt(16)
s_barrier
s_add_u32 s22, s43, 1
s_cmp_ge_u32 s22, 9
s_cselect_b32 s23, 9, 0
s_sub_u32 s22, s22, s23
s_add_u32 s22, s22, 1
s_lshl_b32 s42, s22, 7
s_mul_i32 s22, s22, 221184
s_add_u32 s20, s38, s22
s_add_u32 s21, s39, s22
s_add_u32 m0, s41, 65536
s_nop 0
buffer_load_dwordx4 v10, s[4:7], s42 offen lds
s_add_u32 m0, s41, 81920
s_nop 0
buffer_load_dwordx4 v18, s[12:15], s20 offen lds
s_add_u32 m0, s41, 67584
s_nop 0
buffer_load_dwordx4 v11, s[4:7], s42 offen lds
s_add_u32 m0, s41, 83968
s_nop 0
buffer_load_dwordx4 v19, s[12:15], s20 offen lds
s_add_u32 m0, s41, 69632
s_nop 0
buffer_load_dwordx4 v12, s[4:7], s42 offen lds
s_add_u32 m0, s41, 86016
s_nop 0
buffer_load_dwordx4 v20, s[12:15], s20 offen lds
s_add_u32 m0, s41, 71680
s_nop 0
buffer_load_dwordx4 v13, s[4:7], s42 offen lds
s_add_u32 m0, s41, 88064
s_nop 0
buffer_load_dwordx4 v21, s[12:15], s20 offen lds
s_add_u32 m0, s41, 73728
s_nop 0
buffer_load_dwordx4 v14, s[4:7], s42 offen lds
s_add_u32 m0, s41, 90112
s_nop 0
buffer_load_dwordx4 v18, s[12:15], s21 offen lds
s_add_u32 m0, s41, 75776
s_nop 0
buffer_load_dwordx4 v15, s[4:7], s42 offen lds
s_add_u32 m0, s41, 92160
s_nop 0
buffer_load_dwordx4 v19, s[12:15], s21 offen lds
s_add_u32 m0, s41, 77824
s_nop 0
buffer_load_dwordx4 v16, s[4:7], s42 offen lds
s_add_u32 m0, s41, 94208
s_nop 0
buffer_load_dwordx4 v20, s[12:15], s21 offen lds
s_add_u32 m0, s41, 79872
s_nop 0
buffer_load_dwordx4 v17, s[4:7], s42 offen lds
s_add_u32 m0, s41, 96256
s_nop 0
buffer_load_dwordx4 v21, s[12:15], s21 offen lds
s_add_u32 s22, s43, 2
s_cmp_ge_u32 s22, 9
s_cselect_b32 s23, 9, 0
s_sub_u32 s22, s22, s23
s_add_u32 s22, s22, 1
s_lshl_b32 s42, s22, 7
s_mul_i32 s22, s22, 221184
s_add_u32 s20, s38, s22
s_add_u32 s21, s39, s22
s_add_u32 m0, s41, 98304
s_nop 0
buffer_load_dwordx4 v10, s[4:7], s42 offen lds
s_add_u32 m0, s41, 114688
s_nop 0
buffer_load_dwordx4 v18, s[12:15], s20 offen lds
s_add_u32 m0, s41, 100352
s_nop 0
buffer_load_dwordx4 v11, s[4:7], s42 offen lds
s_add_u32 m0, s41, 116736
s_nop 0
buffer_load_dwordx4 v19, s[12:15], s20 offen lds
s_add_u32 m0, s41, 102400
s_nop 0
buffer_load_dwordx4 v12, s[4:7], s42 offen lds
s_add_u32 m0, s41, 118784
s_nop 0
buffer_load_dwordx4 v20, s[12:15], s20 offen lds
s_add_u32 m0, s41, 104448
s_nop 0
buffer_load_dwordx4 v13, s[4:7], s42 offen lds
s_add_u32 m0, s41, 120832
s_nop 0
buffer_load_dwordx4 v21, s[12:15], s20 offen lds
s_add_u32 m0, s41, 106496
s_nop 0
buffer_load_dwordx4 v14, s[4:7], s42 offen lds
s_add_u32 m0, s41, 122880
s_nop 0
buffer_load_dwordx4 v18, s[12:15], s21 offen lds
s_add_u32 m0, s41, 108544
s_nop 0
buffer_load_dwordx4 v15, s[4:7], s42 offen lds
s_add_u32 m0, s41, 124928
s_nop 0
buffer_load_dwordx4 v19, s[12:15], s21 offen lds
s_add_u32 m0, s41, 110592
s_nop 0
buffer_load_dwordx4 v16, s[4:7], s42 offen lds
s_add_u32 m0, s41, 126976
s_nop 0
buffer_load_dwordx4 v20, s[12:15], s21 offen lds
s_add_u32 m0, s41, 112640
s_nop 0
buffer_load_dwordx4 v17, s[4:7], s42 offen lds
s_add_u32 m0, s41, 129024
s_nop 0
buffer_load_dwordx4 v21, s[12:15], s21 offen lds
s_waitcnt vmcnt(32)
s_barrier
s_add_u32 s22, s43, 3
s_cmp_ge_u32 s22, 9
s_cselect_b32 s23, 9, 0
s_sub_u32 s22, s22, s23
s_add_u32 s22, s22, 1
s_lshl_b32 s42, s22, 7
s_mul_i32 s22, s22, 221184
s_add_u32 s20, s38, s22
s_add_u32 s21, s39, s22
s_add_u32 m0, s41, 0
s_nop 0
buffer_load_dwordx4 v10, s[4:7], s42 offen lds
s_add_u32 m0, s41, 16384
s_nop 0
buffer_load_dwordx4 v18, s[12:15], s20 offen lds
s_add_u32 m0, s41, 2048
s_nop 0
buffer_load_dwordx4 v11, s[4:7], s42 offen lds
s_add_u32 m0, s41, 18432
s_nop 0
buffer_load_dwordx4 v19, s[12:15], s20 offen lds
s_add_u32 m0, s41, 4096
s_nop 0
buffer_load_dwordx4 v12, s[4:7], s42 offen lds
s_add_u32 m0, s41, 20480
s_nop 0
buffer_load_dwordx4 v20, s[12:15], s20 offen lds
s_add_u32 m0, s41, 6144
s_nop 0
buffer_load_dwordx4 v13, s[4:7], s42 offen lds
s_add_u32 m0, s41, 22528
s_nop 0
buffer_load_dwordx4 v21, s[12:15], s20 offen lds
s_add_u32 m0, s41, 8192
s_nop 0
buffer_load_dwordx4 v14, s[4:7], s42 offen lds
s_add_u32 m0, s41, 24576
s_nop 0
buffer_load_dwordx4 v18, s[12:15], s21 offen lds
s_add_u32 m0, s41, 10240
s_nop 0
buffer_load_dwordx4 v15, s[4:7], s42 offen lds
s_add_u32 m0, s41, 26624
s_nop 0
buffer_load_dwordx4 v19, s[12:15], s21 offen lds
s_add_u32 m0, s41, 12288
s_nop 0
buffer_load_dwordx4 v16, s[4:7], s42 offen lds
s_add_u32 m0, s41, 28672
s_nop 0
buffer_load_dwordx4 v20, s[12:15], s21 offen lds
s_add_u32 m0, s41, 14336
s_nop 0
buffer_load_dwordx4 v17, s[4:7], s42 offen lds
s_add_u32 m0, s41, 30720
s_nop 0
buffer_load_dwordx4 v21, s[12:15], s21 offen lds
s_waitcnt vmcnt(32)
s_barrier
s_add_u32 s22, s43, 4
s_cmp_ge_u32 s22, 9
s_cselect_b32 s23, 9, 0
s_sub_u32 s22, s22, s23
s_add_u32 s22, s22, 1
s_lshl_b32 s42, s22, 7
s_mul_i32 s22, s22, 221184
s_add_u32 s20, s38, s22
s_add_u32 s21, s39, s22
s_add_u32 m0, s41, 32768
s_nop 0
buffer_load_dwordx4 v10, s[4:7], s42 offen lds
s_add_u32 m0, s41, 49152
s_nop 0
buffer_load_dwordx4 v18, s[12:15], s20 offen lds
s_add_u32 m0, s41, 34816
s_nop 0
buffer_load_dwordx4 v11, s[4:7], s42 offen lds
s_add_u32 m0, s41, 51200
s_nop 0
buffer_load_dwordx4 v19, s[12:15], s20 offen lds
s_add_u32 m0, s41, 36864
s_nop 0
buffer_load_dwordx4 v12, s[4:7], s42 offen lds
s_add_u32 m0, s41, 53248
s_nop 0
buffer_load_dwordx4 v20, s[12:15], s20 offen lds
s_add_u32 m0, s41, 38912
s_nop 0
buffer_load_dwordx4 v13, s[4:7], s42 offen lds
s_add_u32 m0, s41, 55296
s_nop 0
buffer_load_dwordx4 v21, s[12:15], s20 offen lds
s_add_u32 m0, s41, 40960
s_nop 0
buffer_load_dwordx4 v14, s[4:7], s42 offen lds
s_add_u32 m0, s41, 57344
s_nop 0
buffer_load_dwordx4 v18, s[12:15], s21 offen lds
s_add_u32 m0, s41, 43008
s_nop 0
buffer_load_dwordx4 v15, s[4:7], s42 offen lds
s_add_u32 m0, s41, 59392
s_nop 0
buffer_load_dwordx4 v19, s[12:15], s21 offen lds
s_add_u32 m0, s41, 45056
s_nop 0
buffer_load_dwordx4 v16, s[4:7], s42 offen lds
s_add_u32 m0, s41, 61440
s_nop 0
buffer_load_dwordx4 v20, s[12:15], s21 offen lds
s_add_u32 m0, s41, 47104
s_nop 0
buffer_load_dwordx4 v17, s[4:7], s42 offen lds
s_add_u32 m0, s41, 63488
s_nop 0
buffer_load_dwordx4 v21, s[12:15], s21 offen lds
s_waitcnt vmcnt(32)
s_barrier
s_add_u32 s22, s43, 5
s_cmp_ge_u32 s22, 9
s_cselect_b32 s23, 9, 0
s_sub_u32 s22, s22, s23
s_add_u32 s22, s22, 1
s_lshl_b32 s42, s22, 7
s_mul_i32 s22, s22, 221184
s_add_u32 s20, s38, s22
s_add_u32 s21, s39, s22
s_add_u32 m0, s41, 65536
s_nop 0
buffer_load_dwordx4 v10, s[4:7], s42 offen lds
s_add_u32 m0, s41, 81920
s_nop 0
buffer_load_dwordx4 v18, s[12:15], s20 offen lds
s_add_u32 m0, s41, 67584
s_nop 0
buffer_load_dwordx4 v11, s[4:7], s42 offen lds
s_add_u32 m0, s41, 83968
s_nop 0
buffer_load_dwordx4 v19, s[12:15], s20 offen lds
s_add_u32 m0, s41, 69632
s_nop 0
buffer_load_dwordx4 v12, s[4:7], s42 offen lds
s_add_u32 m0, s41, 86016
s_nop 0
buffer_load_dwordx4 v20, s[12:15], s20 offen lds
s_add_u32 m0, s41, 71680
s_nop 0
buffer_load_dwordx4 v13, s[4:7], s42 offen lds
s_add_u32 m0, s41, 88064
s_nop 0
buffer_load_dwordx4 v21, s[12:15], s20 offen lds
s_add_u32 m0, s41, 73728
s_nop 0
buffer_load_dwordx4 v14, s[4:7], s42 offen lds
s_add_u32 m0, s41, 90112
s_nop 0
buffer_load_dwordx4 v18, s[12:15], s21 offen lds
s_add_u32 m0, s41, 75776
s_nop 0
buffer_load_dwordx4 v15, s[4:7], s42 offen lds
s_add_u32 m0, s41, 92160
s_nop 0
buffer_load_dwordx4 v19, s[12:15], s21 offen lds
s_add_u32 m0, s41, 77824
s_nop 0
buffer_load_dwordx4 v16, s[4:7], s42 offen lds
s_add_u32 m0, s41, 94208
s_nop 0
buffer_load_dwordx4 v20, s[12:15], s21 offen lds
s_add_u32 m0, s41, 79872
s_nop 0
buffer_load_dwordx4 v17, s[4:7], s42 offen lds
s_add_u32 m0, s41, 96256
s_nop 0
buffer_load_dwordx4 v21, s[12:15], s21 offen lds
s_waitcnt vmcnt(32)
s_barrier
s_add_u32 s22, s43, 6
s_cmp_ge_u32 s22, 9
s_cselect_b32 s23, 9, 0
s_sub_u32 s22, s22, s23
s_add_u32 s22, s22, 1
s_lshl_b32 s42, s22, 7
s_mul_i32 s22, s22, 221184
s_add_u32 s20, s38, s22
s_add_u32 s21, s39, s22
s_add_u32 m0, s41, 98304
s_nop 0
buffer_load_dwordx4 v10, s[4:7], s42 offen lds
s_add_u32 m0, s41, 114688
s_nop 0
buffer_load_dwordx4 v18, s[12:15], s20 offen lds
s_add_u32 m0, s41, 100352
s_nop 0
buffer_load_dwordx4 v11, s[4:7], s42 offen lds
s_add_u32 m0, s41, 116736
s_nop 0
buffer_load_dwordx4 v19, s[12:15], s20 offen lds
s_add_u32 m0, s41, 102400
s_nop 0
buffer_load_dwordx4 v12, s[4:7], s42 offen lds
s_add_u32 m0, s41, 118784
s_nop 0
buffer_load_dwordx4 v20, s[12:15], s20 offen lds
s_add_u32 m0, s41, 104448
s_nop 0
buffer_load_dwordx4 v13, s[4:7], s42 offen lds
s_add_u32 m0, s41, 120832
s_nop 0
buffer_load_dwordx4 v21, s[12:15], s20 offen lds
s_add_u32 m0, s41, 106496
s_nop 0
buffer_load_dwordx4 v14, s[4:7], s42 offen lds
s_add_u32 m0, s41, 122880
s_nop 0
buffer_load_dwordx4 v18, s[12:15], s21 offen lds
s_add_u32 m0, s41, 108544
s_nop 0
buffer_load_dwordx4 v15, s[4:7], s42 offen lds
s_add_u32 m0, s41, 124928
s_nop 0
buffer_load_dwordx4 v19, s[12:15], s21 offen lds
s_add_u32 m0, s41, 110592
s_nop 0
buffer_load_dwordx4 v16, s[4:7], s42 offen lds
s_add_u32 m0, s41, 126976
s_nop 0
buffer_load_dwordx4 v20, s[12:15], s21 offen lds
s_add_u32 m0, s41, 112640
s_nop 0
buffer_load_dwordx4 v17, s[4:7], s42 offen lds
s_add_u32 m0, s41, 129024
s_nop 0
buffer_load_dwordx4 v21, s[12:15], s21 offen lds
s_waitcnt vmcnt(32)
s_barrier
s_add_u32 s22, s43, 7
s_cmp_ge_u32 s22, 9
s_cselect_b32 s23, 9, 0
s_sub_u32 s22, s22, s23
s_add_u32 s22, s22, 1
s_lshl_b32 s42, s22, 7
s_mul_i32 s22, s22, 221184
s_add_u32 s20, s38, s22
s_add_u32 s21, s39, s22
s_add_u32 m0, s41, 0
s_nop 0
buffer_load_dwordx4 v10, s[4:7], s42 offen lds
s_add_u32 m0, s41, 16384
s_nop 0
buffer_load_dwordx4 v18, s[12:15], s20 offen lds
s_add_u32 m0, s41, 2048
s_nop 0
buffer_load_dwordx4 v11, s[4:7], s42 offen lds
s_add_u32 m0, s41, 18432
s_nop 0
buffer_load_dwordx4 v19, s[12:15], s20 offen lds
s_add_u32 m0, s41, 4096
s_nop 0
buffer_load_dwordx4 v12, s[4:7], s42 offen lds
s_add_u32 m0, s41, 20480
s_nop 0
buffer_load_dwordx4 v20, s[12:15], s20 offen lds
s_add_u32 m0, s41, 6144
s_nop 0
buffer_load_dwordx4 v13, s[4:7], s42 offen lds
s_add_u32 m0, s41, 22528
s_nop 0
buffer_load_dwordx4 v21, s[12:15], s20 offen lds
s_add_u32 m0, s41, 8192
s_nop 0
buffer_load_dwordx4 v14, s[4:7], s42 offen lds
s_add_u32 m0, s41, 24576
s_nop 0
buffer_load_dwordx4 v18, s[12:15], s21 offen lds
s_add_u32 m0, s41, 10240
s_nop 0
buffer_load_dwordx4 v15, s[4:7], s42 offen lds
s_add_u32 m0, s41, 26624
s_nop 0
buffer_load_dwordx4 v19, s[12:15], s21 offen lds
s_add_u32 m0, s41, 12288
s_nop 0
buffer_load_dwordx4 v16, s[4:7], s42 offen lds
s_add_u32 m0, s41, 28672
s_nop 0
buffer_load_dwordx4 v20, s[12:15], s21 offen lds
s_add_u32 m0, s41, 14336
s_nop 0
buffer_load_dwordx4 v17, s[4:7], s42 offen lds
s_add_u32 m0, s41, 30720
s_nop 0
buffer_load_dwordx4 v21, s[12:15], s21 offen lds
s_waitcnt vmcnt(32)
s_barrier
s_add_u32 s22, s43, 8
s_cmp_ge_u32 s22, 9
s_cselect_b32 s23, 9, 0
s_sub_u32 s22, s22, s23
s_add_u32 s22, s22, 1
s_lshl_b32 s42, s22, 7
s_mul_i32 s22, s22, 221184
s_add_u32 s20, s38, s22
s_add_u32 s21, s39, s22
s_add_u32 m0, s41, 32768
s_nop 0
buffer_load_dwordx4 v10, s[4:7], s42 offen lds
s_add_u32 m0, s41, 49152
s_nop 0
buffer_load_dwordx4 v18, s[12:15], s20 offen lds
s_add_u32 m0, s41, 34816
s_nop 0
buffer_load_dwordx4 v11, s[4:7], s42 offen lds
s_add_u32 m0, s41, 51200
s_nop 0
buffer_load_dwordx4 v19, s[12:15], s20 offen lds
s_add_u32 m0, s41, 36864
s_nop 0
buffer_load_dwordx4 v12, s[4:7], s42 offen lds
s_add_u32 m0, s41, 53248
s_nop 0
buffer_load_dwordx4 v20, s[12:15], s20 offen lds
s_add_u32 m0, s41, 38912
s_nop 0
buffer_load_dwordx4 v13, s[4:7], s42 offen lds
s_add_u32 m0, s41, 55296
s_nop 0
buffer_load_dwordx4 v21, s[12:15], s20 offen lds
s_add_u32 m0, s41, 40960
s_nop 0
buffer_load_dwordx4 v14, s[4:7], s42 offen lds
s_add_u32 m0, s41, 57344
s_nop 0
buffer_load_dwordx4 v18, s[12:15], s21 offen lds
s_add_u32 m0, s41, 43008
s_nop 0
buffer_load_dwordx4 v15, s[4:7], s42 offen lds
s_add_u32 m0, s41, 59392
s_nop 0
buffer_load_dwordx4 v19, s[12:15], s21 offen lds
s_add_u32 m0, s41, 45056
s_nop 0
buffer_load_dwordx4 v16, s[4:7], s42 offen lds
s_add_u32 m0, s41, 61440
s_nop 0
buffer_load_dwordx4 v20, s[12:15], s21 offen lds
s_add_u32 m0, s41, 47104
s_nop 0
buffer_load_dwordx4 v17, s[4:7], s42 offen lds
s_add_u32 m0, s41, 63488
s_nop 0
buffer_load_dwordx4 v21, s[12:15], s21 offen lds
s_waitcnt vmcnt(32)
s_barrier
s_cmp_lt_u32 s33, 15
s_cselect_b32 s20, 2457600, 0
s_mov_b32 s12, s66
s_mov_b32 s13, s67
s_mov_b32 s14, s20
s_mov_b32 s15, 0x20000
s_add_u32 s22, s43, 0
s_cmp_ge_u32 s22, 10
s_cselect_b32 s23, 10, 0
s_sub_u32 s22, s22, s23
s_lshl_b32 s42, s22, 7
s_mul_i32 s22, s22, 245760
s_add_u32 s20, s40, s22
s_add_u32 s21, s20, 128
s_add_u32 m0, s41, 65536
s_nop 0
buffer_load_dwordx4 v10, s[4:7], s42 offen lds
s_add_u32 m0, s41, 81920
s_nop 0
buffer_load_dwordx4 v22, s[12:15], s20 offen lds
s_add_u32 m0, s41, 67584
s_nop 0
buffer_load_dwordx4 v11, s[4:7], s42 offen lds
s_add_u32 m0, s41, 83968
s_nop 0
buffer_load_dwordx4 v23, s[12:15], s20 offen lds
s_add_u32 m0, s41, 69632
s_nop 0
buffer_load_dwordx4 v12, s[4:7], s42 offen lds
s_add_u32 m0, s41, 86016
s_nop 0
buffer_load_dwordx4 v24, s[12:15], s20 offen lds
s_add_u32 m0, s41, 71680
s_nop 0
buffer_load_dwordx4 v13, s[4:7], s42 offen lds
s_add_u32 m0, s41, 88064
s_nop 0
buffer_load_dwordx4 v25, s[12:15], s20 offen lds
s_add_u32 m0, s41, 73728
s_nop 0
buffer_load_dwordx4 v14, s[4:7], s42 offen lds
s_add_u32 m0, s41, 90112
s_nop 0
buffer_load_dwordx4 v22, s[12:15], s21 offen lds
s_add_u32 m0, s41, 75776
s_nop 0
buffer_load_dwordx4 v15, s[4:7], s42 offen lds
s_add_u32 m0, s41, 92160
s_nop 0
buffer_load_dwordx4 v23, s[12:15], s21 offen lds
s_add_u32 m0, s41, 77824
s_nop 0
buffer_load_dwordx4 v16, s[4:7], s42 offen lds
s_add_u32 m0, s41, 94208
s_nop 0
buffer_load_dwordx4 v24, s[12:15], s21 offen lds
s_add_u32 m0, s41, 79872
s_nop 0
buffer_load_dwordx4 v17, s[4:7], s42 offen lds
s_add_u32 m0, s41, 96256
s_nop 0
buffer_load_dwordx4 v25, s[12:15], s21 offen lds
s_waitcnt vmcnt(32)
s_barrier
s_add_u32 s22, s43, 1
s_cmp_ge_u32 s22, 10
s_cselect_b32 s23, 10, 0
s_sub_u32 s22, s22, s23
s_lshl_b32 s42, s22, 7
s_mul_i32 s22, s22, 245760
s_add_u32 s20, s40, s22
s_add_u32 s21, s20, 128
s_add_u32 m0, s41, 98304
s_nop 0
buffer_load_dwordx4 v10, s[4:7], s42 offen lds
s_add_u32 m0, s41, 114688
s_nop 0
buffer_load_dwordx4 v22, s[12:15], s20 offen lds
s_add_u32 m0, s41, 100352
s_nop 0
buffer_load_dwordx4 v11, s[4:7], s42 offen lds
s_add_u32 m0, s41, 116736
s_nop 0
buffer_load_dwordx4 v23, s[12:15], s20 offen lds
s_add_u32 m0, s41, 102400
s_nop 0
buffer_load_dwordx4 v12, s[4:7], s42 offen lds
s_add_u32 m0, s41, 118784
s_nop 0
buffer_load_dwordx4 v24, s[12:15], s20 offen lds
s_add_u32 m0, s41, 104448
s_nop 0
buffer_load_dwordx4 v13, s[4:7], s42 offen lds
s_add_u32 m0, s41, 120832
s_nop 0
buffer_load_dwordx4 v25, s[12:15], s20 offen lds
s_add_u32 m0, s41, 106496
s_nop 0
buffer_load_dwordx4 v14, s[4:7], s42 offen lds
s_add_u32 m0, s41, 122880
s_nop 0
buffer_load_dwordx4 v22, s[12:15], s21 offen lds
s_add_u32 m0, s41, 108544
s_nop 0
buffer_load_dwordx4 v15, s[4:7], s42 offen lds
s_add_u32 m0, s41, 124928
s_nop 0
buffer_load_dwordx4 v23, s[12:15], s21 offen lds
s_add_u32 m0, s41, 110592
s_nop 0
buffer_load_dwordx4 v16, s[4:7], s42 offen lds
s_add_u32 m0, s41, 126976
s_nop 0
buffer_load_dwordx4 v24, s[12:15], s21 offen lds
s_add_u32 m0, s41, 112640
s_nop 0
buffer_load_dwordx4 v17, s[4:7], s42 offen lds
s_add_u32 m0, s41, 129024
s_nop 0
buffer_load_dwordx4 v25, s[12:15], s21 offen lds
s_waitcnt vmcnt(32)
s_barrier
s_add_u32 s22, s43, 2
s_cmp_ge_u32 s22, 10
s_cselect_b32 s23, 10, 0
s_sub_u32 s22, s22, s23
s_lshl_b32 s42, s22, 7
s_mul_i32 s22, s22, 245760
s_add_u32 s20, s40, s22
s_add_u32 s21, s20, 128
s_add_u32 m0, s41, 0
s_nop 0
buffer_load_dwordx4 v10, s[4:7], s42 offen lds
s_add_u32 m0, s41, 16384
s_nop 0
buffer_load_dwordx4 v22, s[12:15], s20 offen lds
s_add_u32 m0, s41, 2048
s_nop 0
buffer_load_dwordx4 v11, s[4:7], s42 offen lds
s_add_u32 m0, s41, 18432
s_nop 0
buffer_load_dwordx4 v23, s[12:15], s20 offen lds
s_add_u32 m0, s41, 4096
s_nop 0
buffer_load_dwordx4 v12, s[4:7], s42 offen lds
s_add_u32 m0, s41, 20480
s_nop 0
buffer_load_dwordx4 v24, s[12:15], s20 offen lds
s_add_u32 m0, s41, 6144
s_nop 0
buffer_load_dwordx4 v13, s[4:7], s42 offen lds
s_add_u32 m0, s41, 22528
s_nop 0
buffer_load_dwordx4 v25, s[12:15], s20 offen lds
s_add_u32 m0, s41, 8192
s_nop 0
buffer_load_dwordx4 v14, s[4:7], s42 offen lds
s_add_u32 m0, s41, 24576
s_nop 0
buffer_load_dwordx4 v22, s[12:15], s21 offen lds
s_add_u32 m0, s41, 10240
s_nop 0
buffer_load_dwordx4 v15, s[4:7], s42 offen lds
s_add_u32 m0, s41, 26624
s_nop 0
buffer_load_dwordx4 v23, s[12:15], s21 offen lds
s_add_u32 m0, s41, 12288
s_nop 0
buffer_load_dwordx4 v16, s[4:7], s42 offen lds
s_add_u32 m0, s41, 28672
s_nop 0
buffer_load_dwordx4 v24, s[12:15], s21 offen lds
s_add_u32 m0, s41, 14336
s_nop 0
buffer_load_dwordx4 v17, s[4:7], s42 offen lds
s_add_u32 m0, s41, 30720
s_nop 0
buffer_load_dwordx4 v25, s[12:15], s21 offen lds
s_barrier
s_add_u32 s22, s43, 3
s_cmp_ge_u32 s22, 10
s_cselect_b32 s23, 10, 0
s_sub_u32 s22, s22, s23
s_lshl_b32 s42, s22, 7
s_mul_i32 s22, s22, 245760
s_add_u32 s20, s40, s22
s_add_u32 s21, s20, 128
s_add_u32 m0, s41, 32768
s_nop 0
buffer_load_dwordx4 v10, s[4:7], s42 offen lds
s_add_u32 m0, s41, 49152
s_nop 0
buffer_load_dwordx4 v22, s[12:15], s20 offen lds
s_add_u32 m0, s41, 34816
s_nop 0
buffer_load_dwordx4 v11, s[4:7], s42 offen lds
s_add_u32 m0, s41, 51200
s_nop 0
buffer_load_dwordx4 v23, s[12:15], s20 offen lds
s_add_u32 m0, s41, 36864
s_nop 0
buffer_load_dwordx4 v12, s[4:7], s42 offen lds
s_add_u32 m0, s41, 53248
s_nop 0
buffer_load_dwordx4 v24, s[12:15], s20 offen lds
s_add_u32 m0, s41, 38912
s_nop 0
buffer_load_dwordx4 v13, s[4:7], s42 offen lds
s_add_u32 m0, s41, 55296
s_nop 0
buffer_load_dwordx4 v25, s[12:15], s20 offen lds
s_add_u32 m0, s41, 40960
s_nop 0
buffer_load_dwordx4 v14, s[4:7], s42 offen lds
s_add_u32 m0, s41, 57344
s_nop 0
buffer_load_dwordx4 v22, s[12:15], s21 offen lds
s_add_u32 m0, s41, 43008
s_nop 0
buffer_load_dwordx4 v15, s[4:7], s42 offen lds
s_add_u32 m0, s41, 59392
s_nop 0
buffer_load_dwordx4 v23, s[12:15], s21 offen lds
s_add_u32 m0, s41, 45056
s_nop 0
buffer_load_dwordx4 v16, s[4:7], s42 offen lds
s_add_u32 m0, s41, 61440
s_nop 0
buffer_load_dwordx4 v24, s[12:15], s21 offen lds
s_add_u32 m0, s41, 47104
s_nop 0
buffer_load_dwordx4 v17, s[4:7], s42 offen lds
s_add_u32 m0, s41, 63488
s_nop 0
buffer_load_dwordx4 v25, s[12:15], s21 offen lds
s_waitcnt vmcnt(48)
s_barrier
s_waitcnt vmcnt(32)
s_barrier
s_add_u32 s22, s43, 4
s_cmp_ge_u32 s22, 10
s_cselect_b32 s23, 10, 0
s_sub_u32 s22, s22, s23
s_lshl_b32 s42, s22, 7
s_mul_i32 s22, s22, 245760
s_add_u32 s20, s40, s22
s_add_u32 s21, s20, 128
s_add_u32 m0, s41, 65536
s_nop 0
buffer_load_dwordx4 v10, s[4:7], s42 offen lds
s_add_u32 m0, s41, 81920
s_nop 0
buffer_load_dwordx4 v22, s[12:15], s20 offen lds
s_add_u32 m0, s41, 67584
s_nop 0
buffer_load_dwordx4 v11, s[4:7], s42 offen lds
s_add_u32 m0, s41, 83968
s_nop 0
buffer_load_dwordx4 v23, s[12:15], s20 offen lds
s_add_u32 m0, s41, 69632
s_nop 0
buffer_load_dwordx4 v12, s[4:7], s42 offen lds
s_add_u32 m0, s41, 86016
s_nop 0
buffer_load_dwordx4 v24, s[12:15], s20 offen lds
s_add_u32 m0, s41, 71680
s_nop 0
buffer_load_dwordx4 v13, s[4:7], s42 offen lds
s_add_u32 m0, s41, 88064
s_nop 0
buffer_load_dwordx4 v25, s[12:15], s20 offen lds
s_add_u32 m0, s41, 73728
s_nop 0
buffer_load_dwordx4 v14, s[4:7], s42 offen lds
s_add_u32 m0, s41, 90112
s_nop 0
buffer_load_dwordx4 v22, s[12:15], s21 offen lds
s_add_u32 m0, s41, 75776
s_nop 0
buffer_load_dwordx4 v15, s[4:7], s42 offen lds
s_add_u32 m0, s41, 92160
s_nop 0
buffer_load_dwordx4 v23, s[12:15], s21 offen lds
s_add_u32 m0, s41, 77824
s_nop 0
buffer_load_dwordx4 v16, s[4:7], s42 offen lds
s_add_u32 m0, s41, 94208
s_nop 0
buffer_load_dwordx4 v24, s[12:15], s21 offen lds
s_add_u32 m0, s41, 79872
s_nop 0
buffer_load_dwordx4 v17, s[4:7], s42 offen lds
s_add_u32 m0, s41, 96256
s_nop 0
buffer_load_dwordx4 v25, s[12:15], s21 offen lds
s_waitcnt vmcnt(32)
s_barrier
s_add_u32 s22, s43, 5
s_cmp_ge_u32 s22, 10
s_cselect_b32 s23, 10, 0
s_sub_u32 s22, s22, s23
s_lshl_b32 s42, s22, 7
s_mul_i32 s22, s22, 245760
s_add_u32 s20, s40, s22
s_add_u32 s21, s20, 128
s_add_u32 m0, s41, 98304
s_nop 0
buffer_load_dwordx4 v10, s[4:7], s42 offen lds
s_add_u32 m0, s41, 114688
s_nop 0
buffer_load_dwordx4 v22, s[12:15], s20 offen lds
s_add_u32 m0, s41, 100352
s_nop 0
buffer_load_dwordx4 v11, s[4:7], s42 offen lds
s_add_u32 m0, s41, 116736
s_nop 0
buffer_load_dwordx4 v23, s[12:15], s20 offen lds
s_add_u32 m0, s41, 102400
s_nop 0
buffer_load_dwordx4 v12, s[4:7], s42 offen lds
s_add_u32 m0, s41, 118784
s_nop 0
buffer_load_dwordx4 v24, s[12:15], s20 offen lds
s_add_u32 m0, s41, 104448
s_nop 0
buffer_load_dwordx4 v13, s[4:7], s42 offen lds
s_add_u32 m0, s41, 120832
s_nop 0
buffer_load_dwordx4 v25, s[12:15], s20 offen lds
s_add_u32 m0, s41, 106496
s_nop 0
buffer_load_dwordx4 v14, s[4:7], s42 offen lds
s_add_u32 m0, s41, 122880
s_nop 0
buffer_load_dwordx4 v22, s[12:15], s21 offen lds
s_add_u32 m0, s41, 108544
s_nop 0
buffer_load_dwordx4 v15, s[4:7], s42 offen lds
s_add_u32 m0, s41, 124928
s_nop 0
buffer_load_dwordx4 v23, s[12:15], s21 offen lds
s_add_u32 m0, s41, 110592
s_nop 0
buffer_load_dwordx4 v16, s[4:7], s42 offen lds
s_add_u32 m0, s41, 126976
s_nop 0
buffer_load_dwordx4 v24, s[12:15], s21 offen lds
s_add_u32 m0, s41, 112640
s_nop 0
buffer_load_dwordx4 v17, s[4:7], s42 offen lds
s_add_u32 m0, s41, 129024
s_nop 0
buffer_load_dwordx4 v25, s[12:15], s21 offen lds
s_waitcnt vmcnt(32)
s_barrier
s_add_u32 s22, s43, 6
s_cmp_ge_u32 s22, 10
s_cselect_b32 s23, 10, 0
s_sub_u32 s22, s22, s23
s_lshl_b32 s42, s22, 7
s_mul_i32 s22, s22, 245760
s_add_u32 s20, s40, s22
s_add_u32 s21, s20, 128
s_add_u32 m0, s41, 0
s_nop 0
buffer_load_dwordx4 v10, s[4:7], s42 offen lds
s_add_u32 m0, s41, 16384
s_nop 0
buffer_load_dwordx4 v22, s[12:15], s20 offen lds
s_add_u32 m0, s41, 2048
s_nop 0
buffer_load_dwordx4 v11, s[4:7], s42 offen lds
s_add_u32 m0, s41, 18432
s_nop 0
buffer_load_dwordx4 v23, s[12:15], s20 offen lds
s_add_u32 m0, s41, 4096
s_nop 0
buffer_load_dwordx4 v12, s[4:7], s42 offen lds
s_add_u32 m0, s41, 20480
s_nop 0
buffer_load_dwordx4 v24, s[12:15], s20 offen lds
s_add_u32 m0, s41, 6144
s_nop 0
buffer_load_dwordx4 v13, s[4:7], s42 offen lds
s_add_u32 m0, s41, 22528
s_nop 0
buffer_load_dwordx4 v25, s[12:15], s20 offen lds
s_add_u32 m0, s41, 8192
s_nop 0
buffer_load_dwordx4 v14, s[4:7], s42 offen lds
s_add_u32 m0, s41, 24576
s_nop 0
buffer_load_dwordx4 v22, s[12:15], s21 offen lds
s_add_u32 m0, s41, 10240
s_nop 0
buffer_load_dwordx4 v15, s[4:7], s42 offen lds
s_add_u32 m0, s41, 26624
s_nop 0
buffer_load_dwordx4 v23, s[12:15], s21 offen lds
s_add_u32 m0, s41, 12288
s_nop 0
buffer_load_dwordx4 v16, s[4:7], s42 offen lds
s_add_u32 m0, s41, 28672
s_nop 0
buffer_load_dwordx4 v24, s[12:15], s21 offen lds
s_add_u32 m0, s41, 14336
s_nop 0
buffer_load_dwordx4 v17, s[4:7], s42 offen lds
s_add_u32 m0, s41, 30720
s_nop 0
buffer_load_dwordx4 v25, s[12:15], s21 offen lds
s_waitcnt vmcnt(32)
s_barrier
s_add_u32 s22, s43, 7
s_cmp_ge_u32 s22, 10
s_cselect_b32 s23, 10, 0
s_sub_u32 s22, s22, s23
s_lshl_b32 s42, s22, 7
s_mul_i32 s22, s22, 245760
s_add_u32 s20, s40, s22
s_add_u32 s21, s20, 128
s_add_u32 m0, s41, 32768
s_nop 0
buffer_load_dwordx4 v10, s[4:7], s42 offen lds
s_add_u32 m0, s41, 49152
s_nop 0
buffer_load_dwordx4 v22, s[12:15], s20 offen lds
s_add_u32 m0, s41, 34816
s_nop 0
buffer_load_dwordx4 v11, s[4:7], s42 offen lds
s_add_u32 m0, s41, 51200
s_nop 0
buffer_load_dwordx4 v23, s[12:15], s20 offen lds
s_add_u32 m0, s41, 36864
s_nop 0
buffer_load_dwordx4 v12, s[4:7], s42 offen lds
s_add_u32 m0, s41, 53248
s_nop 0
buffer_load_dwordx4 v24, s[12:15], s20 offen lds
s_add_u32 m0, s41, 38912
s_nop 0
buffer_load_dwordx4 v13, s[4:7], s42 offen lds
s_add_u32 m0, s41, 55296
s_nop 0
buffer_load_dwordx4 v25, s[12:15], s20 offen lds
s_add_u32 m0, s41, 40960
s_nop 0
buffer_load_dwordx4 v14, s[4:7], s42 offen lds
s_add_u32 m0, s41, 57344
s_nop 0
buffer_load_dwordx4 v22, s[12:15], s21 offen lds
s_add_u32 m0, s41, 43008
s_nop 0
buffer_load_dwordx4 v15, s[4:7], s42 offen lds
s_add_u32 m0, s41, 59392
s_nop 0
buffer_load_dwordx4 v23, s[12:15], s21 offen lds
s_add_u32 m0, s41, 45056
s_nop 0
buffer_load_dwordx4 v16, s[4:7], s42 offen lds
s_add_u32 m0, s41, 61440
s_nop 0
buffer_load_dwordx4 v24, s[12:15], s21 offen lds
s_add_u32 m0, s41, 47104
s_nop 0
buffer_load_dwordx4 v17, s[4:7], s42 offen lds
s_add_u32 m0, s41, 63488
s_nop 0
buffer_load_dwordx4 v25, s[12:15], s21 offen lds
s_waitcnt vmcnt(32)
s_barrier
s_add_u32 s22, s43, 8
s_cmp_ge_u32 s22, 10
s_cselect_b32 s23, 10, 0
s_sub_u32 s22, s22, s23
s_lshl_b32 s42, s22, 7
s_mul_i32 s22, s22, 245760
s_add_u32 s20, s40, s22
s_add_u32 s21, s20, 128
s_add_u32 m0, s41, 65536
s_nop 0
buffer_load_dwordx4 v10, s[4:7], s42 offen lds
s_add_u32 m0, s41, 81920
s_nop 0
buffer_load_dwordx4 v22, s[12:15], s20 offen lds
s_add_u32 m0, s41, 67584
s_nop 0
buffer_load_dwordx4 v11, s[4:7], s42 offen lds
s_add_u32 m0, s41, 83968
s_nop 0
buffer_load_dwordx4 v23, s[12:15], s20 offen lds
s_add_u32 m0, s41, 69632
s_nop 0
buffer_load_dwordx4 v12, s[4:7], s42 offen lds
s_add_u32 m0, s41, 86016
s_nop 0
buffer_load_dwordx4 v24, s[12:15], s20 offen lds
s_add_u32 m0, s41, 71680
s_nop 0
buffer_load_dwordx4 v13, s[4:7], s42 offen lds
s_add_u32 m0, s41, 88064
s_nop 0
buffer_load_dwordx4 v25, s[12:15], s20 offen lds
s_add_u32 m0, s41, 73728
s_nop 0
buffer_load_dwordx4 v14, s[4:7], s42 offen lds
s_add_u32 m0, s41, 90112
s_nop 0
buffer_load_dwordx4 v22, s[12:15], s21 offen lds
s_add_u32 m0, s41, 75776
s_nop 0
buffer_load_dwordx4 v15, s[4:7], s42 offen lds
s_add_u32 m0, s41, 92160
s_nop 0
buffer_load_dwordx4 v23, s[12:15], s21 offen lds
s_add_u32 m0, s41, 77824
s_nop 0
buffer_load_dwordx4 v16, s[4:7], s42 offen lds
s_add_u32 m0, s41, 94208
s_nop 0
buffer_load_dwordx4 v24, s[12:15], s21 offen lds
s_add_u32 m0, s41, 79872
s_nop 0
buffer_load_dwordx4 v17, s[4:7], s42 offen lds
s_add_u32 m0, s41, 96256
s_nop 0
buffer_load_dwordx4 v25, s[12:15], s21 offen lds
s_waitcnt vmcnt(32)
s_barrier
s_add_u32 s22, s43, 9
s_cmp_ge_u32 s22, 10
s_cselect_b32 s23, 10, 0
s_sub_u32 s22, s22, s23
s_lshl_b32 s42, s22, 7
s_mul_i32 s22, s22, 245760
s_add_u32 s20, s40, s22
s_add_u32 s21, s20, 128
s_add_u32 m0, s41, 98304
s_nop 0
buffer_load_dwordx4 v10, s[4:7], s42 offen lds
s_add_u32 m0, s41, 114688
s_nop 0
buffer_load_dwordx4 v22, s[12:15], s20 offen lds
s_add_u32 m0, s41, 100352
s_nop 0
buffer_load_dwordx4 v11, s[4:7], s42 offen lds
s_add_u32 m0, s41, 116736
s_nop 0
buffer_load_dwordx4 v23, s[12:15], s20 offen lds
s_add_u32 m0, s41, 102400
s_nop 0
buffer_load_dwordx4 v12, s[4:7], s42 offen lds
s_add_u32 m0, s41, 118784
s_nop 0
buffer_load_dwordx4 v24, s[12:15], s20 offen lds
s_add_u32 m0, s41, 104448
s_nop 0
buffer_load_dwordx4 v13, s[4:7], s42 offen lds
s_add_u32 m0, s41, 120832
s_nop 0
buffer_load_dwordx4 v25, s[12:15], s20 offen lds
s_add_u32 m0, s41, 106496
s_nop 0
buffer_load_dwordx4 v14, s[4:7], s42 offen lds
s_add_u32 m0, s41, 122880
s_nop 0
buffer_load_dwordx4 v22, s[12:15], s21 offen lds
s_add_u32 m0, s41, 108544
s_nop 0
buffer_load_dwordx4 v15, s[4:7], s42 offen lds
s_add_u32 m0, s41, 124928
s_nop 0
buffer_load_dwordx4 v23, s[12:15], s21 offen lds
s_add_u32 m0, s41, 110592
s_nop 0
buffer_load_dwordx4 v16, s[4:7], s42 offen lds
s_add_u32 m0, s41, 126976
s_nop 0
buffer_load_dwordx4 v24, s[12:15], s21 offen lds
s_add_u32 m0, s41, 112640
s_nop 0
buffer_load_dwordx4 v17, s[4:7], s42 offen lds
s_add_u32 m0, s41, 129024
s_nop 0
buffer_load_dwordx4 v25, s[12:15], s21 offen lds
s_waitcnt vmcnt(32)
s_barrier
s_mov_b32 s4, s74
s_mov_b32 s5, s75
s_mov_b32 s6, 0x800000
s_mov_b32 s7, 0x20000
v_lshrrev_b32 v80, 3, v250
v_lshrrev_b32 v81, 4, v250
s_lshl_b32 s20, s35, 2
v_add_u32 v81, s20, v81
v_and_b32 v82, 7, v250
v_xor_b32 v81, v81, v82
s_lshl_b32 s20, s36, 6
s_lshl_b32 s21, s35, 3
s_add_u32 s20, s20, s21
v_add_u32 v80, s20, v80
v_lshlrev_b32 v80, 12, v80
v_lshl_add_u32 v30, v81, 4, v80
s_lshl_b32 s46, s35, 10
s_mov_b32 s47, 0
s_and_b32 s47, s47, 15
s_add_u32 s21, s47, 0
s_and_b32 s21, s21, 15
s_lshl_b32 s21, s21, 8
s_add_u32 m0, s46, 0
s_add_u32 s20, s21, 0
buffer_load_dwordx4 v30, s[4:7], s20 offen lds
s_add_u32 m0, s46, 2048
s_add_u32 s20, s21, 65536
buffer_load_dwordx4 v30, s[4:7], s20 offen lds
s_add_u32 m0, s46, 4096
s_add_u32 s20, s21, 131072
buffer_load_dwordx4 v30, s[4:7], s20 offen lds
s_add_u32 m0, s46, 6144
s_add_u32 s20, s21, 196608
buffer_load_dwordx4 v30, s[4:7], s20 offen lds
s_add_u32 m0, s46, 8192
s_add_u32 s20, s21, 128
buffer_load_dwordx4 v30, s[4:7], s20 offen lds
s_add_u32 m0, s46, 10240
s_add_u32 s20, s21, 65664
buffer_load_dwordx4 v30, s[4:7], s20 offen lds
s_add_u32 m0, s46, 12288
s_add_u32 s20, s21, 131200
buffer_load_dwordx4 v30, s[4:7], s20 offen lds
s_add_u32 m0, s46, 14336
s_add_u32 s20, s21, 196736
buffer_load_dwordx4 v30, s[4:7], s20 offen lds
s_add_u32 s21, s47, 1
s_and_b32 s21, s21, 15
s_lshl_b32 s21, s21, 8
s_add_u32 m0, s46, 16384
s_add_u32 s20, s21, 0
buffer_load_dwordx4 v30, s[4:7], s20 offen lds
s_add_u32 m0, s46, 18432
s_add_u32 s20, s21, 65536
buffer_load_dwordx4 v30, s[4:7], s20 offen lds
s_add_u32 m0, s46, 20480
s_add_u32 s20, s21, 131072
buffer_load_dwordx4 v30, s[4:7], s20 offen lds
s_add_u32 m0, s46, 22528
s_add_u32 s20, s21, 196608
buffer_load_dwordx4 v30, s[4:7], s20 offen lds
s_add_u32 m0, s46, 24576
s_add_u32 s20, s21, 128
buffer_load_dwordx4 v30, s[4:7], s20 offen lds
s_add_u32 m0, s46, 26624
s_add_u32 s20, s21, 65664
buffer_load_dwordx4 v30, s[4:7], s20 offen lds
s_add_u32 m0, s46, 28672
s_add_u32 s20, s21, 131200
buffer_load_dwordx4 v30, s[4:7], s20 offen lds
s_add_u32 m0, s46, 30720
s_add_u32 s20, s21, 196736
buffer_load_dwordx4 v30, s[4:7], s20 offen lds
s_waitcnt vmcnt(32)
s_barrier
s_add_u32 s21, s47, 2
s_and_b32 s21, s21, 15
s_lshl_b32 s21, s21, 8
s_add_u32 m0, s46, 32768
s_add_u32 s20, s21, 0
buffer_load_dwordx4 v30, s[4:7], s20 offen lds
s_add_u32 m0, s46, 34816
s_add_u32 s20, s21, 65536
buffer_load_dwordx4 v30, s[4:7], s20 offen lds
s_add_u32 m0, s46, 36864
s_add_u32 s20, s21, 131072
buffer_load_dwordx4 v30, s[4:7], s20 offen lds
s_add_u32 m0, s46, 38912
s_add_u32 s20, s21, 196608
buffer_load_dwordx4 v30, s[4:7], s20 offen lds
s_add_u32 m0, s46, 40960
s_add_u32 s20, s21, 128
buffer_load_dwordx4 v30, s[4:7], s20 offen lds
s_add_u32 m0, s46, 43008
s_add_u32 s20, s21, 65664
buffer_load_dwordx4 v30, s[4:7], s20 offen lds
s_add_u32 m0, s46, 45056
s_add_u32 s20, s21, 131200
buffer_load_dwordx4 v30, s[4:7], s20 offen lds
s_add_u32 m0, s46, 47104
s_add_u32 s20, s21, 196736
buffer_load_dwordx4 v30, s[4:7], s20 offen lds
s_add_u32 s21, s47, 3
s_and_b32 s21, s21, 15
s_lshl_b32 s21, s21, 8
s_add_u32 m0, s46, 49152
s_add_u32 s20, s21, 0
buffer_load_dwordx4 v30, s[4:7], s20 offen lds
s_add_u32 m0, s46, 51200
s_add_u32 s20, s21, 65536
buffer_load_dwordx4 v30, s[4:7], s20 offen lds
s_add_u32 m0, s46, 53248
s_add_u32 s20, s21, 131072
buffer_load_dwordx4 v30, s[4:7], s20 offen lds
s_add_u32 m0, s46, 55296
s_add_u32 s20, s21, 196608
buffer_load_dwordx4 v30, s[4:7], s20 offen lds
s_add_u32 m0, s46, 57344
s_add_u32 s20, s21, 128
buffer_load_dwordx4 v30, s[4:7], s20 offen lds
s_add_u32 m0, s46, 59392
s_add_u32 s20, s21, 65664
buffer_load_dwordx4 v30, s[4:7], s20 offen lds
s_add_u32 m0, s46, 61440
s_add_u32 s20, s21, 131200
buffer_load_dwordx4 v30, s[4:7], s20 offen lds
s_add_u32 m0, s46, 63488
s_add_u32 s20, s21, 196736
buffer_load_dwordx4 v30, s[4:7], s20 offen lds
s_waitcnt vmcnt(32)
s_barrier
s_add_u32 s21, s47, 4
s_and_b32 s21, s21, 15
s_lshl_b32 s21, s21, 8
s_add_u32 m0, s46, 65536
s_add_u32 s20, s21, 0
buffer_load_dwordx4 v30, s[4:7], s20 offen lds
s_add_u32 m0, s46, 67584
s_add_u32 s20, s21, 65536
buffer_load_dwordx4 v30, s[4:7], s20 offen lds
s_add_u32 m0, s46, 69632
s_add_u32 s20, s21, 131072
buffer_load_dwordx4 v30, s[4:7], s20 offen lds
s_add_u32 m0, s46, 71680
s_add_u32 s20, s21, 196608
buffer_load_dwordx4 v30, s[4:7], s20 offen lds
s_add_u32 m0, s46, 73728
s_add_u32 s20, s21, 128
buffer_load_dwordx4 v30, s[4:7], s20 offen lds
s_add_u32 m0, s46, 75776
s_add_u32 s20, s21, 65664
buffer_load_dwordx4 v30, s[4:7], s20 offen lds
s_add_u32 m0, s46, 77824
s_add_u32 s20, s21, 131200
buffer_load_dwordx4 v30, s[4:7], s20 offen lds
s_add_u32 m0, s46, 79872
s_add_u32 s20, s21, 196736
buffer_load_dwordx4 v30, s[4:7], s20 offen lds
s_barrier
s_waitcnt vmcnt(32)
s_barrier
s_waitcnt vmcnt(24)
s_barrier
s_add_u32 s21, s47, 5
s_and_b32 s21, s21, 15
s_lshl_b32 s21, s21, 8
s_add_u32 m0, s46, 0
s_add_u32 s20, s21, 0
buffer_load_dwordx4 v30, s[4:7], s20 offen lds
s_add_u32 m0, s46, 2048
s_add_u32 s20, s21, 65536
buffer_load_dwordx4 v30, s[4:7], s20 offen lds
s_add_u32 m0, s46, 4096
s_add_u32 s20, s21, 131072
buffer_load_dwordx4 v30, s[4:7], s20 offen lds
s_add_u32 m0, s46, 6144
s_add_u32 s20, s21, 196608
buffer_load_dwordx4 v30, s[4:7], s20 offen lds
s_add_u32 m0, s46, 8192
s_add_u32 s20, s21, 128
buffer_load_dwordx4 v30, s[4:7], s20 offen lds
s_add_u32 m0, s46, 10240
s_add_u32 s20, s21, 65664
buffer_load_dwordx4 v30, s[4:7], s20 offen lds
s_add_u32 m0, s46, 12288
s_add_u32 s20, s21, 131200
buffer_load_dwordx4 v30, s[4:7], s20 offen lds
s_add_u32 m0, s46, 14336
s_add_u32 s20, s21, 196736
buffer_load_dwordx4 v30, s[4:7], s20 offen lds
s_waitcnt vmcnt(24)
s_barrier
s_add_u32 s21, s47, 6
s_and_b32 s21, s21, 15
s_lshl_b32 s21, s21, 8
s_add_u32 m0, s46, 16384
s_add_u32 s20, s21, 0
buffer_load_dwordx4 v30, s[4:7], s20 offen lds
s_add_u32 m0, s46, 18432
s_add_u32 s20, s21, 65536
buffer_load_dwordx4 v30, s[4:7], s20 offen lds
s_add_u32 m0, s46, 20480
s_add_u32 s20, s21, 131072
buffer_load_dwordx4 v30, s[4:7], s20 offen lds
s_add_u32 m0, s46, 22528
s_add_u32 s20, s21, 196608
buffer_load_dwordx4 v30, s[4:7], s20 offen lds
s_add_u32 m0, s46, 24576
s_add_u32 s20, s21, 128
buffer_load_dwordx4 v30, s[4:7], s20 offen lds
s_add_u32 m0, s46, 26624
s_add_u32 s20, s21, 65664
buffer_load_dwordx4 v30, s[4:7], s20 offen lds
s_add_u32 m0, s46, 28672
s_add_u32 s20, s21, 131200
buffer_load_dwordx4 v30, s[4:7], s20 offen lds
s_add_u32 m0, s46, 30720
s_add_u32 s20, s21, 196736
buffer_load_dwordx4 v30, s[4:7], s20 offen lds
v_lshlrev_b32 v40, 4, v250
s_mul_i32 s50, s35, 10240
s_lshl_b32 s51, s35, 13
s_mul_i32 s20, s37, 245760
s_add_u32 s20, s20, 25165824
s_add_u32 s52, s20, s50
s_add_u32 s53, s20, s51
s_add_u32 m0, s50, 122880
s_add_u32 s20, s52, 0
buffer_load_dwordx4 v40, s[8:11], s20 offen offset:0 sc1 lds
buffer_load_dwordx4 v40, s[8:11], s20 offen offset:1024 sc1 lds
buffer_load_dwordx4 v40, s[8:11], s20 offen offset:2048 sc1 lds
buffer_load_dwordx4 v40, s[8:11], s20 offen offset:3072 sc1 lds
s_add_u32 m0, s50, 126976
s_add_u32 s20, s52, 4096
buffer_load_dwordx4 v40, s[8:11], s20 offen offset:0 sc1 lds
buffer_load_dwordx4 v40, s[8:11], s20 offen offset:1024 sc1 lds
buffer_load_dwordx4 v40, s[8:11], s20 offen offset:2048 sc1 lds
buffer_load_dwordx4 v40, s[8:11], s20 offen offset:3072 sc1 lds
s_add_u32 m0, s50, 131072
s_add_u32 s20, s52, 8192
buffer_load_dwordx4 v40, s[8:11], s20 offen offset:0 sc1 lds
buffer_load_dwordx4 v40, s[8:11], s20 offen offset:1024 sc1 lds
s_waitcnt vmcnt(34)
s_barrier
s_add_u32 s21, s47, 7
s_and_b32 s21, s21, 15
s_lshl_b32 s21, s21, 8
s_add_u32 m0, s46, 32768
s_add_u32 s20, s21, 0
buffer_load_dwordx4 v30, s[4:7], s20 offen lds
s_add_u32 m0, s46, 34816
s_add_u32 s20, s21, 65536
buffer_load_dwordx4 v30, s[4:7], s20 offen lds
s_add_u32 m0, s46, 36864
s_add_u32 s20, s21, 131072
buffer_load_dwordx4 v30, s[4:7], s20 offen lds
s_add_u32 m0, s46, 38912
s_add_u32 s20, s21, 196608
buffer_load_dwordx4 v30, s[4:7], s20 offen lds
s_add_u32 m0, s46, 40960
s_add_u32 s20, s21, 128
buffer_load_dwordx4 v30, s[4:7], s20 offen lds
s_add_u32 m0, s46, 43008
s_add_u32 s20, s21, 65664
buffer_load_dwordx4 v30, s[4:7], s20 offen lds
s_add_u32 m0, s46, 45056
s_add_u32 s20, s21, 131200
buffer_load_dwordx4 v30, s[4:7], s20 offen lds
s_add_u32 m0, s46, 47104
s_add_u32 s20, s21, 196736
buffer_load_dwordx4 v30, s[4:7], s20 offen lds
s_add_u32 m0, s50, 143360
s_add_u32 s20, s52, 20480
buffer_load_dwordx4 v40, s[8:11], s20 offen offset:0 sc1 lds
buffer_load_dwordx4 v40, s[8:11], s20 offen offset:1024 sc1 lds
buffer_load_dwordx4 v40, s[8:11], s20 offen offset:2048 sc1 lds
buffer_load_dwordx4 v40, s[8:11], s20 offen offset:3072 sc1 lds
s_add_u32 m0, s50, 147456
s_add_u32 s20, s52, 24576
buffer_load_dwordx4 v40, s[8:11], s20 offen offset:0 sc1 lds
buffer_load_dwordx4 v40, s[8:11], s20 offen offset:1024 sc1 lds
buffer_load_dwordx4 v40, s[8:11], s20 offen offset:2048 sc1 lds
buffer_load_dwordx4 v40, s[8:11], s20 offen offset:3072 sc1 lds
s_add_u32 m0, s50, 151552
s_add_u32 s20, s52, 28672
buffer_load_dwordx4 v40, s[8:11], s20 offen offset:0 sc1 lds
buffer_load_dwordx4 v40, s[8:11], s20 offen offset:1024 sc1 lds
s_waitcnt vmcnt(44)
s_barrier
s_add_u32 s21, s47, 8
s_and_b32 s21, s21, 15
s_lshl_b32 s21, s21, 8
s_add_u32 m0, s46, 49152
s_add_u32 s20, s21, 0
buffer_load_dwordx4 v30, s[4:7], s20 offen lds
s_add_u32 m0, s46, 51200
s_add_u32 s20, s21, 65536
buffer_load_dwordx4 v30, s[4:7], s20 offen lds
s_add_u32 m0, s46, 53248
s_add_u32 s20, s21, 131072
buffer_load_dwordx4 v30, s[4:7], s20 offen lds
s_add_u32 m0, s46, 55296
s_add_u32 s20, s21, 196608
buffer_load_dwordx4 v30, s[4:7], s20 offen lds
s_add_u32 m0, s46, 57344
s_add_u32 s20, s21, 128
buffer_load_dwordx4 v30, s[4:7], s20 offen lds
s_add_u32 m0, s46, 59392
s_add_u32 s20, s21, 65664
buffer_load_dwordx4 v30, s[4:7], s20 offen lds
s_add_u32 m0, s46, 61440
s_add_u32 s20, s21, 131200
buffer_load_dwordx4 v30, s[4:7], s20 offen lds
s_add_u32 m0, s46, 63488
s_add_u32 s20, s21, 196736
buffer_load_dwordx4 v30, s[4:7], s20 offen lds
s_waitcnt vmcnt(44)
s_barrier
s_add_u32 s21, s47, 9
s_and_b32 s21, s21, 15
s_lshl_b32 s21, s21, 8
s_add_u32 m0, s46, 65536
s_add_u32 s20, s21, 0
buffer_load_dwordx4 v30, s[4:7], s20 offen lds
s_add_u32 m0, s46, 67584
s_add_u32 s20, s21, 65536
buffer_load_dwordx4 v30, s[4:7], s20 offen lds
s_add_u32 m0, s46, 69632
s_add_u32 s20, s21, 131072
buffer_load_dwordx4 v30, s[4:7], s20 offen lds
s_add_u32 m0, s46, 71680
s_add_u32 s20, s21, 196608
buffer_load_dwordx4 v30, s[4:7], s20 offen lds
s_add_u32 m0, s46, 73728
s_add_u32 s20, s21, 128
buffer_load_dwordx4 v30, s[4:7], s20 offen lds
s_add_u32 m0, s46, 75776
s_add_u32 s20, s21, 65664
buffer_load_dwordx4 v30, s[4:7], s20 offen lds
s_add_u32 m0, s46, 77824
s_add_u32 s20, s21, 131200
buffer_load_dwordx4 v30, s[4:7], s20 offen lds
s_add_u32 m0, s46, 79872
s_add_u32 s20, s21, 196736
buffer_load_dwordx4 v30, s[4:7], s20 offen lds
s_waitcnt vmcnt(44)
s_barrier
s_add_u32 s21, s47, 10
s_and_b32 s21, s21, 15
s_lshl_b32 s21, s21, 8
s_add_u32 m0, s46, 0
s_add_u32 s20, s21, 0
buffer_load_dwordx4 v30, s[4:7], s20 offen lds
s_add_u32 m0, s46, 2048
s_add_u32 s20, s21, 65536
buffer_load_dwordx4 v30, s[4:7], s20 offen lds
s_add_u32 m0, s46, 4096
s_add_u32 s20, s21, 131072
buffer_load_dwordx4 v30, s[4:7], s20 offen lds
s_add_u32 m0, s46, 6144
s_add_u32 s20, s21, 196608
buffer_load_dwordx4 v30, s[4:7], s20 offen lds
s_add_u32 m0, s46, 8192
s_add_u32 s20, s21, 128
buffer_load_dwordx4 v30, s[4:7], s20 offen lds
s_add_u32 m0, s46, 10240
s_add_u32 s20, s21, 65664
buffer_load_dwordx4 v30, s[4:7], s20 offen lds
s_add_u32 m0, s46, 12288
s_add_u32 s20, s21, 131200
buffer_load_dwordx4 v30, s[4:7], s20 offen lds
s_add_u32 m0, s46, 14336
s_add_u32 s20, s21, 196736
buffer_load_dwordx4 v30, s[4:7], s20 offen lds
s_waitcnt vmcnt(34)
s_barrier
s_add_u32 s21, s47, 11
s_and_b32 s21, s21, 15
s_lshl_b32 s21, s21, 8
s_add_u32 m0, s46, 16384
s_add_u32 s20, s21, 0
buffer_load_dwordx4 v30, s[4:7], s20 offen lds
s_add_u32 m0, s46, 18432
s_add_u32 s20, s21, 65536
buffer_load_dwordx4 v30, s[4:7], s20 offen lds
s_add_u32 m0, s46, 20480
s_add_u32 s20, s21, 131072
buffer_load_dwordx4 v30, s[4:7], s20 offen lds
s_add_u32 m0, s46, 22528
s_add_u32 s20, s21, 196608
buffer_load_dwordx4 v30, s[4:7], s20 offen lds
s_add_u32 m0, s46, 24576
s_add_u32 s20, s21, 128
buffer_load_dwordx4 v30, s[4:7], s20 offen lds
s_add_u32 m0, s46, 26624
s_add_u32 s20, s21, 65664
buffer_load_dwordx4 v30, s[4:7], s20 offen lds
s_add_u32 m0, s46, 28672
s_add_u32 s20, s21, 131200
buffer_load_dwordx4 v30, s[4:7], s20 offen lds
s_add_u32 m0, s46, 30720
s_add_u32 s20, s21, 196736
buffer_load_dwordx4 v30, s[4:7], s20 offen lds
s_waitcnt vmcnt(24)
s_barrier
s_add_u32 s21, s47, 12
s_and_b32 s21, s21, 15
s_lshl_b32 s21, s21, 8
s_add_u32 m0, s46, 32768
s_add_u32 s20, s21, 0
buffer_load_dwordx4 v30, s[4:7], s20 offen lds
s_add_u32 m0, s46, 34816
s_add_u32 s20, s21, 65536
buffer_load_dwordx4 v30, s[4:7], s20 offen lds
s_add_u32 m0, s46, 36864
s_add_u32 s20, s21, 131072
buffer_load_dwordx4 v30, s[4:7], s20 offen lds
s_add_u32 m0, s46, 38912
s_add_u32 s20, s21, 196608
buffer_load_dwordx4 v30, s[4:7], s20 offen lds
s_add_u32 m0, s46, 40960
s_add_u32 s20, s21, 128
buffer_load_dwordx4 v30, s[4:7], s20 offen lds
s_add_u32 m0, s46, 43008
s_add_u32 s20, s21, 65664
buffer_load_dwordx4 v30, s[4:7], s20 offen lds
s_add_u32 m0, s46, 45056
s_add_u32 s20, s21, 131200
buffer_load_dwordx4 v30, s[4:7], s20 offen lds
s_add_u32 m0, s46, 47104
s_add_u32 s20, s21, 196736
buffer_load_dwordx4 v30, s[4:7], s20 offen lds
s_waitcnt vmcnt(24)
s_barrier
s_add_u32 s21, s47, 13
s_and_b32 s21, s21, 15
s_lshl_b32 s21, s21, 8
s_add_u32 m0, s46, 49152
s_add_u32 s20, s21, 0
buffer_load_dwordx4 v30, s[4:7], s20 offen lds
s_add_u32 m0, s46, 51200
s_add_u32 s20, s21, 65536
buffer_load_dwordx4 v30, s[4:7], s20 offen lds
s_add_u32 m0, s46, 53248
s_add_u32 s20, s21, 131072
buffer_load_dwordx4 v30, s[4:7], s20 offen lds
s_add_u32 m0, s46, 55296
s_add_u32 s20, s21, 196608
buffer_load_dwordx4 v30, s[4:7], s20 offen lds
s_add_u32 m0, s46, 57344
s_add_u32 s20, s21, 128
buffer_load_dwordx4 v30, s[4:7], s20 offen lds
s_add_u32 m0, s46, 59392
s_add_u32 s20, s21, 65664
buffer_load_dwordx4 v30, s[4:7], s20 offen lds
s_add_u32 m0, s46, 61440
s_add_u32 s20, s21, 131200
buffer_load_dwordx4 v30, s[4:7], s20 offen lds
s_add_u32 m0, s46, 63488
s_add_u32 s20, s21, 196736
buffer_load_dwordx4 v30, s[4:7], s20 offen lds
s_waitcnt vmcnt(24)
s_barrier
s_add_u32 s21, s47, 14
s_and_b32 s21, s21, 15
s_lshl_b32 s21, s21, 8
s_add_u32 m0, s46, 65536
s_add_u32 s20, s21, 0
buffer_load_dwordx4 v30, s[4:7], s20 offen lds
s_add_u32 m0, s46, 67584
s_add_u32 s20, s21, 65536
buffer_load_dwordx4 v30, s[4:7], s20 offen lds
s_add_u32 m0, s46, 69632
s_add_u32 s20, s21, 131072
buffer_load_dwordx4 v30, s[4:7], s20 offen lds
s_add_u32 m0, s46, 71680
s_add_u32 s20, s21, 196608
buffer_load_dwordx4 v30, s[4:7], s20 offen lds
s_add_u32 m0, s46, 73728
s_add_u32 s20, s21, 128
buffer_load_dwordx4 v30, s[4:7], s20 offen lds
s_add_u32 m0, s46, 75776
s_add_u32 s20, s21, 65664
buffer_load_dwordx4 v30, s[4:7], s20 offen lds
s_add_u32 m0, s46, 77824
s_add_u32 s20, s21, 131200
buffer_load_dwordx4 v30, s[4:7], s20 offen lds
s_add_u32 m0, s46, 79872
s_add_u32 s20, s21, 196736
buffer_load_dwordx4 v30, s[4:7], s20 offen lds
s_waitcnt vmcnt(24)
s_barrier
s_add_u32 s21, s47, 15
s_and_b32 s21, s21, 15
s_lshl_b32 s21, s21, 8
s_add_u32 m0, s46, 0
s_add_u32 s20, s21, 0
buffer_load_dwordx4 v30, s[4:7], s20 offen lds
s_add_u32 m0, s46, 2048
s_add_u32 s20, s21, 65536
buffer_load_dwordx4 v30, s[4:7], s20 offen lds
s_add_u32 m0, s46, 4096
s_add_u32 s20, s21, 131072
buffer_load_dwordx4 v30, s[4:7], s20 offen lds
s_add_u32 m0, s46, 6144
s_add_u32 s20, s21, 196608
buffer_load_dwordx4 v30, s[4:7], s20 offen lds
s_add_u32 m0, s46, 8192
s_add_u32 s20, s21, 128
buffer_load_dwordx4 v30, s[4:7], s20 offen lds
s_add_u32 m0, s46, 10240
s_add_u32 s20, s21, 65664
buffer_load_dwordx4 v30, s[4:7], s20 offen lds
s_add_u32 m0, s46, 12288
s_add_u32 s20, s21, 131200
buffer_load_dwordx4 v30, s[4:7], s20 offen lds
s_add_u32 m0, s46, 14336
s_add_u32 s20, s21, 196736
buffer_load_dwordx4 v30, s[4:7], s20 offen lds
s_waitcnt vmcnt(24)
s_barrier
s_waitcnt vmcnt(16)
s_barrier
s_add_u32 m0, s50, 81920
s_add_u32 s20, s52, 40960
buffer_load_dwordx4 v40, s[8:11], s20 offen offset:0 sc1 lds
buffer_load_dwordx4 v40, s[8:11], s20 offen offset:1024 sc1 lds
buffer_load_dwordx4 v40, s[8:11], s20 offen offset:2048 sc1 lds
buffer_load_dwordx4 v40, s[8:11], s20 offen offset:3072 sc1 lds
s_add_u32 m0, s50, 86016
s_add_u32 s20, s52, 45056
buffer_load_dwordx4 v40, s[8:11], s20 offen offset:0 sc1 lds
buffer_load_dwordx4 v40, s[8:11], s20 offen offset:1024 sc1 lds
buffer_load_dwordx4 v40, s[8:11], s20 offen offset:2048 sc1 lds
buffer_load_dwordx4 v40, s[8:11], s20 offen offset:3072 sc1 lds
s_add_u32 m0, s50, 90112
s_add_u32 s20, s52, 49152
buffer_load_dwordx4 v40, s[8:11], s20 offen offset:0 sc1 lds
buffer_load_dwordx4 v40, s[8:11], s20 offen offset:1024 sc1 lds
s_waitcnt vmcnt(18)
s_barrier
s_add_u32 m0, s50, 102400
s_add_u32 s20, s52, 61440
buffer_load_dwordx4 v40, s[8:11], s20 offen offset:0 sc1 lds
buffer_load_dwordx4 v40, s[8:11], s20 offen offset:1024 sc1 lds
buffer_load_dwordx4 v40, s[8:11], s20 offen offset:2048 sc1 lds
buffer_load_dwordx4 v40, s[8:11], s20 offen offset:3072 sc1 lds
s_add_u32 m0, s50, 106496
s_add_u32 s20, s52, 65536
buffer_load_dwordx4 v40, s[8:11], s20 offen offset:0 sc1 lds
buffer_load_dwordx4 v40, s[8:11], s20 offen offset:1024 sc1 lds
buffer_load_dwordx4 v40, s[8:11], s20 offen offset:2048 sc1 lds
buffer_load_dwordx4 v40, s[8:11], s20 offen offset:3072 sc1 lds
s_add_u32 m0, s50, 110592
s_add_u32 s20, s52, 69632
buffer_load_dwordx4 v40, s[8:11], s20 offen offset:0 sc1 lds
buffer_load_dwordx4 v40, s[8:11], s20 offen offset:1024 sc1 lds
s_waitcnt vmcnt(20)
s_barrier
s_add_u32 m0, s50, 16384
s_add_u32 s20, s52, 81920
buffer_load_dwordx4 v40, s[8:11], s20 offen offset:0 sc1 lds
buffer_load_dwordx4 v40, s[8:11], s20 offen offset:1024 sc1 lds
buffer_load_dwordx4 v40, s[8:11], s20 offen offset:2048 sc1 lds
buffer_load_dwordx4 v40, s[8:11], s20 offen offset:3072 sc1 lds
s_add_u32 m0, s50, 20480
s_add_u32 s20, s52, 86016
buffer_load_dwordx4 v40, s[8:11], s20 offen offset:0 sc1 lds
buffer_load_dwordx4 v40, s[8:11], s20 offen offset:1024 sc1 lds
buffer_load_dwordx4 v40, s[8:11], s20 offen offset:2048 sc1 lds
buffer_load_dwordx4 v40, s[8:11], s20 offen offset:3072 sc1 lds
s_add_u32 m0, s50, 24576
s_add_u32 s20, s52, 90112
buffer_load_dwordx4 v40, s[8:11], s20 offen offset:0 sc1 lds
buffer_load_dwordx4 v40, s[8:11], s20 offen offset:1024 sc1 lds
s_barrier
s_add_u32 m0, s50, 36864
s_add_u32 s20, s52, 102400
buffer_load_dwordx4 v40, s[8:11], s20 offen offset:0 sc1 lds
buffer_load_dwordx4 v40, s[8:11], s20 offen offset:1024 sc1 lds
buffer_load_dwordx4 v40, s[8:11], s20 offen offset:2048 sc1 lds
buffer_load_dwordx4 v40, s[8:11], s20 offen offset:3072 sc1 lds
s_add_u32 m0, s50, 40960
s_add_u32 s20, s52, 106496
buffer_load_dwordx4 v40, s[8:11], s20 offen offset:0 sc1 lds
buffer_load_dwordx4 v40, s[8:11], s20 offen offset:1024 sc1 lds
buffer_load_dwordx4 v40, s[8:11], s20 offen offset:2048 sc1 lds
buffer_load_dwordx4 v40, s[8:11], s20 offen offset:3072 sc1 lds
s_add_u32 m0, s50, 45056
s_add_u32 s20, s52, 110592
buffer_load_dwordx4 v40, s[8:11], s20 offen offset:0 sc1 lds
buffer_load_dwordx4 v40, s[8:11], s20 offen offset:1024 sc1 lds
s_add_u32 m0, s50, 57344
s_add_u32 s20, s52, 122880
buffer_load_dwordx4 v40, s[8:11], s20 offen offset:0 sc1 lds
buffer_load_dwordx4 v40, s[8:11], s20 offen offset:1024 sc1 lds
buffer_load_dwordx4 v40, s[8:11], s20 offen offset:2048 sc1 lds
buffer_load_dwordx4 v40, s[8:11], s20 offen offset:3072 sc1 lds
s_add_u32 m0, s50, 61440
s_add_u32 s20, s52, 126976
buffer_load_dwordx4 v40, s[8:11], s20 offen offset:0 sc1 lds
buffer_load_dwordx4 v40, s[8:11], s20 offen offset:1024 sc1 lds
buffer_load_dwordx4 v40, s[8:11], s20 offen offset:2048 sc1 lds
buffer_load_dwordx4 v40, s[8:11], s20 offen offset:3072 sc1 lds
s_add_u32 m0, s50, 65536
s_add_u32 s20, s52, 131072
buffer_load_dwordx4 v40, s[8:11], s20 offen offset:0 sc1 lds
buffer_load_dwordx4 v40, s[8:11], s20 offen offset:1024 sc1 lds
s_add_u32 m0, s51, 0
s_add_u32 s20, s53, 225280
buffer_load_dwordx4 v40, s[8:11], s20 offen offset:0 sc1 lds
buffer_load_dwordx4 v40, s[8:11], s20 offen offset:1024 sc1 lds
buffer_load_dwordx4 v40, s[8:11], s20 offen offset:2048 sc1 lds
buffer_load_dwordx4 v40, s[8:11], s20 offen offset:3072 sc1 lds
s_add_u32 m0, s51, 4096
s_add_u32 s20, s53, 229376
buffer_load_dwordx4 v40, s[8:11], s20 offen offset:0 sc1 lds
buffer_load_dwordx4 v40, s[8:11], s20 offen offset:1024 sc1 lds
buffer_load_dwordx4 v40, s[8:11], s20 offen offset:2048 sc1 lds
buffer_load_dwordx4 v40, s[8:11], s20 offen offset:3072 sc1 lds
s_barrier
s_waitcnt vmcnt(48)
s_barrier
s_add_u32 m0, s50, 122880
s_add_u32 s20, s52, 143360
buffer_load_dwordx4 v40, s[8:11], s20 offen offset:0 sc1 lds
buffer_load_dwordx4 v40, s[8:11], s20 offen offset:1024 sc1 lds
buffer_load_dwordx4 v40, s[8:11], s20 offen offset:2048 sc1 lds
buffer_load_dwordx4 v40, s[8:11], s20 offen offset:3072 sc1 lds
s_add_u32 m0, s50, 126976
s_add_u32 s20, s52, 147456
buffer_load_dwordx4 v40, s[8:11], s20 offen offset:0 sc1 lds
buffer_load_dwordx4 v40, s[8:11], s20 offen offset:1024 sc1 lds
buffer_load_dwordx4 v40, s[8:11], s20 offen offset:2048 sc1 lds
buffer_load_dwordx4 v40, s[8:11], s20 offen offset:3072 sc1 lds
s_add_u32 m0, s50, 131072
s_add_u32 s20, s52, 151552
buffer_load_dwordx4 v40, s[8:11], s20 offen offset:0 sc1 lds
buffer_load_dwordx4 v40, s[8:11], s20 offen offset:1024 sc1 lds
s_waitcnt vmcnt(48)
s_barrier
s_add_u32 m0, s50, 143360
s_add_u32 s20, s52, 163840
buffer_load_dwordx4 v40, s[8:11], s20 offen offset:0 sc1 lds
buffer_load_dwordx4 v40, s[8:11], s20 offen offset:1024 sc1 lds
buffer_load_dwordx4 v40, s[8:11], s20 offen offset:2048 sc1 lds
buffer_load_dwordx4 v40, s[8:11], s20 offen offset:3072 sc1 lds
s_add_u32 m0, s50, 147456
s_add_u32 s20, s52, 167936
buffer_load_dwordx4 v40, s[8:11], s20 offen offset:0 sc1 lds
buffer_load_dwordx4 v40, s[8:11], s20 offen offset:1024 sc1 lds
buffer_load_dwordx4 v40, s[8:11], s20 offen offset:2048 sc1 lds
buffer_load_dwordx4 v40, s[8:11], s20 offen offset:3072 sc1 lds
s_add_u32 m0, s50, 151552
s_add_u32 s20, s52, 172032
buffer_load_dwordx4 v40, s[8:11], s20 offen offset:0 sc1 lds
buffer_load_dwordx4 v40, s[8:11], s20 offen offset:1024 sc1 lds
s_waitcnt vmcnt(48)
s_barrier
s_add_u32 m0, s50, 81920
s_add_u32 s20, s52, 184320
buffer_load_dwordx4 v40, s[8:11], s20 offen offset:0 sc1 lds
buffer_load_dwordx4 v40, s[8:11], s20 offen offset:1024 sc1 lds
buffer_load_dwordx4 v40, s[8:11], s20 offen offset:2048 sc1 lds
buffer_load_dwordx4 v40, s[8:11], s20 offen offset:3072 sc1 lds
s_add_u32 m0, s50, 86016
s_add_u32 s20, s52, 188416
buffer_load_dwordx4 v40, s[8:11], s20 offen offset:0 sc1 lds
buffer_load_dwordx4 v40, s[8:11], s20 offen offset:1024 sc1 lds
buffer_load_dwordx4 v40, s[8:11], s20 offen offset:2048 sc1 lds
buffer_load_dwordx4 v40, s[8:11], s20 offen offset:3072 sc1 lds
s_add_u32 m0, s50, 90112
s_add_u32 s20, s52, 192512
buffer_load_dwordx4 v40, s[8:11], s20 offen offset:0 sc1 lds
buffer_load_dwordx4 v40, s[8:11], s20 offen offset:1024 sc1 lds
s_waitcnt vmcnt(48)
s_barrier
s_add_u32 m0, s50, 102400
s_add_u32 s20, s52, 204800
buffer_load_dwordx4 v40, s[8:11], s20 offen offset:0 sc1 lds
buffer_load_dwordx4 v40, s[8:11], s20 offen offset:1024 sc1 lds
buffer_load_dwordx4 v40, s[8:11], s20 offen offset:2048 sc1 lds
buffer_load_dwordx4 v40, s[8:11], s20 offen offset:3072 sc1 lds
s_add_u32 m0, s50, 106496
s_add_u32 s20, s52, 208896
buffer_load_dwordx4 v40, s[8:11], s20 offen offset:0 sc1 lds
buffer_load_dwordx4 v40, s[8:11], s20 offen offset:1024 sc1 lds
buffer_load_dwordx4 v40, s[8:11], s20 offen offset:2048 sc1 lds
buffer_load_dwordx4 v40, s[8:11], s20 offen offset:3072 sc1 lds
s_add_u32 m0, s50, 110592
s_add_u32 s20, s52, 212992
buffer_load_dwordx4 v40, s[8:11], s20 offen offset:0 sc1 lds
buffer_load_dwordx4 v40, s[8:11], s20 offen offset:1024 sc1 lds
s_waitcnt vmcnt(48)
s_barrier
s_waitcnt vmcnt(30)
s_barrier
s_waitcnt vmcnt(20)
s_barrier
s_waitcnt vmcnt(10)
s_barrier
s_waitcnt vmcnt(0)
s_barrier
s_barrier
s_endpgm
.p2align 6
L_cons:
s_waitcnt lgkmcnt(0)
s_mov_b32 s8, s84
s_mov_b32 s9, s85
s_mov_b32 s10, 0x10000000
s_mov_b32 s11, 0x20000
s_add_u32 s20, s84, 31457280
s_addc_u32 s21, s85, 0
s_load_dword s34, s[20:21], 0
s_lshr_b32 s38, s3, 1
s_and_b32 s39, s3, 1
v_and_b32 v246, 15, v250
v_lshrrev_b32 v247, 4, v250
v_lshrrev_b32 v228, 1, v246
v_xor_b32 v228, v228, v247
v_lshlrev_b32 v228, 4, v228
v_lshl_add_u32 v228, v246, 7, v228
s_lshl_b32 s20, s38, 13
v_add_u32 v128, s20, v228
v_xor_b32 v129, 64, v128
v_bfe_u32 v229, v250, 2, 2
v_lshl_add_u32 v230, v247, 3, v229
v_lshlrev_b32 v230, 7, v230
v_and_b32 v231, 3, v250
v_lshl_add_u32 v230, v231, 3, v230
v_add_u32 v230, 16384, v230
v_lshrrev_b32 v229, 1, v229
v_and_b32 v231, 1, v247
v_lshl_or_b32 v229, v231, 1, v229
s_lshl_b32 s20, s39, 1
v_xor_b32 v229, s20, v229
v_xor_b32 v231, 0, v229
v_lshl_add_u32 v130, v231, 5, v230
v_xor_b32 v231, 1, v229
v_lshl_add_u32 v131, v231, 5, v230
v_add_u32 v132, 65536, v128
v_add_u32 v133, 65536, v129
v_add_u32 v134, 65536, v130
v_add_u32 v135, 65536, v131
v_mov_b32 v216, 0x3f803f80
v_mov_b32 v217, 0x3f803f80
v_mov_b32 v218, 0x3f803f80
v_mov_b32 v219, 0x3f803f80
v_and_b32 v233, 1, v247
v_lshrrev_b32 v234, 1, v247
v_lshl_or_b32 v253, v233, 1, v234
v_lshlrev_b32 v233, 8, v253
v_lshl_add_u32 v233, v246, 4, v233
s_lshl_b32 s20, s32, 3
s_lshl_b32 s21, s38, 2
s_add_u32 s20, s20, s21
s_min_u32 s21, s33, 12
s_lshl_b32 s21, s21, 3
s_lshl_b32 s22, s39, 2
s_add_u32 s21, s21, s22
s_lshl_b32 s21, s21, 8
s_mul_i32 s23, s20, 28672
s_add_u32 s21, s21, s23
s_add_u32 s21, s21, 8388608
v_add_u32 v251, s21, v233
s_min_u32 s21, s33, 14
s_lshl_b32 s21, s21, 4
s_add_u32 s21, s21, s22
s_lshl_b32 s21, s21, 8
s_mul_i32 s23, s20, 61440
s_add_u32 s21, s21, s23
v_add_u32 v252, s21, v233
s_waitcnt lgkmcnt(0)
s_mul_i32 s34, s34, 1664525
s_add_u32 s34, s34, 1013904223
s_barrier
ds_read_b128 v[64:67], v128 offset:0
ds_read_b64_tr_b16 v[96:97], v130 offset:0
ds_read_b64_tr_b16 v[98:99], v130 offset:512
ds_read_b64_tr_b16 v[100:101], v131 offset:0
ds_read_b64_tr_b16 v[102:103], v131 offset:512
ds_read_b128 v[68:71], v128 offset:2048
ds_read_b64_tr_b16 v[104:105], v130 offset:8192
ds_read_b64_tr_b16 v[106:107], v130 offset:8704
ds_read_b64_tr_b16 v[108:109], v131 offset:8192
ds_read_b64_tr_b16 v[110:111], v131 offset:8704
ds_read_b128 v[72:75], v128 offset:4096
ds_read_b128 v[76:79], v128 offset:6144
s_waitcnt lgkmcnt(0)
v_mfma_f32_16x16x32_bf16 v[0:3], v[96:99], v[64:67], 0
ds_read_b128 v[80:83], v129 offset:0
ds_read_b64_tr_b16 v[112:113], v130 offset:4096
v_mfma_f32_16x16x32_bf16 v[4:7], v[100:103], v[64:67], 0
ds_read_b64_tr_b16 v[114:115], v130 offset:4608
ds_read_b64_tr_b16 v[116:117], v131 offset:4096
v_mfma_f32_16x16x32_bf16 v[8:11], v[104:107], v[64:67], 0
ds_read_b64_tr_b16 v[118:119], v131 offset:4608
ds_read_b128 v[84:87], v129 offset:2048
v_mfma_f32_16x16x32_bf16 v[12:15], v[108:111], v[64:67], 0
ds_read_b64_tr_b16 v[120:121], v130 offset:12288
ds_read_b64_tr_b16 v[122:123], v130 offset:12800
v_mfma_f32_16x16x32_bf16 v[16:19], v[96:99], v[68:71], 0
ds_read_b64_tr_b16 v[124:125], v131 offset:12288
v_mfma_f32_16x16x32_bf16 v[20:23], v[100:103], v[68:71], 0
ds_read_b64_tr_b16 v[126:127], v131 offset:12800
v_mfma_f32_16x16x32_bf16 v[24:27], v[104:107], v[68:71], 0
ds_read_b128 v[88:91], v129 offset:4096
v_mfma_f32_16x16x32_bf16 v[28:31], v[108:111], v[68:71], 0
ds_read_b128 v[92:95], v129 offset:6144
v_mfma_f32_16x16x32_bf16 v[32:35], v[96:99], v[72:75], 0
v_mfma_f32_16x16x32_bf16 v[36:39], v[100:103], v[72:75], 0
v_mfma_f32_16x16x32_bf16 v[40:43], v[104:107], v[72:75], 0
v_mfma_f32_16x16x32_bf16 v[44:47], v[108:111], v[72:75], 0
v_mfma_f32_16x16x32_bf16 v[48:51], v[96:99], v[76:79], 0
v_mfma_f32_16x16x32_bf16 v[52:55], v[100:103], v[76:79], 0
v_mfma_f32_16x16x32_bf16 v[56:59], v[104:107], v[76:79], 0
v_mfma_f32_16x16x32_bf16 v[60:63], v[108:111], v[76:79], 0
s_cmp_eq_u32 s38, 1
s_cbranch_scc1 Lcs_1
v_mfma_f32_16x16x32_bf16 v[208:211], v[96:99], v[216:219], 0
v_mfma_f32_16x16x32_bf16 v[212:215], v[100:103], v[216:219], 0
s_branch Lcj_2
Lcs_1:
v_mfma_f32_16x16x32_bf16 v[208:211], v[104:107], v[216:219], 0
v_mfma_f32_16x16x32_bf16 v[212:215], v[108:111], v[216:219], 0
Lcj_2:
s_waitcnt lgkmcnt(0)
s_barrier
v_mfma_f32_16x16x32_bf16 v[0:3], v[112:115], v[80:83], v[0:3]
ds_read_b128 v[64:67], v128 offset:32768
ds_read_b64_tr_b16 v[96:97], v130 offset:32768
v_mfma_f32_16x16x32_bf16 v[4:7], v[116:119], v[80:83], v[4:7]
ds_read_b64_tr_b16 v[98:99], v130 offset:33280
ds_read_b64_tr_b16 v[100:101], v131 offset:32768
v_mfma_f32_16x16x32_bf16 v[8:11], v[120:123], v[80:83], v[8:11]
ds_read_b64_tr_b16 v[102:103], v131 offset:33280
ds_read_b128 v[68:71], v128 offset:34816
v_mfma_f32_16x16x32_bf16 v[12:15], v[124:127], v[80:83], v[12:15]
ds_read_b64_tr_b16 v[104:105], v130 offset:40960
ds_read_b64_tr_b16 v[106:107], v130 offset:41472
v_mfma_f32_16x16x32_bf16 v[16:19], v[112:115], v[84:87], v[16:19]
ds_read_b64_tr_b16 v[108:109], v131 offset:40960
v_mfma_f32_16x16x32_bf16 v[20:23], v[116:119], v[84:87], v[20:23]
ds_read_b64_tr_b16 v[110:111], v131 offset:41472
v_mfma_f32_16x16x32_bf16 v[24:27], v[120:123], v[84:87], v[24:27]
ds_read_b128 v[72:75], v128 offset:36864
v_mfma_f32_16x16x32_bf16 v[28:31], v[124:127], v[84:87], v[28:31]
ds_read_b128 v[76:79], v128 offset:38912
v_mfma_f32_16x16x32_bf16 v[32:35], v[112:115], v[88:91], v[32:35]
v_mfma_f32_16x16x32_bf16 v[36:39], v[116:119], v[88:91], v[36:39]
v_mfma_f32_16x16x32_bf16 v[40:43], v[120:123], v[88:91], v[40:43]
v_mfma_f32_16x16x32_bf16 v[44:47], v[124:127], v[88:91], v[44:47]
v_mfma_f32_16x16x32_bf16 v[48:51], v[112:115], v[92:95], v[48:51]
v_mfma_f32_16x16x32_bf16 v[52:55], v[116:119], v[92:95], v[52:55]
v_mfma_f32_16x16x32_bf16 v[56:59], v[120:123], v[92:95], v[56:59]
v_mfma_f32_16x16x32_bf16 v[60:63], v[124:127], v[92:95], v[60:63]
s_cmp_eq_u32 s38, 1
s_cbranch_scc1 Lcs_3
v_mfma_f32_16x16x32_bf16 v[208:211], v[112:115], v[216:219], v[208:211]
v_mfma_f32_16x16x32_bf16 v[212:215], v[116:119], v[216:219], v[212:215]
s_branch Lcj_4
Lcs_3:
v_mfma_f32_16x16x32_bf16 v[208:211], v[120:123], v[216:219], v[208:211]
v_mfma_f32_16x16x32_bf16 v[212:215], v[124:127], v[216:219], v[212:215]
Lcj_4:
s_waitcnt lgkmcnt(0)
v_mfma_f32_16x16x32_bf16 v[0:3], v[96:99], v[64:67], v[0:3]
ds_read_b128 v[80:83], v129 offset:32768
ds_read_b64_tr_b16 v[112:113], v130 offset:36864
v_mfma_f32_16x16x32_bf16 v[4:7], v[100:103], v[64:67], v[4:7]
ds_read_b64_tr_b16 v[114:115], v130 offset:37376
ds_read_b64_tr_b16 v[116:117], v131 offset:36864
v_mfma_f32_16x16x32_bf16 v[8:11], v[104:107], v[64:67], v[8:11]
ds_read_b64_tr_b16 v[118:119], v131 offset:37376
ds_read_b128 v[84:87], v129 offset:34816
v_mfma_f32_16x16x32_bf16 v[12:15], v[108:111], v[64:67], v[12:15]
ds_read_b64_tr_b16 v[120:121], v130 offset:45056
ds_read_b64_tr_b16 v[122:123], v130 offset:45568
v_mfma_f32_16x16x32_bf16 v[16:19], v[96:99], v[68:71], v[16:19]
ds_read_b64_tr_b16 v[124:125], v131 offset:45056
v_mfma_f32_16x16x32_bf16 v[20:23], v[100:103], v[68:71], v[20:23]
ds_read_b64_tr_b16 v[126:127], v131 offset:45568
v_mfma_f32_16x16x32_bf16 v[24:27], v[104:107], v[68:71], v[24:27]
ds_read_b128 v[88:91], v129 offset:36864
v_mfma_f32_16x16x32_bf16 v[28:31], v[108:111], v[68:71], v[28:31]
ds_read_b128 v[92:95], v129 offset:38912
v_mfma_f32_16x16x32_bf16 v[32:35], v[96:99], v[72:75], v[32:35]
v_mfma_f32_16x16x32_bf16 v[36:39], v[100:103], v[72:75], v[36:39]
v_mfma_f32_16x16x32_bf16 v[40:43], v[104:107], v[72:75], v[40:43]
v_mfma_f32_16x16x32_bf16 v[44:47], v[108:111], v[72:75], v[44:47]
v_mfma_f32_16x16x32_bf16 v[48:51], v[96:99], v[76:79], v[48:51]
v_mfma_f32_16x16x32_bf16 v[52:55], v[100:103], v[76:79], v[52:55]
v_mfma_f32_16x16x32_bf16 v[56:59], v[104:107], v[76:79], v[56:59]
v_mfma_f32_16x16x32_bf16 v[60:63], v[108:111], v[76:79], v[60:63]
s_cmp_eq_u32 s38, 1
s_cbranch_scc1 Lcs_5
v_mfma_f32_16x16x32_bf16 v[208:211], v[96:99], v[216:219], v[208:211]
v_mfma_f32_16x16x32_bf16 v[212:215], v[100:103], v[216:219], v[212:215]
s_branch Lcj_6
Lcs_5:
v_mfma_f32_16x16x32_bf16 v[208:211], v[104:107], v[216:219], v[208:211]
v_mfma_f32_16x16x32_bf16 v[212:215], v[108:111], v[216:219], v[212:215]
Lcj_6:
s_waitcnt lgkmcnt(0)
s_barrier
v_mfma_f32_16x16x32_bf16 v[0:3], v[112:115], v[80:83], v[0:3]
ds_read_b128 v[64:67], v132 offset:0
ds_read_b64_tr_b16 v[96:97], v134 offset:0
v_mfma_f32_16x16x32_bf16 v[4:7], v[116:119], v[80:83], v[4:7]
ds_read_b64_tr_b16 v[98:99], v134 offset:512
ds_read_b64_tr_b16 v[100:101], v135 offset:0
v_mfma_f32_16x16x32_bf16 v[8:11], v[120:123], v[80:83], v[8:11]
ds_read_b64_tr_b16 v[102:103], v135 offset:512
ds_read_b128 v[68:71], v132 offset:2048
v_mfma_f32_16x16x32_bf16 v[12:15], v[124:127], v[80:83], v[12:15]
ds_read_b64_tr_b16 v[104:105], v134 offset:8192
ds_read_b64_tr_b16 v[106:107], v134 offset:8704
v_mfma_f32_16x16x32_bf16 v[16:19], v[112:115], v[84:87], v[16:19]
ds_read_b64_tr_b16 v[108:109], v135 offset:8192
v_mfma_f32_16x16x32_bf16 v[20:23], v[116:119], v[84:87], v[20:23]
ds_read_b64_tr_b16 v[110:111], v135 offset:8704
v_mfma_f32_16x16x32_bf16 v[24:27], v[120:123], v[84:87], v[24:27]
ds_read_b128 v[72:75], v132 offset:4096
v_mfma_f32_16x16x32_bf16 v[28:31], v[124:127], v[84:87], v[28:31]
ds_read_b128 v[76:79], v132 offset:6144
v_mfma_f32_16x16x32_bf16 v[32:35], v[112:115], v[88:91], v[32:35]
v_mfma_f32_16x16x32_bf16 v[36:39], v[116:119], v[88:91], v[36:39]
v_mfma_f32_16x16x32_bf16 v[40:43], v[120:123], v[88:91], v[40:43]
v_mfma_f32_16x16x32_bf16 v[44:47], v[124:127], v[88:91], v[44:47]
v_mfma_f32_16x16x32_bf16 v[48:51], v[112:115], v[92:95], v[48:51]
v_mfma_f32_16x16x32_bf16 v[52:55], v[116:119], v[92:95], v[52:55]
v_mfma_f32_16x16x32_bf16 v[56:59], v[120:123], v[92:95], v[56:59]
v_mfma_f32_16x16x32_bf16 v[60:63], v[124:127], v[92:95], v[60:63]
s_cmp_eq_u32 s38, 1
s_cbranch_scc1 Lcs_7
v_mfma_f32_16x16x32_bf16 v[208:211], v[112:115], v[216:219], v[208:211]
v_mfma_f32_16x16x32_bf16 v[212:215], v[116:119], v[216:219], v[212:215]
s_branch Lcj_8
Lcs_7:
v_mfma_f32_16x16x32_bf16 v[208:211], v[120:123], v[216:219], v[208:211]
v_mfma_f32_16x16x32_bf16 v[212:215], v[124:127], v[216:219], v[212:215]
Lcj_8:
s_waitcnt lgkmcnt(0)
v_mfma_f32_16x16x32_bf16 v[0:3], v[96:99], v[64:67], v[0:3]
ds_read_b128 v[80:83], v133 offset:0
ds_read_b64_tr_b16 v[112:113], v134 offset:4096
v_mfma_f32_16x16x32_bf16 v[4:7], v[100:103], v[64:67], v[4:7]
ds_read_b64_tr_b16 v[114:115], v134 offset:4608
ds_read_b64_tr_b16 v[116:117], v135 offset:4096
v_mfma_f32_16x16x32_bf16 v[8:11], v[104:107], v[64:67], v[8:11]
ds_read_b64_tr_b16 v[118:119], v135 offset:4608
ds_read_b128 v[84:87], v133 offset:2048
v_mfma_f32_16x16x32_bf16 v[12:15], v[108:111], v[64:67], v[12:15]
ds_read_b64_tr_b16 v[120:121], v134 offset:12288
ds_read_b64_tr_b16 v[122:123], v134 offset:12800
v_mfma_f32_16x16x32_bf16 v[16:19], v[96:99], v[68:71], v[16:19]
ds_read_b64_tr_b16 v[124:125], v135 offset:12288
v_mfma_f32_16x16x32_bf16 v[20:23], v[100:103], v[68:71], v[20:23]
ds_read_b64_tr_b16 v[126:127], v135 offset:12800
v_mfma_f32_16x16x32_bf16 v[24:27], v[104:107], v[68:71], v[24:27]
ds_read_b128 v[88:91], v133 offset:4096
v_mfma_f32_16x16x32_bf16 v[28:31], v[108:111], v[68:71], v[28:31]
ds_read_b128 v[92:95], v133 offset:6144
v_mfma_f32_16x16x32_bf16 v[32:35], v[96:99], v[72:75], v[32:35]
v_mfma_f32_16x16x32_bf16 v[36:39], v[100:103], v[72:75], v[36:39]
v_mfma_f32_16x16x32_bf16 v[40:43], v[104:107], v[72:75], v[40:43]
v_mfma_f32_16x16x32_bf16 v[44:47], v[108:111], v[72:75], v[44:47]
v_mfma_f32_16x16x32_bf16 v[48:51], v[96:99], v[76:79], v[48:51]
v_mfma_f32_16x16x32_bf16 v[52:55], v[100:103], v[76:79], v[52:55]
v_mfma_f32_16x16x32_bf16 v[56:59], v[104:107], v[76:79], v[56:59]
v_mfma_f32_16x16x32_bf16 v[60:63], v[108:111], v[76:79], v[60:63]
s_cmp_eq_u32 s38, 1
s_cbranch_scc1 Lcs_9
v_mfma_f32_16x16x32_bf16 v[208:211], v[96:99], v[216:219], v[208:211]
v_mfma_f32_16x16x32_bf16 v[212:215], v[100:103], v[216:219], v[212:215]
s_branch Lcj_10
Lcs_9:
v_mfma_f32_16x16x32_bf16 v[208:211], v[104:107], v[216:219], v[208:211]
v_mfma_f32_16x16x32_bf16 v[212:215], v[108:111], v[216:219], v[212:215]
Lcj_10:
s_waitcnt lgkmcnt(0)
s_barrier
v_mfma_f32_16x16x32_bf16 v[0:3], v[112:115], v[80:83], v[0:3]
ds_read_b128 v[64:67], v132 offset:32768
ds_read_b64_tr_b16 v[96:97], v134 offset:32768
v_mfma_f32_16x16x32_bf16 v[4:7], v[116:119], v[80:83], v[4:7]
ds_read_b64_tr_b16 v[98:99], v134 offset:33280
ds_read_b64_tr_b16 v[100:101], v135 offset:32768
v_mfma_f32_16x16x32_bf16 v[8:11], v[120:123], v[80:83], v[8:11]
ds_read_b64_tr_b16 v[102:103], v135 offset:33280
ds_read_b128 v[68:71], v132 offset:34816
v_mfma_f32_16x16x32_bf16 v[12:15], v[124:127], v[80:83], v[12:15]
ds_read_b64_tr_b16 v[104:105], v134 offset:40960
ds_read_b64_tr_b16 v[106:107], v134 offset:41472
v_mfma_f32_16x16x32_bf16 v[16:19], v[112:115], v[84:87], v[16:19]
ds_read_b64_tr_b16 v[108:109], v135 offset:40960
v_mfma_f32_16x16x32_bf16 v[20:23], v[116:119], v[84:87], v[20:23]
ds_read_b64_tr_b16 v[110:111], v135 offset:41472
v_mfma_f32_16x16x32_bf16 v[24:27], v[120:123], v[84:87], v[24:27]
ds_read_b128 v[72:75], v132 offset:36864
v_mfma_f32_16x16x32_bf16 v[28:31], v[124:127], v[84:87], v[28:31]
ds_read_b128 v[76:79], v132 offset:38912
v_mfma_f32_16x16x32_bf16 v[32:35], v[112:115], v[88:91], v[32:35]
v_mfma_f32_16x16x32_bf16 v[36:39], v[116:119], v[88:91], v[36:39]
v_mfma_f32_16x16x32_bf16 v[40:43], v[120:123], v[88:91], v[40:43]
v_mfma_f32_16x16x32_bf16 v[44:47], v[124:127], v[88:91], v[44:47]
v_mfma_f32_16x16x32_bf16 v[48:51], v[112:115], v[92:95], v[48:51]
v_mfma_f32_16x16x32_bf16 v[52:55], v[116:119], v[92:95], v[52:55]
v_mfma_f32_16x16x32_bf16 v[56:59], v[120:123], v[92:95], v[56:59]
v_mfma_f32_16x16x32_bf16 v[60:63], v[124:127], v[92:95], v[60:63]
s_cmp_eq_u32 s38, 1
s_cbranch_scc1 Lcs_11
v_mfma_f32_16x16x32_bf16 v[208:211], v[112:115], v[216:219], v[208:211]
v_mfma_f32_16x16x32_bf16 v[212:215], v[116:119], v[216:219], v[212:215]
s_branch Lcj_12
Lcs_11:
v_mfma_f32_16x16x32_bf16 v[208:211], v[120:123], v[216:219], v[208:211]
v_mfma_f32_16x16x32_bf16 v[212:215], v[124:127], v[216:219], v[212:215]
Lcj_12:
s_waitcnt lgkmcnt(0)
v_mfma_f32_16x16x32_bf16 v[0:3], v[96:99], v[64:67], v[0:3]
ds_read_b128 v[80:83], v133 offset:32768
ds_read_b64_tr_b16 v[112:113], v134 offset:36864
v_mfma_f32_16x16x32_bf16 v[4:7], v[100:103], v[64:67], v[4:7]
ds_read_b64_tr_b16 v[114:115], v134 offset:37376
ds_read_b64_tr_b16 v[116:117], v135 offset:36864
v_mfma_f32_16x16x32_bf16 v[8:11], v[104:107], v[64:67], v[8:11]
ds_read_b64_tr_b16 v[118:119], v135 offset:37376
ds_read_b128 v[84:87], v133 offset:34816
v_mfma_f32_16x16x32_bf16 v[12:15], v[108:111], v[64:67], v[12:15]
ds_read_b64_tr_b16 v[120:121], v134 offset:45056
ds_read_b64_tr_b16 v[122:123], v134 offset:45568
v_mfma_f32_16x16x32_bf16 v[16:19], v[96:99], v[68:71], v[16:19]
ds_read_b64_tr_b16 v[124:125], v135 offset:45056
v_mfma_f32_16x16x32_bf16 v[20:23], v[100:103], v[68:71], v[20:23]
ds_read_b64_tr_b16 v[126:127], v135 offset:45568
v_mfma_f32_16x16x32_bf16 v[24:27], v[104:107], v[68:71], v[24:27]
ds_read_b128 v[88:91], v133 offset:36864
v_mfma_f32_16x16x32_bf16 v[28:31], v[108:111], v[68:71], v[28:31]
ds_read_b128 v[92:95], v133 offset:38912
v_mfma_f32_16x16x32_bf16 v[32:35], v[96:99], v[72:75], v[32:35]
v_mfma_f32_16x16x32_bf16 v[36:39], v[100:103], v[72:75], v[36:39]
v_mfma_f32_16x16x32_bf16 v[40:43], v[104:107], v[72:75], v[40:43]
v_mfma_f32_16x16x32_bf16 v[44:47], v[108:111], v[72:75], v[44:47]
v_mfma_f32_16x16x32_bf16 v[48:51], v[96:99], v[76:79], v[48:51]
v_mfma_f32_16x16x32_bf16 v[52:55], v[100:103], v[76:79], v[52:55]
v_mfma_f32_16x16x32_bf16 v[56:59], v[104:107], v[76:79], v[56:59]
v_mfma_f32_16x16x32_bf16 v[60:63], v[108:111], v[76:79], v[60:63]
s_cmp_eq_u32 s38, 1
s_cbranch_scc1 Lcs_13
v_mfma_f32_16x16x32_bf16 v[208:211], v[96:99], v[216:219], v[208:211]
v_mfma_f32_16x16x32_bf16 v[212:215], v[100:103], v[216:219], v[212:215]
s_branch Lcj_14
Lcs_13:
v_mfma_f32_16x16x32_bf16 v[208:211], v[104:107], v[216:219], v[208:211]
v_mfma_f32_16x16x32_bf16 v[212:215], v[108:111], v[216:219], v[212:215]
Lcj_14:
s_waitcnt lgkmcnt(0)
s_barrier
v_mfma_f32_16x16x32_bf16 v[0:3], v[112:115], v[80:83], v[0:3]
ds_read_b128 v[64:67], v128 offset:0
ds_read_b64_tr_b16 v[96:97], v130 offset:0
v_mfma_f32_16x16x32_bf16 v[4:7], v[116:119], v[80:83], v[4:7]
ds_read_b64_tr_b16 v[98:99], v130 offset:512
ds_read_b64_tr_b16 v[100:101], v131 offset:0
v_mfma_f32_16x16x32_bf16 v[8:11], v[120:123], v[80:83], v[8:11]
ds_read_b64_tr_b16 v[102:103], v131 offset:512
ds_read_b128 v[68:71], v128 offset:2048
v_mfma_f32_16x16x32_bf16 v[12:15], v[124:127], v[80:83], v[12:15]
ds_read_b64_tr_b16 v[104:105], v130 offset:8192
ds_read_b64_tr_b16 v[106:107], v130 offset:8704
v_mfma_f32_16x16x32_bf16 v[16:19], v[112:115], v[84:87], v[16:19]
ds_read_b64_tr_b16 v[108:109], v131 offset:8192
v_mfma_f32_16x16x32_bf16 v[20:23], v[116:119], v[84:87], v[20:23]
ds_read_b64_tr_b16 v[110:111], v131 offset:8704
v_mfma_f32_16x16x32_bf16 v[24:27], v[120:123], v[84:87], v[24:27]
ds_read_b128 v[72:75], v128 offset:4096
v_mfma_f32_16x16x32_bf16 v[28:31], v[124:127], v[84:87], v[28:31]
ds_read_b128 v[76:79], v128 offset:6144
v_mfma_f32_16x16x32_bf16 v[32:35], v[112:115], v[88:91], v[32:35]
v_mfma_f32_16x16x32_bf16 v[36:39], v[116:119], v[88:91], v[36:39]
v_mfma_f32_16x16x32_bf16 v[40:43], v[120:123], v[88:91], v[40:43]
v_mfma_f32_16x16x32_bf16 v[44:47], v[124:127], v[88:91], v[44:47]
v_mfma_f32_16x16x32_bf16 v[48:51], v[112:115], v[92:95], v[48:51]
v_mfma_f32_16x16x32_bf16 v[52:55], v[116:119], v[92:95], v[52:55]
v_mfma_f32_16x16x32_bf16 v[56:59], v[120:123], v[92:95], v[56:59]
v_mfma_f32_16x16x32_bf16 v[60:63], v[124:127], v[92:95], v[60:63]
s_cmp_eq_u32 s38, 1
s_cbranch_scc1 Lcs_15
v_mfma_f32_16x16x32_bf16 v[208:211], v[112:115], v[216:219], v[208:211]
v_mfma_f32_16x16x32_bf16 v[212:215], v[116:119], v[216:219], v[212:215]
s_branch Lcj_16
Lcs_15:
v_mfma_f32_16x16x32_bf16 v[208:211], v[120:123], v[216:219], v[208:211]
v_mfma_f32_16x16x32_bf16 v[212:215], v[124:127], v[216:219], v[212:215]
Lcj_16:
s_waitcnt lgkmcnt(0)
v_mfma_f32_16x16x32_bf16 v[0:3], v[96:99], v[64:67], v[0:3]
ds_read_b128 v[80:83], v129 offset:0
ds_read_b64_tr_b16 v[112:113], v130 offset:4096
v_mfma_f32_16x16x32_bf16 v[4:7], v[100:103], v[64:67], v[4:7]
ds_read_b64_tr_b16 v[114:115], v130 offset:4608
ds_read_b64_tr_b16 v[116:117], v131 offset:4096
v_mfma_f32_16x16x32_bf16 v[8:11], v[104:107], v[64:67], v[8:11]
ds_read_b64_tr_b16 v[118:119], v131 offset:4608
ds_read_b128 v[84:87], v129 offset:2048
v_mfma_f32_16x16x32_bf16 v[12:15], v[108:111], v[64:67], v[12:15]
ds_read_b64_tr_b16 v[120:121], v130 offset:12288
ds_read_b64_tr_b16 v[122:123], v130 offset:12800
v_mfma_f32_16x16x32_bf16 v[16:19], v[96:99], v[68:71], v[16:19]
ds_read_b64_tr_b16 v[124:125], v131 offset:12288
v_mfma_f32_16x16x32_bf16 v[20:23], v[100:103], v[68:71], v[20:23]
ds_read_b64_tr_b16 v[126:127], v131 offset:12800
v_mfma_f32_16x16x32_bf16 v[24:27], v[104:107], v[68:71], v[24:27]
ds_read_b128 v[88:91], v129 offset:4096
v_mfma_f32_16x16x32_bf16 v[28:31], v[108:111], v[68:71], v[28:31]
ds_read_b128 v[92:95], v129 offset:6144
v_mfma_f32_16x16x32_bf16 v[32:35], v[96:99], v[72:75], v[32:35]
v_mfma_f32_16x16x32_bf16 v[36:39], v[100:103], v[72:75], v[36:39]
v_mfma_f32_16x16x32_bf16 v[40:43], v[104:107], v[72:75], v[40:43]
v_mfma_f32_16x16x32_bf16 v[44:47], v[108:111], v[72:75], v[44:47]
v_mfma_f32_16x16x32_bf16 v[48:51], v[96:99], v[76:79], v[48:51]
v_mfma_f32_16x16x32_bf16 v[52:55], v[100:103], v[76:79], v[52:55]
v_mfma_f32_16x16x32_bf16 v[56:59], v[104:107], v[76:79], v[56:59]
v_mfma_f32_16x16x32_bf16 v[60:63], v[108:111], v[76:79], v[60:63]
s_cmp_eq_u32 s38, 1
s_cbranch_scc1 Lcs_17
v_mfma_f32_16x16x32_bf16 v[208:211], v[96:99], v[216:219], v[208:211]
v_mfma_f32_16x16x32_bf16 v[212:215], v[100:103], v[216:219], v[212:215]
s_branch Lcj_18
Lcs_17:
v_mfma_f32_16x16x32_bf16 v[208:211], v[104:107], v[216:219], v[208:211]
v_mfma_f32_16x16x32_bf16 v[212:215], v[108:111], v[216:219], v[212:215]
Lcj_18:
s_waitcnt lgkmcnt(0)
s_barrier
v_mfma_f32_16x16x32_bf16 v[0:3], v[112:115], v[80:83], v[0:3]
ds_read_b128 v[64:67], v128 offset:32768
ds_read_b64_tr_b16 v[96:97], v130 offset:32768
v_mfma_f32_16x16x32_bf16 v[4:7], v[116:119], v[80:83], v[4:7]
ds_read_b64_tr_b16 v[98:99], v130 offset:33280
ds_read_b64_tr_b16 v[100:101], v131 offset:32768
v_mfma_f32_16x16x32_bf16 v[8:11], v[120:123], v[80:83], v[8:11]
ds_read_b64_tr_b16 v[102:103], v131 offset:33280
ds_read_b128 v[68:71], v128 offset:34816
v_mfma_f32_16x16x32_bf16 v[12:15], v[124:127], v[80:83], v[12:15]
ds_read_b64_tr_b16 v[104:105], v130 offset:40960
ds_read_b64_tr_b16 v[106:107], v130 offset:41472
v_mfma_f32_16x16x32_bf16 v[16:19], v[112:115], v[84:87], v[16:19]
ds_read_b64_tr_b16 v[108:109], v131 offset:40960
v_mfma_f32_16x16x32_bf16 v[20:23], v[116:119], v[84:87], v[20:23]
ds_read_b64_tr_b16 v[110:111], v131 offset:41472
v_mfma_f32_16x16x32_bf16 v[24:27], v[120:123], v[84:87], v[24:27]
ds_read_b128 v[72:75], v128 offset:36864
v_mfma_f32_16x16x32_bf16 v[28:31], v[124:127], v[84:87], v[28:31]
ds_read_b128 v[76:79], v128 offset:38912
v_mfma_f32_16x16x32_bf16 v[32:35], v[112:115], v[88:91], v[32:35]
v_mfma_f32_16x16x32_bf16 v[36:39], v[116:119], v[88:91], v[36:39]
v_mfma_f32_16x16x32_bf16 v[40:43], v[120:123], v[88:91], v[40:43]
v_mfma_f32_16x16x32_bf16 v[44:47], v[124:127], v[88:91], v[44:47]
v_mfma_f32_16x16x32_bf16 v[48:51], v[112:115], v[92:95], v[48:51]
v_mfma_f32_16x16x32_bf16 v[52:55], v[116:119], v[92:95], v[52:55]
v_mfma_f32_16x16x32_bf16 v[56:59], v[120:123], v[92:95], v[56:59]
v_mfma_f32_16x16x32_bf16 v[60:63], v[124:127], v[92:95], v[60:63]
s_cmp_eq_u32 s38, 1
s_cbranch_scc1 Lcs_19
v_mfma_f32_16x16x32_bf16 v[208:211], v[112:115], v[216:219], v[208:211]
v_mfma_f32_16x16x32_bf16 v[212:215], v[116:119], v[216:219], v[212:215]
s_branch Lcj_20
Lcs_19:
v_mfma_f32_16x16x32_bf16 v[208:211], v[120:123], v[216:219], v[208:211]
v_mfma_f32_16x16x32_bf16 v[212:215], v[124:127], v[216:219], v[212:215]
Lcj_20:
s_waitcnt lgkmcnt(0)
v_mfma_f32_16x16x32_bf16 v[0:3], v[96:99], v[64:67], v[0:3]
ds_read_b128 v[80:83], v129 offset:32768
ds_read_b64_tr_b16 v[112:113], v130 offset:36864
v_mfma_f32_16x16x32_bf16 v[4:7], v[100:103], v[64:67], v[4:7]
ds_read_b64_tr_b16 v[114:115], v130 offset:37376
ds_read_b64_tr_b16 v[116:117], v131 offset:36864
v_mfma_f32_16x16x32_bf16 v[8:11], v[104:107], v[64:67], v[8:11]
ds_read_b64_tr_b16 v[118:119], v131 offset:37376
ds_read_b128 v[84:87], v129 offset:34816
v_mfma_f32_16x16x32_bf16 v[12:15], v[108:111], v[64:67], v[12:15]
ds_read_b64_tr_b16 v[120:121], v130 offset:45056
ds_read_b64_tr_b16 v[122:123], v130 offset:45568
v_mfma_f32_16x16x32_bf16 v[16:19], v[96:99], v[68:71], v[16:19]
ds_read_b64_tr_b16 v[124:125], v131 offset:45056
v_mfma_f32_16x16x32_bf16 v[20:23], v[100:103], v[68:71], v[20:23]
ds_read_b64_tr_b16 v[126:127], v131 offset:45568
v_mfma_f32_16x16x32_bf16 v[24:27], v[104:107], v[68:71], v[24:27]
ds_read_b128 v[88:91], v129 offset:36864
v_mfma_f32_16x16x32_bf16 v[28:31], v[108:111], v[68:71], v[28:31]
ds_read_b128 v[92:95], v129 offset:38912
v_mfma_f32_16x16x32_bf16 v[32:35], v[96:99], v[72:75], v[32:35]
v_mfma_f32_16x16x32_bf16 v[36:39], v[100:103], v[72:75], v[36:39]
v_mfma_f32_16x16x32_bf16 v[40:43], v[104:107], v[72:75], v[40:43]
v_mfma_f32_16x16x32_bf16 v[44:47], v[108:111], v[72:75], v[44:47]
v_mfma_f32_16x16x32_bf16 v[48:51], v[96:99], v[76:79], v[48:51]
v_mfma_f32_16x16x32_bf16 v[52:55], v[100:103], v[76:79], v[52:55]
v_mfma_f32_16x16x32_bf16 v[56:59], v[104:107], v[76:79], v[56:59]
v_mfma_f32_16x16x32_bf16 v[60:63], v[108:111], v[76:79], v[60:63]
s_cmp_eq_u32 s38, 1
s_cbranch_scc1 Lcs_21
v_mfma_f32_16x16x32_bf16 v[208:211], v[96:99], v[216:219], v[208:211]
v_mfma_f32_16x16x32_bf16 v[212:215], v[100:103], v[216:219], v[212:215]
s_branch Lcj_22
Lcs_21:
v_mfma_f32_16x16x32_bf16 v[208:211], v[104:107], v[216:219], v[208:211]
v_mfma_f32_16x16x32_bf16 v[212:215], v[108:111], v[216:219], v[212:215]
Lcj_22:
s_waitcnt lgkmcnt(0)
s_barrier
v_mfma_f32_16x16x32_bf16 v[0:3], v[112:115], v[80:83], v[0:3]
ds_read_b128 v[64:67], v132 offset:0
ds_read_b64_tr_b16 v[96:97], v134 offset:0
v_mfma_f32_16x16x32_bf16 v[4:7], v[116:119], v[80:83], v[4:7]
ds_read_b64_tr_b16 v[98:99], v134 offset:512
ds_read_b64_tr_b16 v[100:101], v135 offset:0
v_mfma_f32_16x16x32_bf16 v[8:11], v[120:123], v[80:83], v[8:11]
ds_read_b64_tr_b16 v[102:103], v135 offset:512
ds_read_b128 v[68:71], v132 offset:2048
v_mfma_f32_16x16x32_bf16 v[12:15], v[124:127], v[80:83], v[12:15]
ds_read_b64_tr_b16 v[104:105], v134 offset:8192
ds_read_b64_tr_b16 v[106:107], v134 offset:8704
v_mfma_f32_16x16x32_bf16 v[16:19], v[112:115], v[84:87], v[16:19]
ds_read_b64_tr_b16 v[108:109], v135 offset:8192
v_mfma_f32_16x16x32_bf16 v[20:23], v[116:119], v[84:87], v[20:23]
ds_read_b64_tr_b16 v[110:111], v135 offset:8704
v_mfma_f32_16x16x32_bf16 v[24:27], v[120:123], v[84:87], v[24:27]
ds_read_b128 v[72:75], v132 offset:4096
v_mfma_f32_16x16x32_bf16 v[28:31], v[124:127], v[84:87], v[28:31]
ds_read_b128 v[76:79], v132 offset:6144
v_mfma_f32_16x16x32_bf16 v[32:35], v[112:115], v[88:91], v[32:35]
v_mfma_f32_16x16x32_bf16 v[36:39], v[116:119], v[88:91], v[36:39]
v_mfma_f32_16x16x32_bf16 v[40:43], v[120:123], v[88:91], v[40:43]
v_mfma_f32_16x16x32_bf16 v[44:47], v[124:127], v[88:91], v[44:47]
v_mfma_f32_16x16x32_bf16 v[48:51], v[112:115], v[92:95], v[48:51]
v_mfma_f32_16x16x32_bf16 v[52:55], v[116:119], v[92:95], v[52:55]
v_mfma_f32_16x16x32_bf16 v[56:59], v[120:123], v[92:95], v[56:59]
v_mfma_f32_16x16x32_bf16 v[60:63], v[124:127], v[92:95], v[60:63]
s_cmp_eq_u32 s38, 1
s_cbranch_scc1 Lcs_23
v_mfma_f32_16x16x32_bf16 v[208:211], v[112:115], v[216:219], v[208:211]
v_mfma_f32_16x16x32_bf16 v[212:215], v[116:119], v[216:219], v[212:215]
s_branch Lcj_24
Lcs_23:
v_mfma_f32_16x16x32_bf16 v[208:211], v[120:123], v[216:219], v[208:211]
v_mfma_f32_16x16x32_bf16 v[212:215], v[124:127], v[216:219], v[212:215]
Lcj_24:
s_waitcnt lgkmcnt(0)
v_mfma_f32_16x16x32_bf16 v[0:3], v[96:99], v[64:67], v[0:3]
ds_read_b128 v[80:83], v133 offset:0
ds_read_b64_tr_b16 v[112:113], v134 offset:4096
v_mfma_f32_16x16x32_bf16 v[4:7], v[100:103], v[64:67], v[4:7]
ds_read_b64_tr_b16 v[114:115], v134 offset:4608
ds_read_b64_tr_b16 v[116:117], v135 offset:4096
v_mfma_f32_16x16x32_bf16 v[8:11], v[104:107], v[64:67], v[8:11]
ds_read_b64_tr_b16 v[118:119], v135 offset:4608
ds_read_b128 v[84:87], v133 offset:2048
v_mfma_f32_16x16x32_bf16 v[12:15], v[108:111], v[64:67], v[12:15]
ds_read_b64_tr_b16 v[120:121], v134 offset:12288
ds_read_b64_tr_b16 v[122:123], v134 offset:12800
v_mfma_f32_16x16x32_bf16 v[16:19], v[96:99], v[68:71], v[16:19]
ds_read_b64_tr_b16 v[124:125], v135 offset:12288
v_mfma_f32_16x16x32_bf16 v[20:23], v[100:103], v[68:71], v[20:23]
ds_read_b64_tr_b16 v[126:127], v135 offset:12800
v_mfma_f32_16x16x32_bf16 v[24:27], v[104:107], v[68:71], v[24:27]
ds_read_b128 v[88:91], v133 offset:4096
v_mfma_f32_16x16x32_bf16 v[28:31], v[108:111], v[68:71], v[28:31]
ds_read_b128 v[92:95], v133 offset:6144
v_mfma_f32_16x16x32_bf16 v[32:35], v[96:99], v[72:75], v[32:35]
v_mfma_f32_16x16x32_bf16 v[36:39], v[100:103], v[72:75], v[36:39]
v_mfma_f32_16x16x32_bf16 v[40:43], v[104:107], v[72:75], v[40:43]
v_mfma_f32_16x16x32_bf16 v[44:47], v[108:111], v[72:75], v[44:47]
v_mfma_f32_16x16x32_bf16 v[48:51], v[96:99], v[76:79], v[48:51]
v_mfma_f32_16x16x32_bf16 v[52:55], v[100:103], v[76:79], v[52:55]
v_mfma_f32_16x16x32_bf16 v[56:59], v[104:107], v[76:79], v[56:59]
v_mfma_f32_16x16x32_bf16 v[60:63], v[108:111], v[76:79], v[60:63]
s_cmp_eq_u32 s38, 1
s_cbranch_scc1 Lcs_25
v_mfma_f32_16x16x32_bf16 v[208:211], v[96:99], v[216:219], v[208:211]
v_mfma_f32_16x16x32_bf16 v[212:215], v[100:103], v[216:219], v[212:215]
s_branch Lcj_26
Lcs_25:
v_mfma_f32_16x16x32_bf16 v[208:211], v[104:107], v[216:219], v[208:211]
v_mfma_f32_16x16x32_bf16 v[212:215], v[108:111], v[216:219], v[212:215]
Lcj_26:
s_waitcnt lgkmcnt(0)
s_barrier
v_mfma_f32_16x16x32_bf16 v[0:3], v[112:115], v[80:83], v[0:3]
ds_read_b128 v[64:67], v132 offset:32768
ds_read_b64_tr_b16 v[96:97], v134 offset:32768
v_mfma_f32_16x16x32_bf16 v[4:7], v[116:119], v[80:83], v[4:7]
ds_read_b64_tr_b16 v[98:99], v134 offset:33280
ds_read_b64_tr_b16 v[100:101], v135 offset:32768
v_mfma_f32_16x16x32_bf16 v[8:11], v[120:123], v[80:83], v[8:11]
ds_read_b64_tr_b16 v[102:103], v135 offset:33280
ds_read_b128 v[68:71], v132 offset:34816
v_mfma_f32_16x16x32_bf16 v[12:15], v[124:127], v[80:83], v[12:15]
ds_read_b64_tr_b16 v[104:105], v134 offset:40960
ds_read_b64_tr_b16 v[106:107], v134 offset:41472
v_mfma_f32_16x16x32_bf16 v[16:19], v[112:115], v[84:87], v[16:19]
ds_read_b64_tr_b16 v[108:109], v135 offset:40960
v_mfma_f32_16x16x32_bf16 v[20:23], v[116:119], v[84:87], v[20:23]
ds_read_b64_tr_b16 v[110:111], v135 offset:41472
v_mfma_f32_16x16x32_bf16 v[24:27], v[120:123], v[84:87], v[24:27]
ds_read_b128 v[72:75], v132 offset:36864
v_mfma_f32_16x16x32_bf16 v[28:31], v[124:127], v[84:87], v[28:31]
ds_read_b128 v[76:79], v132 offset:38912
v_mfma_f32_16x16x32_bf16 v[32:35], v[112:115], v[88:91], v[32:35]
v_mfma_f32_16x16x32_bf16 v[36:39], v[116:119], v[88:91], v[36:39]
v_mfma_f32_16x16x32_bf16 v[40:43], v[120:123], v[88:91], v[40:43]
v_mfma_f32_16x16x32_bf16 v[44:47], v[124:127], v[88:91], v[44:47]
v_mfma_f32_16x16x32_bf16 v[48:51], v[112:115], v[92:95], v[48:51]
v_mfma_f32_16x16x32_bf16 v[52:55], v[116:119], v[92:95], v[52:55]
v_mfma_f32_16x16x32_bf16 v[56:59], v[120:123], v[92:95], v[56:59]
v_mfma_f32_16x16x32_bf16 v[60:63], v[124:127], v[92:95], v[60:63]
s_cmp_eq_u32 s38, 1
s_cbranch_scc1 Lcs_27
v_mfma_f32_16x16x32_bf16 v[208:211], v[112:115], v[216:219], v[208:211]
v_mfma_f32_16x16x32_bf16 v[212:215], v[116:119], v[216:219], v[212:215]
s_branch Lcj_28
Lcs_27:
v_mfma_f32_16x16x32_bf16 v[208:211], v[120:123], v[216:219], v[208:211]
v_mfma_f32_16x16x32_bf16 v[212:215], v[124:127], v[216:219], v[212:215]
Lcj_28:
s_waitcnt lgkmcnt(0)
v_mfma_f32_16x16x32_bf16 v[0:3], v[96:99], v[64:67], v[0:3]
ds_read_b128 v[80:83], v133 offset:32768
ds_read_b64_tr_b16 v[112:113], v134 offset:36864
v_mfma_f32_16x16x32_bf16 v[4:7], v[100:103], v[64:67], v[4:7]
ds_read_b64_tr_b16 v[114:115], v134 offset:37376
ds_read_b64_tr_b16 v[116:117], v135 offset:36864
v_mfma_f32_16x16x32_bf16 v[8:11], v[104:107], v[64:67], v[8:11]
ds_read_b64_tr_b16 v[118:119], v135 offset:37376
ds_read_b128 v[84:87], v133 offset:34816
v_mfma_f32_16x16x32_bf16 v[12:15], v[108:111], v[64:67], v[12:15]
ds_read_b64_tr_b16 v[120:121], v134 offset:45056
ds_read_b64_tr_b16 v[122:123], v134 offset:45568
v_mfma_f32_16x16x32_bf16 v[16:19], v[96:99], v[68:71], v[16:19]
ds_read_b64_tr_b16 v[124:125], v135 offset:45056
v_mfma_f32_16x16x32_bf16 v[20:23], v[100:103], v[68:71], v[20:23]
ds_read_b64_tr_b16 v[126:127], v135 offset:45568
v_mfma_f32_16x16x32_bf16 v[24:27], v[104:107], v[68:71], v[24:27]
ds_read_b128 v[88:91], v133 offset:36864
v_mfma_f32_16x16x32_bf16 v[28:31], v[108:111], v[68:71], v[28:31]
ds_read_b128 v[92:95], v133 offset:38912
v_mfma_f32_16x16x32_bf16 v[32:35], v[96:99], v[72:75], v[32:35]
v_mfma_f32_16x16x32_bf16 v[36:39], v[100:103], v[72:75], v[36:39]
v_mfma_f32_16x16x32_bf16 v[40:43], v[104:107], v[72:75], v[40:43]
v_mfma_f32_16x16x32_bf16 v[44:47], v[108:111], v[72:75], v[44:47]
v_mfma_f32_16x16x32_bf16 v[48:51], v[96:99], v[76:79], v[48:51]
v_mfma_f32_16x16x32_bf16 v[52:55], v[100:103], v[76:79], v[52:55]
v_mfma_f32_16x16x32_bf16 v[56:59], v[104:107], v[76:79], v[56:59]
v_mfma_f32_16x16x32_bf16 v[60:63], v[108:111], v[76:79], v[60:63]
s_cmp_eq_u32 s38, 1
s_cbranch_scc1 Lcs_29
v_mfma_f32_16x16x32_bf16 v[208:211], v[96:99], v[216:219], v[208:211]
v_mfma_f32_16x16x32_bf16 v[212:215], v[100:103], v[216:219], v[212:215]
s_branch Lcj_30
Lcs_29:
v_mfma_f32_16x16x32_bf16 v[208:211], v[104:107], v[216:219], v[208:211]
v_mfma_f32_16x16x32_bf16 v[212:215], v[108:111], v[216:219], v[212:215]
Lcj_30:
s_waitcnt lgkmcnt(0)
s_barrier
v_mfma_f32_16x16x32_bf16 v[0:3], v[112:115], v[80:83], v[0:3]
ds_read_b128 v[64:67], v128 offset:0
ds_read_b64_tr_b16 v[96:97], v130 offset:0
v_mfma_f32_16x16x32_bf16 v[4:7], v[116:119], v[80:83], v[4:7]
ds_read_b64_tr_b16 v[98:99], v130 offset:512
ds_read_b64_tr_b16 v[100:101], v131 offset:0
v_mfma_f32_16x16x32_bf16 v[8:11], v[120:123], v[80:83], v[8:11]
ds_read_b64_tr_b16 v[102:103], v131 offset:512
ds_read_b128 v[68:71], v128 offset:2048
v_mfma_f32_16x16x32_bf16 v[12:15], v[124:127], v[80:83], v[12:15]
ds_read_b64_tr_b16 v[104:105], v130 offset:8192
ds_read_b64_tr_b16 v[106:107], v130 offset:8704
v_mfma_f32_16x16x32_bf16 v[16:19], v[112:115], v[84:87], v[16:19]
ds_read_b64_tr_b16 v[108:109], v131 offset:8192
v_mfma_f32_16x16x32_bf16 v[20:23], v[116:119], v[84:87], v[20:23]
ds_read_b64_tr_b16 v[110:111], v131 offset:8704
v_mfma_f32_16x16x32_bf16 v[24:27], v[120:123], v[84:87], v[24:27]
ds_read_b128 v[72:75], v128 offset:4096
v_mfma_f32_16x16x32_bf16 v[28:31], v[124:127], v[84:87], v[28:31]
ds_read_b128 v[76:79], v128 offset:6144
v_mfma_f32_16x16x32_bf16 v[32:35], v[112:115], v[88:91], v[32:35]
v_mfma_f32_16x16x32_bf16 v[36:39], v[116:119], v[88:91], v[36:39]
v_mfma_f32_16x16x32_bf16 v[40:43], v[120:123], v[88:91], v[40:43]
v_mfma_f32_16x16x32_bf16 v[44:47], v[124:127], v[88:91], v[44:47]
v_mfma_f32_16x16x32_bf16 v[48:51], v[112:115], v[92:95], v[48:51]
v_mfma_f32_16x16x32_bf16 v[52:55], v[116:119], v[92:95], v[52:55]
v_mfma_f32_16x16x32_bf16 v[56:59], v[120:123], v[92:95], v[56:59]
v_mfma_f32_16x16x32_bf16 v[60:63], v[124:127], v[92:95], v[60:63]
s_cmp_eq_u32 s38, 1
s_cbranch_scc1 Lcs_31
v_mfma_f32_16x16x32_bf16 v[208:211], v[112:115], v[216:219], v[208:211]
v_mfma_f32_16x16x32_bf16 v[212:215], v[116:119], v[216:219], v[212:215]
s_branch Lcj_32
Lcs_31:
v_mfma_f32_16x16x32_bf16 v[208:211], v[120:123], v[216:219], v[208:211]
v_mfma_f32_16x16x32_bf16 v[212:215], v[124:127], v[216:219], v[212:215]
Lcj_32:
s_waitcnt lgkmcnt(0)
v_mfma_f32_16x16x32_bf16 v[0:3], v[96:99], v[64:67], v[0:3]
ds_read_b128 v[80:83], v129 offset:0
ds_read_b64_tr_b16 v[112:113], v130 offset:4096
v_mfma_f32_16x16x32_bf16 v[4:7], v[100:103], v[64:67], v[4:7]
ds_read_b64_tr_b16 v[114:115], v130 offset:4608
ds_read_b64_tr_b16 v[116:117], v131 offset:4096
v_mfma_f32_16x16x32_bf16 v[8:11], v[104:107], v[64:67], v[8:11]
ds_read_b64_tr_b16 v[118:119], v131 offset:4608
ds_read_b128 v[84:87], v129 offset:2048
v_mfma_f32_16x16x32_bf16 v[12:15], v[108:111], v[64:67], v[12:15]
ds_read_b64_tr_b16 v[120:121], v130 offset:12288
ds_read_b64_tr_b16 v[122:123], v130 offset:12800
v_mfma_f32_16x16x32_bf16 v[16:19], v[96:99], v[68:71], v[16:19]
ds_read_b64_tr_b16 v[124:125], v131 offset:12288
v_mfma_f32_16x16x32_bf16 v[20:23], v[100:103], v[68:71], v[20:23]
ds_read_b64_tr_b16 v[126:127], v131 offset:12800
v_mfma_f32_16x16x32_bf16 v[24:27], v[104:107], v[68:71], v[24:27]
ds_read_b128 v[88:91], v129 offset:4096
v_mfma_f32_16x16x32_bf16 v[28:31], v[108:111], v[68:71], v[28:31]
ds_read_b128 v[92:95], v129 offset:6144
v_mfma_f32_16x16x32_bf16 v[32:35], v[96:99], v[72:75], v[32:35]
v_mfma_f32_16x16x32_bf16 v[36:39], v[100:103], v[72:75], v[36:39]
v_mfma_f32_16x16x32_bf16 v[40:43], v[104:107], v[72:75], v[40:43]
v_mfma_f32_16x16x32_bf16 v[44:47], v[108:111], v[72:75], v[44:47]
v_mfma_f32_16x16x32_bf16 v[48:51], v[96:99], v[76:79], v[48:51]
v_mfma_f32_16x16x32_bf16 v[52:55], v[100:103], v[76:79], v[52:55]
v_mfma_f32_16x16x32_bf16 v[56:59], v[104:107], v[76:79], v[56:59]
v_mfma_f32_16x16x32_bf16 v[60:63], v[108:111], v[76:79], v[60:63]
s_cmp_eq_u32 s38, 1
s_cbranch_scc1 Lcs_33
v_mfma_f32_16x16x32_bf16 v[208:211], v[96:99], v[216:219], v[208:211]
v_mfma_f32_16x16x32_bf16 v[212:215], v[100:103], v[216:219], v[212:215]
s_branch Lcj_34
Lcs_33:
v_mfma_f32_16x16x32_bf16 v[208:211], v[104:107], v[216:219], v[208:211]
v_mfma_f32_16x16x32_bf16 v[212:215], v[108:111], v[216:219], v[212:215]
Lcj_34:
s_waitcnt lgkmcnt(0)
s_barrier
v_mfma_f32_16x16x32_bf16 v[0:3], v[112:115], v[80:83], v[0:3]
ds_read_b128 v[64:67], v128 offset:32768
ds_read_b64_tr_b16 v[96:97], v130 offset:32768
v_mfma_f32_16x16x32_bf16 v[4:7], v[116:119], v[80:83], v[4:7]
ds_read_b64_tr_b16 v[98:99], v130 offset:33280
ds_read_b64_tr_b16 v[100:101], v131 offset:32768
v_mfma_f32_16x16x32_bf16 v[8:11], v[120:123], v[80:83], v[8:11]
ds_read_b64_tr_b16 v[102:103], v131 offset:33280
ds_read_b128 v[68:71], v128 offset:34816
v_mfma_f32_16x16x32_bf16 v[12:15], v[124:127], v[80:83], v[12:15]
ds_read_b64_tr_b16 v[104:105], v130 offset:40960
ds_read_b64_tr_b16 v[106:107], v130 offset:41472
v_mfma_f32_16x16x32_bf16 v[16:19], v[112:115], v[84:87], v[16:19]
ds_read_b64_tr_b16 v[108:109], v131 offset:40960
v_mfma_f32_16x16x32_bf16 v[20:23], v[116:119], v[84:87], v[20:23]
ds_read_b64_tr_b16 v[110:111], v131 offset:41472
v_mfma_f32_16x16x32_bf16 v[24:27], v[120:123], v[84:87], v[24:27]
ds_read_b128 v[72:75], v128 offset:36864
v_mfma_f32_16x16x32_bf16 v[28:31], v[124:127], v[84:87], v[28:31]
ds_read_b128 v[76:79], v128 offset:38912
v_mfma_f32_16x16x32_bf16 v[32:35], v[112:115], v[88:91], v[32:35]
v_mfma_f32_16x16x32_bf16 v[36:39], v[116:119], v[88:91], v[36:39]
v_mfma_f32_16x16x32_bf16 v[40:43], v[120:123], v[88:91], v[40:43]
v_mfma_f32_16x16x32_bf16 v[44:47], v[124:127], v[88:91], v[44:47]
v_mfma_f32_16x16x32_bf16 v[48:51], v[112:115], v[92:95], v[48:51]
v_mfma_f32_16x16x32_bf16 v[52:55], v[116:119], v[92:95], v[52:55]
v_mfma_f32_16x16x32_bf16 v[56:59], v[120:123], v[92:95], v[56:59]
v_mfma_f32_16x16x32_bf16 v[60:63], v[124:127], v[92:95], v[60:63]
s_cmp_eq_u32 s38, 1
s_cbranch_scc1 Lcs_35
v_mfma_f32_16x16x32_bf16 v[208:211], v[112:115], v[216:219], v[208:211]
v_mfma_f32_16x16x32_bf16 v[212:215], v[116:119], v[216:219], v[212:215]
s_branch Lcj_36
Lcs_35:
v_mfma_f32_16x16x32_bf16 v[208:211], v[120:123], v[216:219], v[208:211]
v_mfma_f32_16x16x32_bf16 v[212:215], v[124:127], v[216:219], v[212:215]
Lcj_36:
s_waitcnt lgkmcnt(0)
v_mfma_f32_16x16x32_bf16 v[0:3], v[96:99], v[64:67], v[0:3]
ds_read_b128 v[80:83], v129 offset:32768
ds_read_b64_tr_b16 v[112:113], v130 offset:36864
v_mfma_f32_16x16x32_bf16 v[4:7], v[100:103], v[64:67], v[4:7]
ds_read_b64_tr_b16 v[114:115], v130 offset:37376
ds_read_b64_tr_b16 v[116:117], v131 offset:36864
v_mfma_f32_16x16x32_bf16 v[8:11], v[104:107], v[64:67], v[8:11]
ds_read_b64_tr_b16 v[118:119], v131 offset:37376
ds_read_b128 v[84:87], v129 offset:34816
v_mfma_f32_16x16x32_bf16 v[12:15], v[108:111], v[64:67], v[12:15]
ds_read_b64_tr_b16 v[120:121], v130 offset:45056
ds_read_b64_tr_b16 v[122:123], v130 offset:45568
v_mfma_f32_16x16x32_bf16 v[16:19], v[96:99], v[68:71], v[16:19]
ds_read_b64_tr_b16 v[124:125], v131 offset:45056
v_mfma_f32_16x16x32_bf16 v[20:23], v[100:103], v[68:71], v[20:23]
ds_read_b64_tr_b16 v[126:127], v131 offset:45568
v_mfma_f32_16x16x32_bf16 v[24:27], v[104:107], v[68:71], v[24:27]
ds_read_b128 v[88:91], v129 offset:36864
v_mfma_f32_16x16x32_bf16 v[28:31], v[108:111], v[68:71], v[28:31]
ds_read_b128 v[92:95], v129 offset:38912
v_mfma_f32_16x16x32_bf16 v[32:35], v[96:99], v[72:75], v[32:35]
v_mfma_f32_16x16x32_bf16 v[36:39], v[100:103], v[72:75], v[36:39]
v_mfma_f32_16x16x32_bf16 v[40:43], v[104:107], v[72:75], v[40:43]
v_mfma_f32_16x16x32_bf16 v[44:47], v[108:111], v[72:75], v[44:47]
v_mfma_f32_16x16x32_bf16 v[48:51], v[96:99], v[76:79], v[48:51]
v_mfma_f32_16x16x32_bf16 v[52:55], v[100:103], v[76:79], v[52:55]
v_mfma_f32_16x16x32_bf16 v[56:59], v[104:107], v[76:79], v[56:59]
v_mfma_f32_16x16x32_bf16 v[60:63], v[108:111], v[76:79], v[60:63]
s_cmp_eq_u32 s38, 1
s_cbranch_scc1 Lcs_37
v_mfma_f32_16x16x32_bf16 v[208:211], v[96:99], v[216:219], v[208:211]
v_mfma_f32_16x16x32_bf16 v[212:215], v[100:103], v[216:219], v[212:215]
s_branch Lcj_38
Lcs_37:
v_mfma_f32_16x16x32_bf16 v[208:211], v[104:107], v[216:219], v[208:211]
v_mfma_f32_16x16x32_bf16 v[212:215], v[108:111], v[216:219], v[212:215]
Lcj_38:
s_waitcnt lgkmcnt(0)
v_mfma_f32_16x16x32_bf16 v[0:3], v[112:115], v[80:83], v[0:3]
v_mfma_f32_16x16x32_bf16 v[4:7], v[116:119], v[80:83], v[4:7]
v_mfma_f32_16x16x32_bf16 v[8:11], v[120:123], v[80:83], v[8:11]
v_mfma_f32_16x16x32_bf16 v[12:15], v[124:127], v[80:83], v[12:15]
v_mfma_f32_16x16x32_bf16 v[16:19], v[112:115], v[84:87], v[16:19]
v_mfma_f32_16x16x32_bf16 v[20:23], v[116:119], v[84:87], v[20:23]
v_mfma_f32_16x16x32_bf16 v[24:27], v[120:123], v[84:87], v[24:27]
v_mfma_f32_16x16x32_bf16 v[28:31], v[124:127], v[84:87], v[28:31]
v_mfma_f32_16x16x32_bf16 v[32:35], v[112:115], v[88:91], v[32:35]
v_mfma_f32_16x16x32_bf16 v[36:39], v[116:119], v[88:91], v[36:39]
v_mfma_f32_16x16x32_bf16 v[40:43], v[120:123], v[88:91], v[40:43]
v_mfma_f32_16x16x32_bf16 v[44:47], v[124:127], v[88:91], v[44:47]
v_mfma_f32_16x16x32_bf16 v[48:51], v[112:115], v[92:95], v[48:51]
v_mfma_f32_16x16x32_bf16 v[52:55], v[116:119], v[92:95], v[52:55]
v_mfma_f32_16x16x32_bf16 v[56:59], v[120:123], v[92:95], v[56:59]
v_mfma_f32_16x16x32_bf16 v[60:63], v[124:127], v[92:95], v[60:63]
s_cmp_eq_u32 s38, 1
s_cbranch_scc1 Lcs_39
v_mfma_f32_16x16x32_bf16 v[208:211], v[112:115], v[216:219], v[208:211]
v_mfma_f32_16x16x32_bf16 v[212:215], v[116:119], v[216:219], v[212:215]
s_branch Lcj_40
Lcs_39:
v_mfma_f32_16x16x32_bf16 v[208:211], v[120:123], v[216:219], v[208:211]
v_mfma_f32_16x16x32_bf16 v[212:215], v[124:127], v[216:219], v[212:215]
Lcj_40:
s_lshl_b32 s20, s38, 8
s_lshl_b32 s21, s39, 7
s_add_u32 s20, s20, s21
s_add_u32 s20, s20, 148480
v_lshl_add_u32 v230, v247, 4, s20
s_mov_b32 s22, 0x00010001
s_mov_b32 s23, 0x00010001
s_mov_b64 exec, s[22:23]
s_nop 2
ds_write_b128 v230, v[208:211]
ds_write_b128 v230, v[212:215] offset:64
s_mov_b64 exec, -1
s_waitcnt lgkmcnt(0)
s_barrier
s_lshl_b32 s20, s38, 6
v_add_u32 v228, s20, v246
v_lshlrev_b32 v229, 3, v228
v_add_u32 v229, 147456, v229
ds_read_b64 v[136:137], v229 offset:0
ds_read_b64 v[138:139], v229 offset:128
ds_read_b64 v[140:141], v229 offset:256
ds_read_b64 v[142:143], v229 offset:384
v_lshlrev_b32 v230, 4, v247
s_lshl_b32 s20, s39, 7
s_add_u32 s20, s20, 148480
v_add_u32 v230, s20, v230
ds_read_b128 v[64:67], v230 offset:0
ds_read_b128 v[68:71], v230 offset:64
ds_read_b128 v[220:223], v230 offset:256
ds_read_b128 v[224:227], v230 offset:320
v_mov_b32 v100, 0xbdd2d3e8
v_mov_b32 v101, 0xc0135761
v_mov_b32 v102, 1.0
v_mov_b32 v103, 1.0
v_mov_b32 v104, 0x3f803f80
v_mov_b32 v84, 0
v_mov_b32 v85, 0
v_mov_b32 v86, 0
v_mov_b32 v87, 0
v_mov_b32 v88, 0
v_mov_b32 v89, 0
v_mov_b32 v90, 0
v_mov_b32 v91, 0
v_lshrrev_b32 v234, 3, v246
v_lshlrev_b32 v234, 2, v234
v_and_b32 v235, 7, v246
v_xor_b32 v234, v234, v235
s_lshl_b32 s20, s39, 2
v_or_b32 v233, s20, v253
v_xor_b32 v234, v234, v233
v_lshlrev_b32 v234, 4, v234
v_lshl_add_u32 v231, v228, 7, v234
v_add_u32 v231, 131072, v231
s_cmp_lt_u32 s33, 13
s_cselect_b32 s20, 0x10000000, 0
s_mov_b32 s16, s84
s_mov_b32 s17, s85
s_mov_b32 s18, s20
s_mov_b32 s19, 0x20000
s_waitcnt lgkmcnt(0)
v_pk_mul_f32 v[92:93], v[64:65], v[136:137] op_sel:[0,1] op_sel_hi:[1,1]
v_pk_mul_f32 v[94:95], v[66:67], v[136:137] op_sel:[0,1] op_sel_hi:[1,1]
v_pk_fma_f32 v[0:1], v[0:1], v[136:137], v[92:93] op_sel:[0,0,0] op_sel_hi:[1,0,1]
v_pk_fma_f32 v[2:3], v[2:3], v[136:137], v[94:95] op_sel:[0,0,0] op_sel_hi:[1,0,1]
v_pk_mul_f32 v[92:93], v[68:69], v[136:137] op_sel:[0,1] op_sel_hi:[1,1]
v_pk_mul_f32 v[94:95], v[70:71], v[136:137] op_sel:[0,1] op_sel_hi:[1,1]
v_pk_fma_f32 v[4:5], v[4:5], v[136:137], v[92:93] op_sel:[0,0,0] op_sel_hi:[1,0,1]
v_pk_fma_f32 v[6:7], v[6:7], v[136:137], v[94:95] op_sel:[0,0,0] op_sel_hi:[1,0,1]
v_pk_mul_f32 v[92:93], v[64:65], v[138:139] op_sel:[0,1] op_sel_hi:[1,1]
v_pk_mul_f32 v[94:95], v[66:67], v[138:139] op_sel:[0,1] op_sel_hi:[1,1]
v_pk_fma_f32 v[16:17], v[16:17], v[138:139], v[92:93] op_sel:[0,0,0] op_sel_hi:[1,0,1]
v_pk_fma_f32 v[18:19], v[18:19], v[138:139], v[94:95] op_sel:[0,0,0] op_sel_hi:[1,0,1]
v_pk_mul_f32 v[92:93], v[68:69], v[138:139] op_sel:[0,1] op_sel_hi:[1,1]
v_pk_mul_f32 v[94:95], v[70:71], v[138:139] op_sel:[0,1] op_sel_hi:[1,1]
v_pk_fma_f32 v[20:21], v[20:21], v[138:139], v[92:93] op_sel:[0,0,0] op_sel_hi:[1,0,1]
v_pk_fma_f32 v[22:23], v[22:23], v[138:139], v[94:95] op_sel:[0,0,0] op_sel_hi:[1,0,1]
v_pk_mul_f32 v[92:93], v[64:65], v[140:141] op_sel:[0,1] op_sel_hi:[1,1]
v_pk_mul_f32 v[94:95], v[66:67], v[140:141] op_sel:[0,1] op_sel_hi:[1,1]
v_pk_fma_f32 v[32:33], v[32:33], v[140:141], v[92:93] op_sel:[0,0,0] op_sel_hi:[1,0,1]
v_pk_fma_f32 v[34:35], v[34:35], v[140:141], v[94:95] op_sel:[0,0,0] op_sel_hi:[1,0,1]
v_pk_mul_f32 v[92:93], v[68:69], v[140:141] op_sel:[0,1] op_sel_hi:[1,1]
v_pk_mul_f32 v[94:95], v[70:71], v[140:141] op_sel:[0,1] op_sel_hi:[1,1]
v_pk_fma_f32 v[36:37], v[36:37], v[140:141], v[92:93] op_sel:[0,0,0] op_sel_hi:[1,0,1]
v_pk_fma_f32 v[38:39], v[38:39], v[140:141], v[94:95] op_sel:[0,0,0] op_sel_hi:[1,0,1]
v_pk_mul_f32 v[92:93], v[64:65], v[142:143] op_sel:[0,1] op_sel_hi:[1,1]
v_pk_mul_f32 v[94:95], v[66:67], v[142:143] op_sel:[0,1] op_sel_hi:[1,1]
v_pk_fma_f32 v[48:49], v[48:49], v[142:143], v[92:93] op_sel:[0,0,0] op_sel_hi:[1,0,1]
v_pk_fma_f32 v[50:51], v[50:51], v[142:143], v[94:95] op_sel:[0,0,0] op_sel_hi:[1,0,1]
v_pk_mul_f32 v[92:93], v[68:69], v[142:143] op_sel:[0,1] op_sel_hi:[1,1]
v_pk_mul_f32 v[94:95], v[70:71], v[142:143] op_sel:[0,1] op_sel_hi:[1,1]
v_pk_fma_f32 v[52:53], v[52:53], v[142:143], v[92:93] op_sel:[0,0,0] op_sel_hi:[1,0,1]
v_pk_fma_f32 v[54:55], v[54:55], v[142:143], v[94:95] op_sel:[0,0,0] op_sel_hi:[1,0,1]
s_add_u32 s20, s33, s39
s_cmp_lg_u32 s20, 0
s_cbranch_scc1 La_z_41
v_add_u32 v96, 26624, v251
v_cvt_pk_bf16_f32 v72, v0, v1
v_cvt_pk_bf16_f32 v73, v2, v3
v_cvt_pk_bf16_f32 v74, v4, v5
v_cvt_pk_bf16_f32 v75, v6, v7
s_nop 1
v_permlane16_swap_b32 v72, v74
v_permlane16_swap_b32 v73, v75
s_mov_b32 s20, 0
buffer_store_dwordx4 v[72:75], v96, s[16:19], s20 offen sc1
v_cvt_pk_bf16_f32 v76, v16, v17
v_cvt_pk_bf16_f32 v77, v18, v19
v_cvt_pk_bf16_f32 v78, v20, v21
v_cvt_pk_bf16_f32 v79, v22, v23
s_nop 1
v_permlane16_swap_b32 v76, v78
v_permlane16_swap_b32 v77, v79
s_mov_b32 s20, 28672
buffer_store_dwordx4 v[76:79], v96, s[16:19], s20 offen sc1
v_cvt_pk_bf16_f32 v80, v32, v33
v_cvt_pk_bf16_f32 v81, v34, v35
v_cvt_pk_bf16_f32 v82, v36, v37
v_cvt_pk_bf16_f32 v83, v38, v39
s_nop 1
v_permlane16_swap_b32 v80, v82
v_permlane16_swap_b32 v81, v83
s_mov_b32 s20, 57344
buffer_store_dwordx4 v[80:83], v96, s[16:19], s20 offen sc1
v_cvt_pk_bf16_f32 v84, v48, v49
v_cvt_pk_bf16_f32 v85, v50, v51
v_cvt_pk_bf16_f32 v86, v52, v53
v_cvt_pk_bf16_f32 v87, v54, v55
s_nop 1
v_permlane16_swap_b32 v84, v86
v_permlane16_swap_b32 v85, v87
s_mov_b32 s20, 86016
buffer_store_dwordx4 v[84:87], v96, s[16:19], s20 offen sc1
s_nop 1
v_mov_b32 v84, 0
v_mov_b32 v85, 0
v_mov_b32 v86, 0
v_mov_b32 v87, 0
v_mov_b32 v88, 0
v_mov_b32 v89, 0
v_mov_b32 v90, 0
v_mov_b32 v91, 0
s_branch La_n_42
La_z_41:
v_pk_mul_f32 v[92:93], v[0:1], v[0:1]
v_pk_mul_f32 v[94:95], v[2:3], v[2:3]
v_pk_fma_f32 v[92:93], v[92:93], v[100:101], v[100:101] op_sel:[0,0,1] op_sel_hi:[1,0,1]
v_pk_fma_f32 v[94:95], v[94:95], v[100:101], v[100:101] op_sel:[0,0,1] op_sel_hi:[1,0,1]
v_pk_mul_f32 v[92:93], v[92:93], v[0:1]
v_pk_mul_f32 v[94:95], v[94:95], v[2:3]
v_exp_f32 v92, v92
v_exp_f32 v93, v93
v_exp_f32 v94, v94
v_exp_f32 v95, v95
s_nop 0
v_pk_add_f32 v[92:93], v[92:93], v[102:103]
v_pk_add_f32 v[94:95], v[94:95], v[102:103]
v_rcp_f32 v92, v92
v_rcp_f32 v93, v93
v_rcp_f32 v94, v94
v_rcp_f32 v95, v95
s_nop 0
v_pk_mul_f32 v[92:93], v[92:93], v[0:1]
v_pk_mul_f32 v[94:95], v[94:95], v[2:3]
v_cvt_pk_bf16_f32 v80, v92, v93
v_cvt_pk_bf16_f32 v81, v94, v95
v_pk_mul_f32 v[92:93], v[4:5], v[4:5]
v_pk_mul_f32 v[94:95], v[6:7], v[6:7]
v_pk_fma_f32 v[92:93], v[92:93], v[100:101], v[100:101] op_sel:[0,0,1] op_sel_hi:[1,0,1]
v_pk_fma_f32 v[94:95], v[94:95], v[100:101], v[100:101] op_sel:[0,0,1] op_sel_hi:[1,0,1]
v_pk_mul_f32 v[92:93], v[92:93], v[4:5]
v_pk_mul_f32 v[94:95], v[94:95], v[6:7]
v_exp_f32 v92, v92
v_exp_f32 v93, v93
v_exp_f32 v94, v94
v_exp_f32 v95, v95
s_nop 0
v_pk_add_f32 v[92:93], v[92:93], v[102:103]
v_pk_add_f32 v[94:95], v[94:95], v[102:103]
v_rcp_f32 v92, v92
v_rcp_f32 v93, v93
v_rcp_f32 v94, v94
v_rcp_f32 v95, v95
s_nop 0
v_pk_mul_f32 v[92:93], v[92:93], v[4:5]
v_pk_mul_f32 v[94:95], v[94:95], v[6:7]
v_cvt_pk_bf16_f32 v82, v92, v93
v_cvt_pk_bf16_f32 v83, v94, v95
v_dot2c_f32_bf16 v84, v80, v104
v_dot2c_f32_bf16 v85, v80, v80
v_dot2c_f32_bf16 v84, v81, v104
v_dot2c_f32_bf16 v85, v81, v81
v_dot2c_f32_bf16 v84, v82, v104
v_dot2c_f32_bf16 v85, v82, v82
v_dot2c_f32_bf16 v84, v83, v104
v_dot2c_f32_bf16 v85, v83, v83
v_permlane16_swap_b32 v80, v82
v_permlane16_swap_b32 v81, v83
ds_write_b128 v231, v[80:83] offset:0
v_pk_mul_f32 v[92:93], v[16:17], v[16:17]
v_pk_mul_f32 v[94:95], v[18:19], v[18:19]
v_pk_fma_f32 v[92:93], v[92:93], v[100:101], v[100:101] op_sel:[0,0,1] op_sel_hi:[1,0,1]
v_pk_fma_f32 v[94:95], v[94:95], v[100:101], v[100:101] op_sel:[0,0,1] op_sel_hi:[1,0,1]
v_pk_mul_f32 v[92:93], v[92:93], v[16:17]
v_pk_mul_f32 v[94:95], v[94:95], v[18:19]
v_exp_f32 v92, v92
v_exp_f32 v93, v93
v_exp_f32 v94, v94
v_exp_f32 v95, v95
s_nop 0
v_pk_add_f32 v[92:93], v[92:93], v[102:103]
v_pk_add_f32 v[94:95], v[94:95], v[102:103]
v_rcp_f32 v92, v92
v_rcp_f32 v93, v93
v_rcp_f32 v94, v94
v_rcp_f32 v95, v95
s_nop 0
v_pk_mul_f32 v[92:93], v[92:93], v[16:17]
v_pk_mul_f32 v[94:95], v[94:95], v[18:19]
v_cvt_pk_bf16_f32 v80, v92, v93
v_cvt_pk_bf16_f32 v81, v94, v95
v_pk_mul_f32 v[92:93], v[20:21], v[20:21]
v_pk_mul_f32 v[94:95], v[22:23], v[22:23]
v_pk_fma_f32 v[92:93], v[92:93], v[100:101], v[100:101] op_sel:[0,0,1] op_sel_hi:[1,0,1]
v_pk_fma_f32 v[94:95], v[94:95], v[100:101], v[100:101] op_sel:[0,0,1] op_sel_hi:[1,0,1]
v_pk_mul_f32 v[92:93], v[92:93], v[20:21]
v_pk_mul_f32 v[94:95], v[94:95], v[22:23]
v_exp_f32 v92, v92
v_exp_f32 v93, v93
v_exp_f32 v94, v94
v_exp_f32 v95, v95
s_nop 0
v_pk_add_f32 v[92:93], v[92:93], v[102:103]
v_pk_add_f32 v[94:95], v[94:95], v[102:103]
v_rcp_f32 v92, v92
v_rcp_f32 v93, v93
v_rcp_f32 v94, v94
v_rcp_f32 v95, v95
s_nop 0
v_pk_mul_f32 v[92:93], v[92:93], v[20:21]
v_pk_mul_f32 v[94:95], v[94:95], v[22:23]
v_cvt_pk_bf16_f32 v82, v92, v93
v_cvt_pk_bf16_f32 v83, v94, v95
v_dot2c_f32_bf16 v86, v80, v104
v_dot2c_f32_bf16 v87, v80, v80
v_dot2c_f32_bf16 v86, v81, v104
v_dot2c_f32_bf16 v87, v81, v81
v_dot2c_f32_bf16 v86, v82, v104
v_dot2c_f32_bf16 v87, v82, v82
v_dot2c_f32_bf16 v86, v83, v104
v_dot2c_f32_bf16 v87, v83, v83
v_permlane16_swap_b32 v80, v82
v_permlane16_swap_b32 v81, v83
ds_write_b128 v231, v[80:83] offset:2048
v_pk_mul_f32 v[92:93], v[32:33], v[32:33]
v_pk_mul_f32 v[94:95], v[34:35], v[34:35]
v_pk_fma_f32 v[92:93], v[92:93], v[100:101], v[100:101] op_sel:[0,0,1] op_sel_hi:[1,0,1]
v_pk_fma_f32 v[94:95], v[94:95], v[100:101], v[100:101] op_sel:[0,0,1] op_sel_hi:[1,0,1]
v_pk_mul_f32 v[92:93], v[92:93], v[32:33]
v_pk_mul_f32 v[94:95], v[94:95], v[34:35]
v_exp_f32 v92, v92
v_exp_f32 v93, v93
v_exp_f32 v94, v94
v_exp_f32 v95, v95
s_nop 0
v_pk_add_f32 v[92:93], v[92:93], v[102:103]
v_pk_add_f32 v[94:95], v[94:95], v[102:103]
v_rcp_f32 v92, v92
v_rcp_f32 v93, v93
v_rcp_f32 v94, v94
v_rcp_f32 v95, v95
s_nop 0
v_pk_mul_f32 v[92:93], v[92:93], v[32:33]
v_pk_mul_f32 v[94:95], v[94:95], v[34:35]
v_cvt_pk_bf16_f32 v80, v92, v93
v_cvt_pk_bf16_f32 v81, v94, v95
v_pk_mul_f32 v[92:93], v[36:37], v[36:37]
v_pk_mul_f32 v[94:95], v[38:39], v[38:39]
v_pk_fma_f32 v[92:93], v[92:93], v[100:101], v[100:101] op_sel:[0,0,1] op_sel_hi:[1,0,1]
v_pk_fma_f32 v[94:95], v[94:95], v[100:101], v[100:101] op_sel:[0,0,1] op_sel_hi:[1,0,1]
v_pk_mul_f32 v[92:93], v[92:93], v[36:37]
v_pk_mul_f32 v[94:95], v[94:95], v[38:39]
v_exp_f32 v92, v92
v_exp_f32 v93, v93
v_exp_f32 v94, v94
v_exp_f32 v95, v95
s_nop 0
v_pk_add_f32 v[92:93], v[92:93], v[102:103]
v_pk_add_f32 v[94:95], v[94:95], v[102:103]
v_rcp_f32 v92, v92
v_rcp_f32 v93, v93
v_rcp_f32 v94, v94
v_rcp_f32 v95, v95
s_nop 0
v_pk_mul_f32 v[92:93], v[92:93], v[36:37]
v_pk_mul_f32 v[94:95], v[94:95], v[38:39]
v_cvt_pk_bf16_f32 v82, v92, v93
v_cvt_pk_bf16_f32 v83, v94, v95
v_dot2c_f32_bf16 v88, v80, v104
v_dot2c_f32_bf16 v89, v80, v80
v_dot2c_f32_bf16 v88, v81, v104
v_dot2c_f32_bf16 v89, v81, v81
v_dot2c_f32_bf16 v88, v82, v104
v_dot2c_f32_bf16 v89, v82, v82
v_dot2c_f32_bf16 v88, v83, v104
v_dot2c_f32_bf16 v89, v83, v83
v_permlane16_swap_b32 v80, v82
v_permlane16_swap_b32 v81, v83
ds_write_b128 v231, v[80:83] offset:4096
v_pk_mul_f32 v[92:93], v[48:49], v[48:49]
v_pk_mul_f32 v[94:95], v[50:51], v[50:51]
v_pk_fma_f32 v[92:93], v[92:93], v[100:101], v[100:101] op_sel:[0,0,1] op_sel_hi:[1,0,1]
v_pk_fma_f32 v[94:95], v[94:95], v[100:101], v[100:101] op_sel:[0,0,1] op_sel_hi:[1,0,1]
v_pk_mul_f32 v[92:93], v[92:93], v[48:49]
v_pk_mul_f32 v[94:95], v[94:95], v[50:51]
v_exp_f32 v92, v92
v_exp_f32 v93, v93
v_exp_f32 v94, v94
v_exp_f32 v95, v95
s_nop 0
v_pk_add_f32 v[92:93], v[92:93], v[102:103]
v_pk_add_f32 v[94:95], v[94:95], v[102:103]
v_rcp_f32 v92, v92
v_rcp_f32 v93, v93
v_rcp_f32 v94, v94
v_rcp_f32 v95, v95
s_nop 0
v_pk_mul_f32 v[92:93], v[92:93], v[48:49]
v_pk_mul_f32 v[94:95], v[94:95], v[50:51]
v_cvt_pk_bf16_f32 v80, v92, v93
v_cvt_pk_bf16_f32 v81, v94, v95
v_pk_mul_f32 v[92:93], v[52:53], v[52:53]
v_pk_mul_f32 v[94:95], v[54:55], v[54:55]
v_pk_fma_f32 v[92:93], v[92:93], v[100:101], v[100:101] op_sel:[0,0,1] op_sel_hi:[1,0,1]
v_pk_fma_f32 v[94:95], v[94:95], v[100:101], v[100:101] op_sel:[0,0,1] op_sel_hi:[1,0,1]
v_pk_mul_f32 v[92:93], v[92:93], v[52:53]
v_pk_mul_f32 v[94:95], v[94:95], v[54:55]
v_exp_f32 v92, v92
v_exp_f32 v93, v93
v_exp_f32 v94, v94
v_exp_f32 v95, v95
s_nop 0
v_pk_add_f32 v[92:93], v[92:93], v[102:103]
v_pk_add_f32 v[94:95], v[94:95], v[102:103]
v_rcp_f32 v92, v92
v_rcp_f32 v93, v93
v_rcp_f32 v94, v94
v_rcp_f32 v95, v95
s_nop 0
v_pk_mul_f32 v[92:93], v[92:93], v[52:53]
v_pk_mul_f32 v[94:95], v[94:95], v[54:55]
v_cvt_pk_bf16_f32 v82, v92, v93
v_cvt_pk_bf16_f32 v83, v94, v95
v_dot2c_f32_bf16 v90, v80, v104
v_dot2c_f32_bf16 v91, v80, v80
v_dot2c_f32_bf16 v90, v81, v104
v_dot2c_f32_bf16 v91, v81, v81
v_dot2c_f32_bf16 v90, v82, v104
v_dot2c_f32_bf16 v91, v82, v82
v_dot2c_f32_bf16 v90, v83, v104
v_dot2c_f32_bf16 v91, v83, v83
v_permlane16_swap_b32 v80, v82
v_permlane16_swap_b32 v81, v83
ds_write_b128 v231, v[80:83] offset:6144
La_n_42:
s_nop 2
v_mov_b32 v92, v84
v_mov_b32 v93, v85
v_mov_b32 v94, v86
v_mov_b32 v95, v87
v_mov_b32 v96, v88
v_mov_b32 v97, v89
v_mov_b32 v98, v90
v_mov_b32 v99, v91
s_nop 1
v_permlane32_swap_b32 v84, v92
v_permlane32_swap_b32 v85, v93
v_permlane32_swap_b32 v86, v94
v_permlane32_swap_b32 v87, v95
v_permlane32_swap_b32 v88, v96
v_permlane32_swap_b32 v89, v97
v_permlane32_swap_b32 v90, v98
v_permlane32_swap_b32 v91, v99
s_nop 0
v_add_f32 v84, v84, v92
v_add_f32 v85, v85, v93
v_add_f32 v86, v86, v94
v_add_f32 v87, v87, v95
v_add_f32 v88, v88, v96
v_add_f32 v89, v89, v97
v_add_f32 v90, v90, v98
v_add_f32 v91, v91, v99
v_mov_b32 v92, v84
v_mov_b32 v93, v85
v_mov_b32 v94, v86
v_mov_b32 v95, v87
v_mov_b32 v96, v88
v_mov_b32 v97, v89
v_mov_b32 v98, v90
v_mov_b32 v99, v91
s_nop 1
v_permlane16_swap_b32 v84, v92
v_permlane16_swap_b32 v85, v93
v_permlane16_swap_b32 v86, v94
v_permlane16_swap_b32 v87, v95
v_permlane16_swap_b32 v88, v96
v_permlane16_swap_b32 v89, v97
v_permlane16_swap_b32 v90, v98
v_permlane16_swap_b32 v91, v99
s_nop 0
v_add_f32 v84, v84, v92
v_add_f32 v85, v85, v93
v_add_f32 v86, v86, v94
v_add_f32 v87, v87, v95
v_add_f32 v88, v88, v96
v_add_f32 v89, v89, v97
v_add_f32 v90, v90, v98
v_add_f32 v91, v91, v99
v_lshlrev_b32 v229, 3, v228
s_lshl_b32 s20, s39, 10
s_add_u32 s20, s20, 149504
v_add_u32 v229, s20, v229
ds_write_b64 v229, v[84:85] offset:0
ds_write_b64 v229, v[86:87] offset:128
ds_write_b64 v229, v[88:89] offset:256
ds_write_b64 v229, v[90:91] offset:384
s_waitcnt lgkmcnt(0)
s_barrier
ds_read_b128 v[64:67], v132 offset:0
ds_read_b64_tr_b16 v[96:97], v134 offset:0
ds_read_b64_tr_b16 v[98:99], v134 offset:512
ds_read_b64_tr_b16 v[100:101], v135 offset:0
ds_read_b64_tr_b16 v[102:103], v135 offset:512
ds_read_b128 v[68:71], v132 offset:2048
ds_read_b64_tr_b16 v[104:105], v134 offset:8192
ds_read_b64_tr_b16 v[106:107], v134 offset:8704
ds_read_b64_tr_b16 v[108:109], v135 offset:8192
ds_read_b64_tr_b16 v[110:111], v135 offset:8704
ds_read_b128 v[72:75], v132 offset:4096
ds_read_b128 v[76:79], v132 offset:6144
s_waitcnt lgkmcnt(0)
v_mfma_f32_16x16x32_bf16 v[144:147], v[96:99], v[64:67], 0
ds_read_b128 v[80:83], v133 offset:0
ds_read_b64_tr_b16 v[112:113], v134 offset:4096
v_mfma_f32_16x16x32_bf16 v[148:151], v[100:103], v[64:67], 0
ds_read_b64_tr_b16 v[114:115], v134 offset:4608
ds_read_b64_tr_b16 v[116:117], v135 offset:4096
v_mfma_f32_16x16x32_bf16 v[152:155], v[104:107], v[64:67], 0
ds_read_b64_tr_b16 v[118:119], v135 offset:4608
ds_read_b128 v[84:87], v133 offset:2048
v_mfma_f32_16x16x32_bf16 v[156:159], v[108:111], v[64:67], 0
ds_read_b64_tr_b16 v[120:121], v134 offset:12288
ds_read_b64_tr_b16 v[122:123], v134 offset:12800
v_mfma_f32_16x16x32_bf16 v[160:163], v[96:99], v[68:71], 0
ds_read_b64_tr_b16 v[124:125], v135 offset:12288
v_mfma_f32_16x16x32_bf16 v[164:167], v[100:103], v[68:71], 0
ds_read_b64_tr_b16 v[126:127], v135 offset:12800
v_mfma_f32_16x16x32_bf16 v[168:171], v[104:107], v[68:71], 0
ds_read_b128 v[88:91], v133 offset:4096
v_mfma_f32_16x16x32_bf16 v[172:175], v[108:111], v[68:71], 0
ds_read_b128 v[92:95], v133 offset:6144
v_mfma_f32_16x16x32_bf16 v[176:179], v[96:99], v[72:75], 0
v_mfma_f32_16x16x32_bf16 v[180:183], v[100:103], v[72:75], 0
v_mfma_f32_16x16x32_bf16 v[184:187], v[104:107], v[72:75], 0
v_mfma_f32_16x16x32_bf16 v[188:191], v[108:111], v[72:75], 0
v_mfma_f32_16x16x32_bf16 v[192:195], v[96:99], v[76:79], 0
v_mfma_f32_16x16x32_bf16 v[196:199], v[100:103], v[76:79], 0
v_mfma_f32_16x16x32_bf16 v[200:203], v[104:107], v[76:79], 0
v_mfma_f32_16x16x32_bf16 v[204:207], v[108:111], v[76:79], 0
s_cmp_eq_u32 s38, 1
s_cbranch_scc1 Lcs_43
v_mfma_f32_16x16x32_bf16 v[208:211], v[96:99], v[216:219], 0
v_mfma_f32_16x16x32_bf16 v[212:215], v[100:103], v[216:219], 0
s_branch Lcj_44
Lcs_43:
v_mfma_f32_16x16x32_bf16 v[208:211], v[104:107], v[216:219], 0
v_mfma_f32_16x16x32_bf16 v[212:215], v[108:111], v[216:219], 0
Lcj_44:
s_waitcnt lgkmcnt(0)
s_barrier
v_mfma_f32_16x16x32_bf16 v[144:147], v[112:115], v[80:83], v[144:147]
ds_read_b128 v[64:67], v132 offset:32768
ds_read_b64_tr_b16 v[96:97], v134 offset:32768
v_mfma_f32_16x16x32_bf16 v[148:151], v[116:119], v[80:83], v[148:151]
ds_read_b64_tr_b16 v[98:99], v134 offset:33280
ds_read_b64_tr_b16 v[100:101], v135 offset:32768
v_mfma_f32_16x16x32_bf16 v[152:155], v[120:123], v[80:83], v[152:155]
ds_read_b64_tr_b16 v[102:103], v135 offset:33280
ds_read_b128 v[68:71], v132 offset:34816
v_mfma_f32_16x16x32_bf16 v[156:159], v[124:127], v[80:83], v[156:159]
ds_read_b64_tr_b16 v[104:105], v134 offset:40960
ds_read_b64_tr_b16 v[106:107], v134 offset:41472
v_mfma_f32_16x16x32_bf16 v[160:163], v[112:115], v[84:87], v[160:163]
ds_read_b64_tr_b16 v[108:109], v135 offset:40960
v_mfma_f32_16x16x32_bf16 v[164:167], v[116:119], v[84:87], v[164:167]
ds_read_b64_tr_b16 v[110:111], v135 offset:41472
v_mfma_f32_16x16x32_bf16 v[168:171], v[120:123], v[84:87], v[168:171]
ds_read_b128 v[72:75], v132 offset:36864
v_mfma_f32_16x16x32_bf16 v[172:175], v[124:127], v[84:87], v[172:175]
ds_read_b128 v[76:79], v132 offset:38912
v_mfma_f32_16x16x32_bf16 v[176:179], v[112:115], v[88:91], v[176:179]
v_mfma_f32_16x16x32_bf16 v[180:183], v[116:119], v[88:91], v[180:183]
v_mfma_f32_16x16x32_bf16 v[184:187], v[120:123], v[88:91], v[184:187]
v_mfma_f32_16x16x32_bf16 v[188:191], v[124:127], v[88:91], v[188:191]
v_mfma_f32_16x16x32_bf16 v[192:195], v[112:115], v[92:95], v[192:195]
v_mfma_f32_16x16x32_bf16 v[196:199], v[116:119], v[92:95], v[196:199]
v_mfma_f32_16x16x32_bf16 v[200:203], v[120:123], v[92:95], v[200:203]
v_mfma_f32_16x16x32_bf16 v[204:207], v[124:127], v[92:95], v[204:207]
s_cmp_eq_u32 s38, 1
s_cbranch_scc1 Lcs_45
v_mfma_f32_16x16x32_bf16 v[208:211], v[112:115], v[216:219], v[208:211]
v_mfma_f32_16x16x32_bf16 v[212:215], v[116:119], v[216:219], v[212:215]
s_branch Lcj_46
Lcs_45:
v_mfma_f32_16x16x32_bf16 v[208:211], v[120:123], v[216:219], v[208:211]
v_mfma_f32_16x16x32_bf16 v[212:215], v[124:127], v[216:219], v[212:215]
Lcj_46:
s_waitcnt lgkmcnt(0)
v_mfma_f32_16x16x32_bf16 v[144:147], v[96:99], v[64:67], v[144:147]
v_mul_f32 v4, v220, v137
ds_read_b128 v[80:83], v133 offset:32768
ds_read_b64_tr_b16 v[112:113], v134 offset:36864
v_mfma_f32_16x16x32_bf16 v[148:151], v[100:103], v[64:67], v[148:151]
v_mul_f32 v5, v221, v137
ds_read_b64_tr_b16 v[114:115], v134 offset:37376
ds_read_b64_tr_b16 v[116:117], v135 offset:36864
v_mfma_f32_16x16x32_bf16 v[152:155], v[104:107], v[64:67], v[152:155]
v_mul_f32 v6, v222, v137
ds_read_b64_tr_b16 v[118:119], v135 offset:37376
ds_read_b128 v[84:87], v133 offset:34816
v_mfma_f32_16x16x32_bf16 v[156:159], v[108:111], v[64:67], v[156:159]
ds_read_b64_tr_b16 v[120:121], v134 offset:45056
ds_read_b64_tr_b16 v[122:123], v134 offset:45568
v_mfma_f32_16x16x32_bf16 v[160:163], v[96:99], v[68:71], v[160:163]
v_mul_f32 v7, v223, v137
ds_read_b64_tr_b16 v[124:125], v135 offset:45056
v_mfma_f32_16x16x32_bf16 v[164:167], v[100:103], v[68:71], v[164:167]
v_fma_f32 v8, v8, v136, v4
ds_read_b64_tr_b16 v[126:127], v135 offset:45568
v_mfma_f32_16x16x32_bf16 v[168:171], v[104:107], v[68:71], v[168:171]
ds_read_b128 v[88:91], v133 offset:36864
v_mfma_f32_16x16x32_bf16 v[172:175], v[108:111], v[68:71], v[172:175]
v_fma_f32 v9, v9, v136, v5
ds_read_b128 v[92:95], v133 offset:38912
v_mfma_f32_16x16x32_bf16 v[176:179], v[96:99], v[72:75], v[176:179]
v_fma_f32 v10, v10, v136, v6
v_mfma_f32_16x16x32_bf16 v[180:183], v[100:103], v[72:75], v[180:183]
v_fma_f32 v11, v11, v136, v7
v_mfma_f32_16x16x32_bf16 v[184:187], v[104:107], v[72:75], v[184:187]
v_mfma_f32_16x16x32_bf16 v[188:191], v[108:111], v[72:75], v[188:191]
v_mul_f32 v4, v224, v137
v_mfma_f32_16x16x32_bf16 v[192:195], v[96:99], v[76:79], v[192:195]
v_mul_f32 v5, v225, v137
v_mfma_f32_16x16x32_bf16 v[196:199], v[100:103], v[76:79], v[196:199]
v_mfma_f32_16x16x32_bf16 v[200:203], v[104:107], v[76:79], v[200:203]
v_mul_f32 v6, v226, v137
v_mfma_f32_16x16x32_bf16 v[204:207], v[108:111], v[76:79], v[204:207]
v_mul_f32 v7, v227, v137
s_cmp_eq_u32 s38, 1
s_cbranch_scc1 Lcs_47
v_mfma_f32_16x16x32_bf16 v[208:211], v[96:99], v[216:219], v[208:211]
v_mfma_f32_16x16x32_bf16 v[212:215], v[100:103], v[216:219], v[212:215]
s_branch Lcj_48
Lcs_47:
v_mfma_f32_16x16x32_bf16 v[208:211], v[104:107], v[216:219], v[208:211]
v_mfma_f32_16x16x32_bf16 v[212:215], v[108:111], v[216:219], v[212:215]
Lcj_48:
s_waitcnt lgkmcnt(0)
s_barrier
v_mfma_f32_16x16x32_bf16 v[144:147], v[112:115], v[80:83], v[144:147]
v_fma_f32 v12, v12, v136, v4
ds_read_b128 v[64:67], v128 offset:0
ds_read_b64_tr_b16 v[96:97], v130 offset:0
v_mfma_f32_16x16x32_bf16 v[148:151], v[116:119], v[80:83], v[148:151]
v_fma_f32 v13, v13, v136, v5
ds_read_b64_tr_b16 v[98:99], v130 offset:512
ds_read_b64_tr_b16 v[100:101], v131 offset:0
v_mfma_f32_16x16x32_bf16 v[152:155], v[120:123], v[80:83], v[152:155]
v_fma_f32 v14, v14, v136, v6
ds_read_b64_tr_b16 v[102:103], v131 offset:512
ds_read_b128 v[68:71], v128 offset:2048
v_mfma_f32_16x16x32_bf16 v[156:159], v[124:127], v[80:83], v[156:159]
ds_read_b64_tr_b16 v[104:105], v130 offset:8192
ds_read_b64_tr_b16 v[106:107], v130 offset:8704
v_mfma_f32_16x16x32_bf16 v[160:163], v[112:115], v[84:87], v[160:163]
v_fma_f32 v15, v15, v136, v7
ds_read_b64_tr_b16 v[108:109], v131 offset:8192
v_mfma_f32_16x16x32_bf16 v[164:167], v[116:119], v[84:87], v[164:167]
v_cvt_pk_bf16_f32 v0, v8, v9
ds_read_b64_tr_b16 v[110:111], v131 offset:8704
v_mfma_f32_16x16x32_bf16 v[168:171], v[120:123], v[84:87], v[168:171]
ds_read_b128 v[72:75], v128 offset:4096
v_mfma_f32_16x16x32_bf16 v[172:175], v[124:127], v[84:87], v[172:175]
v_cvt_pk_bf16_f32 v1, v10, v11
ds_read_b128 v[76:79], v128 offset:6144
v_mfma_f32_16x16x32_bf16 v[176:179], v[112:115], v[88:91], v[176:179]
v_cvt_pk_bf16_f32 v2, v12, v13
v_mfma_f32_16x16x32_bf16 v[180:183], v[116:119], v[88:91], v[180:183]
v_cvt_pk_bf16_f32 v3, v14, v15
v_mfma_f32_16x16x32_bf16 v[184:187], v[120:123], v[88:91], v[184:187]
v_mfma_f32_16x16x32_bf16 v[188:191], v[124:127], v[88:91], v[188:191]
s_mov_b32 s40, 0
v_mfma_f32_16x16x32_bf16 v[192:195], v[112:115], v[92:95], v[192:195]
v_permlane16_swap_b32 v0, v2
v_mfma_f32_16x16x32_bf16 v[196:199], v[116:119], v[92:95], v[196:199]
v_mfma_f32_16x16x32_bf16 v[200:203], v[120:123], v[92:95], v[200:203]
v_permlane16_swap_b32 v1, v3
v_mfma_f32_16x16x32_bf16 v[204:207], v[124:127], v[92:95], v[204:207]
buffer_store_dwordx4 v[0:3], v251, s[16:19], s40 offen sc1
s_cmp_eq_u32 s38, 1
s_cbranch_scc1 Lcs_49
v_mfma_f32_16x16x32_bf16 v[208:211], v[112:115], v[216:219], v[208:211]
v_mfma_f32_16x16x32_bf16 v[212:215], v[116:119], v[216:219], v[212:215]
s_branch Lcj_50
Lcs_49:
v_mfma_f32_16x16x32_bf16 v[208:211], v[120:123], v[216:219], v[208:211]
v_mfma_f32_16x16x32_bf16 v[212:215], v[124:127], v[216:219], v[212:215]
Lcj_50:
s_waitcnt lgkmcnt(0)
v_mfma_f32_16x16x32_bf16 v[144:147], v[96:99], v[64:67], v[144:147]
v_mul_f32 v20, v220, v139
ds_read_b128 v[80:83], v129 offset:0
ds_read_b64_tr_b16 v[112:113], v130 offset:4096
v_mfma_f32_16x16x32_bf16 v[148:151], v[100:103], v[64:67], v[148:151]
v_mul_f32 v21, v221, v139
ds_read_b64_tr_b16 v[114:115], v130 offset:4608
ds_read_b64_tr_b16 v[116:117], v131 offset:4096
v_mfma_f32_16x16x32_bf16 v[152:155], v[104:107], v[64:67], v[152:155]
v_mul_f32 v22, v222, v139
ds_read_b64_tr_b16 v[118:119], v131 offset:4608
ds_read_b128 v[84:87], v129 offset:2048
v_mfma_f32_16x16x32_bf16 v[156:159], v[108:111], v[64:67], v[156:159]
ds_read_b64_tr_b16 v[120:121], v130 offset:12288
ds_read_b64_tr_b16 v[122:123], v130 offset:12800
v_mfma_f32_16x16x32_bf16 v[160:163], v[96:99], v[68:71], v[160:163]
v_mul_f32 v23, v223, v139
ds_read_b64_tr_b16 v[124:125], v131 offset:12288
v_mfma_f32_16x16x32_bf16 v[164:167], v[100:103], v[68:71], v[164:167]
v_fma_f32 v24, v24, v138, v20
ds_read_b64_tr_b16 v[126:127], v131 offset:12800
v_mfma_f32_16x16x32_bf16 v[168:171], v[104:107], v[68:71], v[168:171]
ds_read_b128 v[88:91], v129 offset:4096
v_mfma_f32_16x16x32_bf16 v[172:175], v[108:111], v[68:71], v[172:175]
v_fma_f32 v25, v25, v138, v21
ds_read_b128 v[92:95], v129 offset:6144
v_mfma_f32_16x16x32_bf16 v[176:179], v[96:99], v[72:75], v[176:179]
v_fma_f32 v26, v26, v138, v22
v_mfma_f32_16x16x32_bf16 v[180:183], v[100:103], v[72:75], v[180:183]
v_fma_f32 v27, v27, v138, v23
v_mfma_f32_16x16x32_bf16 v[184:187], v[104:107], v[72:75], v[184:187]
v_mfma_f32_16x16x32_bf16 v[188:191], v[108:111], v[72:75], v[188:191]
v_mul_f32 v20, v224, v139
v_mfma_f32_16x16x32_bf16 v[192:195], v[96:99], v[76:79], v[192:195]
v_mul_f32 v21, v225, v139
v_mfma_f32_16x16x32_bf16 v[196:199], v[100:103], v[76:79], v[196:199]
v_mfma_f32_16x16x32_bf16 v[200:203], v[104:107], v[76:79], v[200:203]
v_mul_f32 v22, v226, v139
v_mfma_f32_16x16x32_bf16 v[204:207], v[108:111], v[76:79], v[204:207]
v_mul_f32 v23, v227, v139
s_cmp_eq_u32 s38, 1
s_cbranch_scc1 Lcs_51
v_mfma_f32_16x16x32_bf16 v[208:211], v[96:99], v[216:219], v[208:211]
v_mfma_f32_16x16x32_bf16 v[212:215], v[100:103], v[216:219], v[212:215]
s_branch Lcj_52
Lcs_51:
v_mfma_f32_16x16x32_bf16 v[208:211], v[104:107], v[216:219], v[208:211]
v_mfma_f32_16x16x32_bf16 v[212:215], v[108:111], v[216:219], v[212:215]
Lcj_52:
s_waitcnt lgkmcnt(0)
s_barrier
v_mfma_f32_16x16x32_bf16 v[144:147], v[112:115], v[80:83], v[144:147]
v_fma_f32 v28, v28, v138, v20
ds_read_b128 v[64:67], v128 offset:32768
ds_read_b64_tr_b16 v[96:97], v130 offset:32768
v_mfma_f32_16x16x32_bf16 v[148:151], v[116:119], v[80:83], v[148:151]
v_fma_f32 v29, v29, v138, v21
ds_read_b64_tr_b16 v[98:99], v130 offset:33280
ds_read_b64_tr_b16 v[100:101], v131 offset:32768
v_mfma_f32_16x16x32_bf16 v[152:155], v[120:123], v[80:83], v[152:155]
v_fma_f32 v30, v30, v138, v22
ds_read_b64_tr_b16 v[102:103], v131 offset:33280
ds_read_b128 v[68:71], v128 offset:34816
v_mfma_f32_16x16x32_bf16 v[156:159], v[124:127], v[80:83], v[156:159]
ds_read_b64_tr_b16 v[104:105], v130 offset:40960
ds_read_b64_tr_b16 v[106:107], v130 offset:41472
v_mfma_f32_16x16x32_bf16 v[160:163], v[112:115], v[84:87], v[160:163]
v_fma_f32 v31, v31, v138, v23
ds_read_b64_tr_b16 v[108:109], v131 offset:40960
v_mfma_f32_16x16x32_bf16 v[164:167], v[116:119], v[84:87], v[164:167]
v_cvt_pk_bf16_f32 v16, v24, v25
ds_read_b64_tr_b16 v[110:111], v131 offset:41472
v_mfma_f32_16x16x32_bf16 v[168:171], v[120:123], v[84:87], v[168:171]
ds_read_b128 v[72:75], v128 offset:36864
v_mfma_f32_16x16x32_bf16 v[172:175], v[124:127], v[84:87], v[172:175]
v_cvt_pk_bf16_f32 v17, v26, v27
ds_read_b128 v[76:79], v128 offset:38912
v_mfma_f32_16x16x32_bf16 v[176:179], v[112:115], v[88:91], v[176:179]
v_cvt_pk_bf16_f32 v18, v28, v29
v_mfma_f32_16x16x32_bf16 v[180:183], v[116:119], v[88:91], v[180:183]
v_cvt_pk_bf16_f32 v19, v30, v31
v_mfma_f32_16x16x32_bf16 v[184:187], v[120:123], v[88:91], v[184:187]
v_mfma_f32_16x16x32_bf16 v[188:191], v[124:127], v[88:91], v[188:191]
s_mov_b32 s40, 28672
v_mfma_f32_16x16x32_bf16 v[192:195], v[112:115], v[92:95], v[192:195]
v_permlane16_swap_b32 v16, v18
v_mfma_f32_16x16x32_bf16 v[196:199], v[116:119], v[92:95], v[196:199]
v_mfma_f32_16x16x32_bf16 v[200:203], v[120:123], v[92:95], v[200:203]
v_permlane16_swap_b32 v17, v19
v_mfma_f32_16x16x32_bf16 v[204:207], v[124:127], v[92:95], v[204:207]
buffer_store_dwordx4 v[16:19], v251, s[16:19], s40 offen sc1
s_cmp_eq_u32 s38, 1
s_cbranch_scc1 Lcs_53
v_mfma_f32_16x16x32_bf16 v[208:211], v[112:115], v[216:219], v[208:211]
v_mfma_f32_16x16x32_bf16 v[212:215], v[116:119], v[216:219], v[212:215]
s_branch Lcj_54
Lcs_53:
v_mfma_f32_16x16x32_bf16 v[208:211], v[120:123], v[216:219], v[208:211]
v_mfma_f32_16x16x32_bf16 v[212:215], v[124:127], v[216:219], v[212:215]
Lcj_54:
s_waitcnt lgkmcnt(0)
v_mfma_f32_16x16x32_bf16 v[144:147], v[96:99], v[64:67], v[144:147]
v_mul_f32 v36, v220, v141
ds_read_b128 v[80:83], v129 offset:32768
ds_read_b64_tr_b16 v[112:113], v130 offset:36864
v_mfma_f32_16x16x32_bf16 v[148:151], v[100:103], v[64:67], v[148:151]
v_mul_f32 v37, v221, v141
ds_read_b64_tr_b16 v[114:115], v130 offset:37376
ds_read_b64_tr_b16 v[116:117], v131 offset:36864
v_mfma_f32_16x16x32_bf16 v[152:155], v[104:107], v[64:67], v[152:155]
v_mul_f32 v38, v222, v141
ds_read_b64_tr_b16 v[118:119], v131 offset:37376
ds_read_b128 v[84:87], v129 offset:34816
v_mfma_f32_16x16x32_bf16 v[156:159], v[108:111], v[64:67], v[156:159]
ds_read_b64_tr_b16 v[120:121], v130 offset:45056
ds_read_b64_tr_b16 v[122:123], v130 offset:45568
v_mfma_f32_16x16x32_bf16 v[160:163], v[96:99], v[68:71], v[160:163]
v_mul_f32 v39, v223, v141
ds_read_b64_tr_b16 v[124:125], v131 offset:45056
v_mfma_f32_16x16x32_bf16 v[164:167], v[100:103], v[68:71], v[164:167]
v_fma_f32 v40, v40, v140, v36
ds_read_b64_tr_b16 v[126:127], v131 offset:45568
v_mfma_f32_16x16x32_bf16 v[168:171], v[104:107], v[68:71], v[168:171]
ds_read_b128 v[88:91], v129 offset:36864
v_mfma_f32_16x16x32_bf16 v[172:175], v[108:111], v[68:71], v[172:175]
v_fma_f32 v41, v41, v140, v37
ds_read_b128 v[92:95], v129 offset:38912
v_mfma_f32_16x16x32_bf16 v[176:179], v[96:99], v[72:75], v[176:179]
v_fma_f32 v42, v42, v140, v38
v_mfma_f32_16x16x32_bf16 v[180:183], v[100:103], v[72:75], v[180:183]
v_fma_f32 v43, v43, v140, v39
v_mfma_f32_16x16x32_bf16 v[184:187], v[104:107], v[72:75], v[184:187]
v_mfma_f32_16x16x32_bf16 v[188:191], v[108:111], v[72:75], v[188:191]
v_mul_f32 v36, v224, v141
v_mfma_f32_16x16x32_bf16 v[192:195], v[96:99], v[76:79], v[192:195]
v_mul_f32 v37, v225, v141
v_mfma_f32_16x16x32_bf16 v[196:199], v[100:103], v[76:79], v[196:199]
v_mfma_f32_16x16x32_bf16 v[200:203], v[104:107], v[76:79], v[200:203]
v_mul_f32 v38, v226, v141
v_mfma_f32_16x16x32_bf16 v[204:207], v[108:111], v[76:79], v[204:207]
v_mul_f32 v39, v227, v141
s_cmp_eq_u32 s38, 1
s_cbranch_scc1 Lcs_55
v_mfma_f32_16x16x32_bf16 v[208:211], v[96:99], v[216:219], v[208:211]
v_mfma_f32_16x16x32_bf16 v[212:215], v[100:103], v[216:219], v[212:215]
s_branch Lcj_56
Lcs_55:
v_mfma_f32_16x16x32_bf16 v[208:211], v[104:107], v[216:219], v[208:211]
v_mfma_f32_16x16x32_bf16 v[212:215], v[108:111], v[216:219], v[212:215]
Lcj_56:
s_waitcnt lgkmcnt(0)
s_barrier
v_mfma_f32_16x16x32_bf16 v[144:147], v[112:115], v[80:83], v[144:147]
v_fma_f32 v44, v44, v140, v36
ds_read_b128 v[64:67], v132 offset:0
ds_read_b64_tr_b16 v[96:97], v134 offset:0
v_mfma_f32_16x16x32_bf16 v[148:151], v[116:119], v[80:83], v[148:151]
v_fma_f32 v45, v45, v140, v37
ds_read_b64_tr_b16 v[98:99], v134 offset:512
ds_read_b64_tr_b16 v[100:101], v135 offset:0
v_mfma_f32_16x16x32_bf16 v[152:155], v[120:123], v[80:83], v[152:155]
v_fma_f32 v46, v46, v140, v38
ds_read_b64_tr_b16 v[102:103], v135 offset:512
ds_read_b128 v[68:71], v132 offset:2048
v_mfma_f32_16x16x32_bf16 v[156:159], v[124:127], v[80:83], v[156:159]
ds_read_b64_tr_b16 v[104:105], v134 offset:8192
ds_read_b64_tr_b16 v[106:107], v134 offset:8704
v_mfma_f32_16x16x32_bf16 v[160:163], v[112:115], v[84:87], v[160:163]
v_fma_f32 v47, v47, v140, v39
ds_read_b64_tr_b16 v[108:109], v135 offset:8192
v_mfma_f32_16x16x32_bf16 v[164:167], v[116:119], v[84:87], v[164:167]
v_cvt_pk_bf16_f32 v32, v40, v41
ds_read_b64_tr_b16 v[110:111], v135 offset:8704
v_mfma_f32_16x16x32_bf16 v[168:171], v[120:123], v[84:87], v[168:171]
ds_read_b128 v[72:75], v132 offset:4096
v_mfma_f32_16x16x32_bf16 v[172:175], v[124:127], v[84:87], v[172:175]
v_cvt_pk_bf16_f32 v33, v42, v43
ds_read_b128 v[76:79], v132 offset:6144
v_mfma_f32_16x16x32_bf16 v[176:179], v[112:115], v[88:91], v[176:179]
v_cvt_pk_bf16_f32 v34, v44, v45
v_mfma_f32_16x16x32_bf16 v[180:183], v[116:119], v[88:91], v[180:183]
v_cvt_pk_bf16_f32 v35, v46, v47
v_mfma_f32_16x16x32_bf16 v[184:187], v[120:123], v[88:91], v[184:187]
v_mfma_f32_16x16x32_bf16 v[188:191], v[124:127], v[88:91], v[188:191]
s_mov_b32 s40, 57344
v_mfma_f32_16x16x32_bf16 v[192:195], v[112:115], v[92:95], v[192:195]
v_permlane16_swap_b32 v32, v34
v_mfma_f32_16x16x32_bf16 v[196:199], v[116:119], v[92:95], v[196:199]
v_mfma_f32_16x16x32_bf16 v[200:203], v[120:123], v[92:95], v[200:203]
v_permlane16_swap_b32 v33, v35
v_mfma_f32_16x16x32_bf16 v[204:207], v[124:127], v[92:95], v[204:207]
buffer_store_dwordx4 v[32:35], v251, s[16:19], s40 offen sc1
s_cmp_eq_u32 s38, 1
s_cbranch_scc1 Lcs_57
v_mfma_f32_16x16x32_bf16 v[208:211], v[112:115], v[216:219], v[208:211]
v_mfma_f32_16x16x32_bf16 v[212:215], v[116:119], v[216:219], v[212:215]
s_branch Lcj_58
Lcs_57:
v_mfma_f32_16x16x32_bf16 v[208:211], v[120:123], v[216:219], v[208:211]
v_mfma_f32_16x16x32_bf16 v[212:215], v[124:127], v[216:219], v[212:215]
Lcj_58:
s_waitcnt lgkmcnt(0)
v_mfma_f32_16x16x32_bf16 v[144:147], v[96:99], v[64:67], v[144:147]
v_mul_f32 v52, v220, v143
ds_read_b128 v[80:83], v133 offset:0
ds_read_b64_tr_b16 v[112:113], v134 offset:4096
v_mfma_f32_16x16x32_bf16 v[148:151], v[100:103], v[64:67], v[148:151]
v_mul_f32 v53, v221, v143
ds_read_b64_tr_b16 v[114:115], v134 offset:4608
ds_read_b64_tr_b16 v[116:117], v135 offset:4096
v_mfma_f32_16x16x32_bf16 v[152:155], v[104:107], v[64:67], v[152:155]
v_mul_f32 v54, v222, v143
ds_read_b64_tr_b16 v[118:119], v135 offset:4608
ds_read_b128 v[84:87], v133 offset:2048
v_mfma_f32_16x16x32_bf16 v[156:159], v[108:111], v[64:67], v[156:159]
ds_read_b64_tr_b16 v[120:121], v134 offset:12288
ds_read_b64_tr_b16 v[122:123], v134 offset:12800
v_mfma_f32_16x16x32_bf16 v[160:163], v[96:99], v[68:71], v[160:163]
v_mul_f32 v55, v223, v143
ds_read_b64_tr_b16 v[124:125], v135 offset:12288
v_mfma_f32_16x16x32_bf16 v[164:167], v[100:103], v[68:71], v[164:167]
v_fma_f32 v56, v56, v142, v52
ds_read_b64_tr_b16 v[126:127], v135 offset:12800
v_mfma_f32_16x16x32_bf16 v[168:171], v[104:107], v[68:71], v[168:171]
ds_read_b128 v[88:91], v133 offset:4096
v_mfma_f32_16x16x32_bf16 v[172:175], v[108:111], v[68:71], v[172:175]
v_fma_f32 v57, v57, v142, v53
ds_read_b128 v[92:95], v133 offset:6144
v_mfma_f32_16x16x32_bf16 v[176:179], v[96:99], v[72:75], v[176:179]
v_fma_f32 v58, v58, v142, v54
v_mfma_f32_16x16x32_bf16 v[180:183], v[100:103], v[72:75], v[180:183]
v_fma_f32 v59, v59, v142, v55
v_mfma_f32_16x16x32_bf16 v[184:187], v[104:107], v[72:75], v[184:187]
v_mfma_f32_16x16x32_bf16 v[188:191], v[108:111], v[72:75], v[188:191]
v_mul_f32 v52, v224, v143
v_mfma_f32_16x16x32_bf16 v[192:195], v[96:99], v[76:79], v[192:195]
v_mul_f32 v53, v225, v143
v_mfma_f32_16x16x32_bf16 v[196:199], v[100:103], v[76:79], v[196:199]
v_mfma_f32_16x16x32_bf16 v[200:203], v[104:107], v[76:79], v[200:203]
v_mul_f32 v54, v226, v143
v_mfma_f32_16x16x32_bf16 v[204:207], v[108:111], v[76:79], v[204:207]
v_mul_f32 v55, v227, v143
s_cmp_eq_u32 s38, 1
s_cbranch_scc1 Lcs_59
v_mfma_f32_16x16x32_bf16 v[208:211], v[96:99], v[216:219], v[208:211]
v_mfma_f32_16x16x32_bf16 v[212:215], v[100:103], v[216:219], v[212:215]
s_branch Lcj_60
Lcs_59:
v_mfma_f32_16x16x32_bf16 v[208:211], v[104:107], v[216:219], v[208:211]
v_mfma_f32_16x16x32_bf16 v[212:215], v[108:111], v[216:219], v[212:215]
Lcj_60:
s_waitcnt lgkmcnt(0)
s_barrier
v_mfma_f32_16x16x32_bf16 v[144:147], v[112:115], v[80:83], v[144:147]
v_fma_f32 v60, v60, v142, v52
ds_read_b128 v[64:67], v132 offset:32768
ds_read_b64_tr_b16 v[96:97], v134 offset:32768
v_mfma_f32_16x16x32_bf16 v[148:151], v[116:119], v[80:83], v[148:151]
v_fma_f32 v61, v61, v142, v53
ds_read_b64_tr_b16 v[98:99], v134 offset:33280
ds_read_b64_tr_b16 v[100:101], v135 offset:32768
v_mfma_f32_16x16x32_bf16 v[152:155], v[120:123], v[80:83], v[152:155]
v_fma_f32 v62, v62, v142, v54
ds_read_b64_tr_b16 v[102:103], v135 offset:33280
ds_read_b128 v[68:71], v132 offset:34816
v_mfma_f32_16x16x32_bf16 v[156:159], v[124:127], v[80:83], v[156:159]
ds_read_b64_tr_b16 v[104:105], v134 offset:40960
ds_read_b64_tr_b16 v[106:107], v134 offset:41472
v_mfma_f32_16x16x32_bf16 v[160:163], v[112:115], v[84:87], v[160:163]
v_fma_f32 v63, v63, v142, v55
ds_read_b64_tr_b16 v[108:109], v135 offset:40960
v_mfma_f32_16x16x32_bf16 v[164:167], v[116:119], v[84:87], v[164:167]
v_cvt_pk_bf16_f32 v48, v56, v57
ds_read_b64_tr_b16 v[110:111], v135 offset:41472
v_mfma_f32_16x16x32_bf16 v[168:171], v[120:123], v[84:87], v[168:171]
ds_read_b128 v[72:75], v132 offset:36864
v_mfma_f32_16x16x32_bf16 v[172:175], v[124:127], v[84:87], v[172:175]
v_cvt_pk_bf16_f32 v49, v58, v59
ds_read_b128 v[76:79], v132 offset:38912
v_mfma_f32_16x16x32_bf16 v[176:179], v[112:115], v[88:91], v[176:179]
v_cvt_pk_bf16_f32 v50, v60, v61
v_mfma_f32_16x16x32_bf16 v[180:183], v[116:119], v[88:91], v[180:183]
v_cvt_pk_bf16_f32 v51, v62, v63
v_mfma_f32_16x16x32_bf16 v[184:187], v[120:123], v[88:91], v[184:187]
v_mfma_f32_16x16x32_bf16 v[188:191], v[124:127], v[88:91], v[188:191]
s_mov_b32 s40, 86016
v_mfma_f32_16x16x32_bf16 v[192:195], v[112:115], v[92:95], v[192:195]
v_permlane16_swap_b32 v48, v50
v_mfma_f32_16x16x32_bf16 v[196:199], v[116:119], v[92:95], v[196:199]
v_mfma_f32_16x16x32_bf16 v[200:203], v[120:123], v[92:95], v[200:203]
v_permlane16_swap_b32 v49, v51
v_mfma_f32_16x16x32_bf16 v[204:207], v[124:127], v[92:95], v[204:207]
buffer_store_dwordx4 v[48:51], v251, s[16:19], s40 offen sc1
s_cmp_eq_u32 s38, 1
s_cbranch_scc1 Lcs_61
v_mfma_f32_16x16x32_bf16 v[208:211], v[112:115], v[216:219], v[208:211]
v_mfma_f32_16x16x32_bf16 v[212:215], v[116:119], v[216:219], v[212:215]
s_branch Lcj_62
Lcs_61:
v_mfma_f32_16x16x32_bf16 v[208:211], v[120:123], v[216:219], v[208:211]
v_mfma_f32_16x16x32_bf16 v[212:215], v[124:127], v[216:219], v[212:215]
Lcj_62:
s_waitcnt lgkmcnt(0)
v_mfma_f32_16x16x32_bf16 v[144:147], v[96:99], v[64:67], v[144:147]
ds_read_b128 v[80:83], v133 offset:32768
ds_read_b64_tr_b16 v[112:113], v134 offset:36864
v_mfma_f32_16x16x32_bf16 v[148:151], v[100:103], v[64:67], v[148:151]
ds_read_b64_tr_b16 v[114:115], v134 offset:37376
ds_read_b64_tr_b16 v[116:117], v135 offset:36864
v_mfma_f32_16x16x32_bf16 v[152:155], v[104:107], v[64:67], v[152:155]
ds_read_b64_tr_b16 v[118:119], v135 offset:37376
ds_read_b128 v[84:87], v133 offset:34816
v_mfma_f32_16x16x32_bf16 v[156:159], v[108:111], v[64:67], v[156:159]
ds_read_b64_tr_b16 v[120:121], v134 offset:45056
ds_read_b64_tr_b16 v[122:123], v134 offset:45568
v_mfma_f32_16x16x32_bf16 v[160:163], v[96:99], v[68:71], v[160:163]
ds_read_b64_tr_b16 v[124:125], v135 offset:45056
v_mfma_f32_16x16x32_bf16 v[164:167], v[100:103], v[68:71], v[164:167]
ds_read_b64_tr_b16 v[126:127], v135 offset:45568
v_mfma_f32_16x16x32_bf16 v[168:171], v[104:107], v[68:71], v[168:171]
ds_read_b128 v[88:91], v133 offset:36864
v_mfma_f32_16x16x32_bf16 v[172:175], v[108:111], v[68:71], v[172:175]
ds_read_b128 v[92:95], v133 offset:38912
v_mfma_f32_16x16x32_bf16 v[176:179], v[96:99], v[72:75], v[176:179]
v_mfma_f32_16x16x32_bf16 v[180:183], v[100:103], v[72:75], v[180:183]
v_mfma_f32_16x16x32_bf16 v[184:187], v[104:107], v[72:75], v[184:187]
v_mfma_f32_16x16x32_bf16 v[188:191], v[108:111], v[72:75], v[188:191]
v_mfma_f32_16x16x32_bf16 v[192:195], v[96:99], v[76:79], v[192:195]
v_mfma_f32_16x16x32_bf16 v[196:199], v[100:103], v[76:79], v[196:199]
v_mfma_f32_16x16x32_bf16 v[200:203], v[104:107], v[76:79], v[200:203]
v_mfma_f32_16x16x32_bf16 v[204:207], v[108:111], v[76:79], v[204:207]
s_cmp_eq_u32 s38, 1
s_cbranch_scc1 Lcs_63
v_mfma_f32_16x16x32_bf16 v[208:211], v[96:99], v[216:219], v[208:211]
v_mfma_f32_16x16x32_bf16 v[212:215], v[100:103], v[216:219], v[212:215]
s_branch Lcj_64
Lcs_63:
v_mfma_f32_16x16x32_bf16 v[208:211], v[104:107], v[216:219], v[208:211]
v_mfma_f32_16x16x32_bf16 v[212:215], v[108:111], v[216:219], v[212:215]
Lcj_64:
s_waitcnt lgkmcnt(0)
s_barrier
v_mfma_f32_16x16x32_bf16 v[144:147], v[112:115], v[80:83], v[144:147]
ds_read_b128 v[64:67], v128 offset:0
ds_read_b64_tr_b16 v[96:97], v130 offset:0
v_mfma_f32_16x16x32_bf16 v[148:151], v[116:119], v[80:83], v[148:151]
ds_read_b64_tr_b16 v[98:99], v130 offset:512
ds_read_b64_tr_b16 v[100:101], v131 offset:0
v_mfma_f32_16x16x32_bf16 v[152:155], v[120:123], v[80:83], v[152:155]
ds_read_b64_tr_b16 v[102:103], v131 offset:512
ds_read_b128 v[68:71], v128 offset:2048
v_mfma_f32_16x16x32_bf16 v[156:159], v[124:127], v[80:83], v[156:159]
ds_read_b64_tr_b16 v[104:105], v130 offset:8192
ds_read_b64_tr_b16 v[106:107], v130 offset:8704
v_mfma_f32_16x16x32_bf16 v[160:163], v[112:115], v[84:87], v[160:163]
ds_read_b64_tr_b16 v[108:109], v131 offset:8192
v_mfma_f32_16x16x32_bf16 v[164:167], v[116:119], v[84:87], v[164:167]
ds_read_b64_tr_b16 v[110:111], v131 offset:8704
v_mfma_f32_16x16x32_bf16 v[168:171], v[120:123], v[84:87], v[168:171]
ds_read_b128 v[72:75], v128 offset:4096
v_mfma_f32_16x16x32_bf16 v[172:175], v[124:127], v[84:87], v[172:175]
ds_read_b128 v[76:79], v128 offset:6144
v_mfma_f32_16x16x32_bf16 v[176:179], v[112:115], v[88:91], v[176:179]
v_mfma_f32_16x16x32_bf16 v[180:183], v[116:119], v[88:91], v[180:183]
v_mfma_f32_16x16x32_bf16 v[184:187], v[120:123], v[88:91], v[184:187]
v_mfma_f32_16x16x32_bf16 v[188:191], v[124:127], v[88:91], v[188:191]
v_mfma_f32_16x16x32_bf16 v[192:195], v[112:115], v[92:95], v[192:195]
v_mfma_f32_16x16x32_bf16 v[196:199], v[116:119], v[92:95], v[196:199]
v_mfma_f32_16x16x32_bf16 v[200:203], v[120:123], v[92:95], v[200:203]
v_mfma_f32_16x16x32_bf16 v[204:207], v[124:127], v[92:95], v[204:207]
s_cmp_eq_u32 s38, 1
s_cbranch_scc1 Lcs_65
v_mfma_f32_16x16x32_bf16 v[208:211], v[112:115], v[216:219], v[208:211]
v_mfma_f32_16x16x32_bf16 v[212:215], v[116:119], v[216:219], v[212:215]
s_branch Lcj_66
Lcs_65:
v_mfma_f32_16x16x32_bf16 v[208:211], v[120:123], v[216:219], v[208:211]
v_mfma_f32_16x16x32_bf16 v[212:215], v[124:127], v[216:219], v[212:215]
Lcj_66:
s_waitcnt lgkmcnt(0)
v_mfma_f32_16x16x32_bf16 v[144:147], v[96:99], v[64:67], v[144:147]
s_mov_b32 s16, s76
s_mov_b32 s17, s77
s_mov_b32 s18, 0x1000
s_mov_b32 s19, 0x20000
s_lshl_b32 s20, s36, 7
v_lshl_add_u32 v228, v246, 1, s20
buffer_load_ushort v220, v228, s[16:19], 0 offen offset:0
buffer_load_ushort v221, v228, s[16:19], 0 offen offset:32
buffer_load_ushort v222, v228, s[16:19], 0 offen offset:64
buffer_load_ushort v223, v228, s[16:19], 0 offen offset:96
ds_read_b128 v[80:83], v129 offset:0
ds_read_b64_tr_b16 v[112:113], v130 offset:4096
v_mfma_f32_16x16x32_bf16 v[148:151], v[100:103], v[64:67], v[148:151]
ds_read_b64_tr_b16 v[114:115], v130 offset:4608
ds_read_b64_tr_b16 v[116:117], v131 offset:4096
v_mfma_f32_16x16x32_bf16 v[152:155], v[104:107], v[64:67], v[152:155]
ds_read_b64_tr_b16 v[118:119], v131 offset:4608
ds_read_b128 v[84:87], v129 offset:2048
v_mfma_f32_16x16x32_bf16 v[156:159], v[108:111], v[64:67], v[156:159]
ds_read_b64_tr_b16 v[120:121], v130 offset:12288
ds_read_b64_tr_b16 v[122:123], v130 offset:12800
v_mfma_f32_16x16x32_bf16 v[160:163], v[96:99], v[68:71], v[160:163]
ds_read_b64_tr_b16 v[124:125], v131 offset:12288
v_mfma_f32_16x16x32_bf16 v[164:167], v[100:103], v[68:71], v[164:167]
ds_read_b64_tr_b16 v[126:127], v131 offset:12800
v_mfma_f32_16x16x32_bf16 v[168:171], v[104:107], v[68:71], v[168:171]
ds_read_b128 v[88:91], v129 offset:4096
v_mfma_f32_16x16x32_bf16 v[172:175], v[108:111], v[68:71], v[172:175]
ds_read_b128 v[92:95], v129 offset:6144
v_mfma_f32_16x16x32_bf16 v[176:179], v[96:99], v[72:75], v[176:179]
s_mov_b32 s12, s74
s_mov_b32 s13, s75
s_mov_b32 s14, 0x800000
s_mov_b32 s15, 0x20000
s_and_b32 s20, s37, 7
s_mul_i32 s20, s20, 32768
s_lshl_b32 s21, s36, 18
s_add_u32 s20, s20, s21
s_mul_i32 s21, s3, 8192
s_add_u32 s20, s20, s21
s_add_u32 s20, s20, 0
v_lshlrev_b32 v254, 7, v250
buffer_load_dword v255, v254, s[12:15], s20 offen
v_mfma_f32_16x16x32_bf16 v[180:183], v[100:103], v[72:75], v[180:183]
v_mfma_f32_16x16x32_bf16 v[184:187], v[104:107], v[72:75], v[184:187]
v_mfma_f32_16x16x32_bf16 v[188:191], v[108:111], v[72:75], v[188:191]
v_mfma_f32_16x16x32_bf16 v[192:195], v[96:99], v[76:79], v[192:195]
v_mfma_f32_16x16x32_bf16 v[196:199], v[100:103], v[76:79], v[196:199]
v_mfma_f32_16x16x32_bf16 v[200:203], v[104:107], v[76:79], v[200:203]
v_mfma_f32_16x16x32_bf16 v[204:207], v[108:111], v[76:79], v[204:207]
s_cmp_eq_u32 s38, 1
s_cbranch_scc1 Lcs_67
v_mfma_f32_16x16x32_bf16 v[208:211], v[96:99], v[216:219], v[208:211]
v_mfma_f32_16x16x32_bf16 v[212:215], v[100:103], v[216:219], v[212:215]
s_branch Lcj_68
Lcs_67:
v_mfma_f32_16x16x32_bf16 v[208:211], v[104:107], v[216:219], v[208:211]
v_mfma_f32_16x16x32_bf16 v[212:215], v[108:111], v[216:219], v[212:215]
Lcj_68:
s_waitcnt lgkmcnt(0)
s_barrier
v_mfma_f32_16x16x32_bf16 v[144:147], v[112:115], v[80:83], v[144:147]
ds_read_b128 v[64:67], v128 offset:32768
ds_read_b64_tr_b16 v[96:97], v130 offset:32768
v_mfma_f32_16x16x32_bf16 v[148:151], v[116:119], v[80:83], v[148:151]
ds_read_b64_tr_b16 v[98:99], v130 offset:33280
ds_read_b64_tr_b16 v[100:101], v131 offset:32768
v_mfma_f32_16x16x32_bf16 v[152:155], v[120:123], v[80:83], v[152:155]
ds_read_b64_tr_b16 v[102:103], v131 offset:33280
ds_read_b128 v[68:71], v128 offset:34816
v_mfma_f32_16x16x32_bf16 v[156:159], v[124:127], v[80:83], v[156:159]
ds_read_b64_tr_b16 v[104:105], v130 offset:40960
ds_read_b64_tr_b16 v[106:107], v130 offset:41472
v_mfma_f32_16x16x32_bf16 v[160:163], v[112:115], v[84:87], v[160:163]
ds_read_b64_tr_b16 v[108:109], v131 offset:40960
v_mfma_f32_16x16x32_bf16 v[164:167], v[116:119], v[84:87], v[164:167]
ds_read_b64_tr_b16 v[110:111], v131 offset:41472
v_mfma_f32_16x16x32_bf16 v[168:171], v[120:123], v[84:87], v[168:171]
ds_read_b128 v[72:75], v128 offset:36864
v_mfma_f32_16x16x32_bf16 v[172:175], v[124:127], v[84:87], v[172:175]
ds_read_b128 v[76:79], v128 offset:38912
v_mfma_f32_16x16x32_bf16 v[176:179], v[112:115], v[88:91], v[176:179]
v_mfma_f32_16x16x32_bf16 v[180:183], v[116:119], v[88:91], v[180:183]
v_mfma_f32_16x16x32_bf16 v[184:187], v[120:123], v[88:91], v[184:187]
v_mfma_f32_16x16x32_bf16 v[188:191], v[124:127], v[88:91], v[188:191]
v_mfma_f32_16x16x32_bf16 v[192:195], v[112:115], v[92:95], v[192:195]
v_mfma_f32_16x16x32_bf16 v[196:199], v[116:119], v[92:95], v[196:199]
v_mfma_f32_16x16x32_bf16 v[200:203], v[120:123], v[92:95], v[200:203]
v_mfma_f32_16x16x32_bf16 v[204:207], v[124:127], v[92:95], v[204:207]
s_cmp_eq_u32 s38, 1
s_cbranch_scc1 Lcs_69
v_mfma_f32_16x16x32_bf16 v[208:211], v[112:115], v[216:219], v[208:211]
v_mfma_f32_16x16x32_bf16 v[212:215], v[116:119], v[216:219], v[212:215]
s_branch Lcj_70
Lcs_69:
v_mfma_f32_16x16x32_bf16 v[208:211], v[120:123], v[216:219], v[208:211]
v_mfma_f32_16x16x32_bf16 v[212:215], v[124:127], v[216:219], v[212:215]
Lcj_70:
s_waitcnt lgkmcnt(0)
v_mfma_f32_16x16x32_bf16 v[144:147], v[96:99], v[64:67], v[144:147]
ds_read_b128 v[80:83], v129 offset:32768
ds_read_b64_tr_b16 v[112:113], v130 offset:36864
v_mfma_f32_16x16x32_bf16 v[148:151], v[100:103], v[64:67], v[148:151]
ds_read_b64_tr_b16 v[114:115], v130 offset:37376
ds_read_b64_tr_b16 v[116:117], v131 offset:36864
v_mfma_f32_16x16x32_bf16 v[152:155], v[104:107], v[64:67], v[152:155]
ds_read_b64_tr_b16 v[118:119], v131 offset:37376
ds_read_b128 v[84:87], v129 offset:34816
v_mfma_f32_16x16x32_bf16 v[156:159], v[108:111], v[64:67], v[156:159]
ds_read_b64_tr_b16 v[120:121], v130 offset:45056
ds_read_b64_tr_b16 v[122:123], v130 offset:45568
v_mfma_f32_16x16x32_bf16 v[160:163], v[96:99], v[68:71], v[160:163]
ds_read_b64_tr_b16 v[124:125], v131 offset:45056
v_mfma_f32_16x16x32_bf16 v[164:167], v[100:103], v[68:71], v[164:167]
ds_read_b64_tr_b16 v[126:127], v131 offset:45568
v_mfma_f32_16x16x32_bf16 v[168:171], v[104:107], v[68:71], v[168:171]
ds_read_b128 v[88:91], v129 offset:36864
v_mfma_f32_16x16x32_bf16 v[172:175], v[108:111], v[68:71], v[172:175]
ds_read_b128 v[92:95], v129 offset:38912
v_mfma_f32_16x16x32_bf16 v[176:179], v[96:99], v[72:75], v[176:179]
v_mfma_f32_16x16x32_bf16 v[180:183], v[100:103], v[72:75], v[180:183]
v_mfma_f32_16x16x32_bf16 v[184:187], v[104:107], v[72:75], v[184:187]
v_mfma_f32_16x16x32_bf16 v[188:191], v[108:111], v[72:75], v[188:191]
v_mfma_f32_16x16x32_bf16 v[192:195], v[96:99], v[76:79], v[192:195]
v_mfma_f32_16x16x32_bf16 v[196:199], v[100:103], v[76:79], v[196:199]
v_mfma_f32_16x16x32_bf16 v[200:203], v[104:107], v[76:79], v[200:203]
v_mfma_f32_16x16x32_bf16 v[204:207], v[108:111], v[76:79], v[204:207]
s_cmp_eq_u32 s38, 1
s_cbranch_scc1 Lcs_71
v_mfma_f32_16x16x32_bf16 v[208:211], v[96:99], v[216:219], v[208:211]
v_mfma_f32_16x16x32_bf16 v[212:215], v[100:103], v[216:219], v[212:215]
s_branch Lcj_72
Lcs_71:
v_mfma_f32_16x16x32_bf16 v[208:211], v[104:107], v[216:219], v[208:211]
v_mfma_f32_16x16x32_bf16 v[212:215], v[108:111], v[216:219], v[212:215]
Lcj_72:
s_waitcnt lgkmcnt(0)
s_barrier
v_mfma_f32_16x16x32_bf16 v[144:147], v[112:115], v[80:83], v[144:147]
ds_read_b128 v[64:67], v132 offset:0
ds_read_b64_tr_b16 v[96:97], v134 offset:0
v_mfma_f32_16x16x32_bf16 v[148:151], v[116:119], v[80:83], v[148:151]
ds_read_b64_tr_b16 v[98:99], v134 offset:512
ds_read_b64_tr_b16 v[100:101], v135 offset:0
v_mfma_f32_16x16x32_bf16 v[152:155], v[120:123], v[80:83], v[152:155]
ds_read_b64_tr_b16 v[102:103], v135 offset:512
ds_read_b128 v[68:71], v132 offset:2048
v_mfma_f32_16x16x32_bf16 v[156:159], v[124:127], v[80:83], v[156:159]
ds_read_b64_tr_b16 v[104:105], v134 offset:8192
ds_read_b64_tr_b16 v[106:107], v134 offset:8704
v_mfma_f32_16x16x32_bf16 v[160:163], v[112:115], v[84:87], v[160:163]
ds_read_b64_tr_b16 v[108:109], v135 offset:8192
v_mfma_f32_16x16x32_bf16 v[164:167], v[116:119], v[84:87], v[164:167]
ds_read_b64_tr_b16 v[110:111], v135 offset:8704
v_mfma_f32_16x16x32_bf16 v[168:171], v[120:123], v[84:87], v[168:171]
ds_read_b128 v[72:75], v132 offset:4096
v_mfma_f32_16x16x32_bf16 v[172:175], v[124:127], v[84:87], v[172:175]
ds_read_b128 v[76:79], v132 offset:6144
v_mfma_f32_16x16x32_bf16 v[176:179], v[112:115], v[88:91], v[176:179]
v_mfma_f32_16x16x32_bf16 v[180:183], v[116:119], v[88:91], v[180:183]
v_mfma_f32_16x16x32_bf16 v[184:187], v[120:123], v[88:91], v[184:187]
v_mfma_f32_16x16x32_bf16 v[188:191], v[124:127], v[88:91], v[188:191]
v_mfma_f32_16x16x32_bf16 v[192:195], v[112:115], v[92:95], v[192:195]
v_mfma_f32_16x16x32_bf16 v[196:199], v[116:119], v[92:95], v[196:199]
v_mfma_f32_16x16x32_bf16 v[200:203], v[120:123], v[92:95], v[200:203]
v_mfma_f32_16x16x32_bf16 v[204:207], v[124:127], v[92:95], v[204:207]
s_cmp_eq_u32 s38, 1
s_cbranch_scc1 Lcs_73
v_mfma_f32_16x16x32_bf16 v[208:211], v[112:115], v[216:219], v[208:211]
v_mfma_f32_16x16x32_bf16 v[212:215], v[116:119], v[216:219], v[212:215]
s_branch Lcj_74
Lcs_73:
v_mfma_f32_16x16x32_bf16 v[208:211], v[120:123], v[216:219], v[208:211]
v_mfma_f32_16x16x32_bf16 v[212:215], v[124:127], v[216:219], v[212:215]
Lcj_74:
s_waitcnt lgkmcnt(0)
v_mfma_f32_16x16x32_bf16 v[144:147], v[96:99], v[64:67], v[144:147]
ds_read_b128 v[80:83], v133 offset:0
ds_read_b64_tr_b16 v[112:113], v134 offset:4096
v_mfma_f32_16x16x32_bf16 v[148:151], v[100:103], v[64:67], v[148:151]
ds_read_b64_tr_b16 v[114:115], v134 offset:4608
ds_read_b64_tr_b16 v[116:117], v135 offset:4096
v_mfma_f32_16x16x32_bf16 v[152:155], v[104:107], v[64:67], v[152:155]
ds_read_b64_tr_b16 v[118:119], v135 offset:4608
ds_read_b128 v[84:87], v133 offset:2048
v_mfma_f32_16x16x32_bf16 v[156:159], v[108:111], v[64:67], v[156:159]
ds_read_b64_tr_b16 v[120:121], v134 offset:12288
ds_read_b64_tr_b16 v[122:123], v134 offset:12800
v_mfma_f32_16x16x32_bf16 v[160:163], v[96:99], v[68:71], v[160:163]
ds_read_b64_tr_b16 v[124:125], v135 offset:12288
v_mfma_f32_16x16x32_bf16 v[164:167], v[100:103], v[68:71], v[164:167]
ds_read_b64_tr_b16 v[126:127], v135 offset:12800
v_mfma_f32_16x16x32_bf16 v[168:171], v[104:107], v[68:71], v[168:171]
ds_read_b128 v[88:91], v133 offset:4096
v_mfma_f32_16x16x32_bf16 v[172:175], v[108:111], v[68:71], v[172:175]
ds_read_b128 v[92:95], v133 offset:6144
v_mfma_f32_16x16x32_bf16 v[176:179], v[96:99], v[72:75], v[176:179]
v_mfma_f32_16x16x32_bf16 v[180:183], v[100:103], v[72:75], v[180:183]
v_mfma_f32_16x16x32_bf16 v[184:187], v[104:107], v[72:75], v[184:187]
v_mfma_f32_16x16x32_bf16 v[188:191], v[108:111], v[72:75], v[188:191]
v_mfma_f32_16x16x32_bf16 v[192:195], v[96:99], v[76:79], v[192:195]
v_mfma_f32_16x16x32_bf16 v[196:199], v[100:103], v[76:79], v[196:199]
v_mfma_f32_16x16x32_bf16 v[200:203], v[104:107], v[76:79], v[200:203]
v_mfma_f32_16x16x32_bf16 v[204:207], v[108:111], v[76:79], v[204:207]
s_cmp_eq_u32 s38, 1
s_cbranch_scc1 Lcs_75
v_mfma_f32_16x16x32_bf16 v[208:211], v[96:99], v[216:219], v[208:211]
v_mfma_f32_16x16x32_bf16 v[212:215], v[100:103], v[216:219], v[212:215]
s_branch Lcj_76
Lcs_75:
v_mfma_f32_16x16x32_bf16 v[208:211], v[104:107], v[216:219], v[208:211]
v_mfma_f32_16x16x32_bf16 v[212:215], v[108:111], v[216:219], v[212:215]
Lcj_76:
s_waitcnt lgkmcnt(0)
s_barrier
v_mfma_f32_16x16x32_bf16 v[144:147], v[112:115], v[80:83], v[144:147]
ds_read_b128 v[64:67], v132 offset:32768
ds_read_b64_tr_b16 v[96:97], v134 offset:32768
v_mfma_f32_16x16x32_bf16 v[148:151], v[116:119], v[80:83], v[148:151]
ds_read_b64_tr_b16 v[98:99], v134 offset:33280
ds_read_b64_tr_b16 v[100:101], v135 offset:32768
v_mfma_f32_16x16x32_bf16 v[152:155], v[120:123], v[80:83], v[152:155]
ds_read_b64_tr_b16 v[102:103], v135 offset:33280
ds_read_b128 v[68:71], v132 offset:34816
v_mfma_f32_16x16x32_bf16 v[156:159], v[124:127], v[80:83], v[156:159]
ds_read_b64_tr_b16 v[104:105], v134 offset:40960
ds_read_b64_tr_b16 v[106:107], v134 offset:41472
v_mfma_f32_16x16x32_bf16 v[160:163], v[112:115], v[84:87], v[160:163]
ds_read_b64_tr_b16 v[108:109], v135 offset:40960
v_mfma_f32_16x16x32_bf16 v[164:167], v[116:119], v[84:87], v[164:167]
ds_read_b64_tr_b16 v[110:111], v135 offset:41472
v_mfma_f32_16x16x32_bf16 v[168:171], v[120:123], v[84:87], v[168:171]
ds_read_b128 v[72:75], v132 offset:36864
v_mfma_f32_16x16x32_bf16 v[172:175], v[124:127], v[84:87], v[172:175]
ds_read_b128 v[76:79], v132 offset:38912
v_mfma_f32_16x16x32_bf16 v[176:179], v[112:115], v[88:91], v[176:179]
v_mfma_f32_16x16x32_bf16 v[180:183], v[116:119], v[88:91], v[180:183]
v_mfma_f32_16x16x32_bf16 v[184:187], v[120:123], v[88:91], v[184:187]
v_mfma_f32_16x16x32_bf16 v[188:191], v[124:127], v[88:91], v[188:191]
v_mfma_f32_16x16x32_bf16 v[192:195], v[112:115], v[92:95], v[192:195]
v_mfma_f32_16x16x32_bf16 v[196:199], v[116:119], v[92:95], v[196:199]
v_mfma_f32_16x16x32_bf16 v[200:203], v[120:123], v[92:95], v[200:203]
v_mfma_f32_16x16x32_bf16 v[204:207], v[124:127], v[92:95], v[204:207]
s_cmp_eq_u32 s38, 1
s_cbranch_scc1 Lcs_77
v_mfma_f32_16x16x32_bf16 v[208:211], v[112:115], v[216:219], v[208:211]
v_mfma_f32_16x16x32_bf16 v[212:215], v[116:119], v[216:219], v[212:215]
s_branch Lcj_78
Lcs_77:
v_mfma_f32_16x16x32_bf16 v[208:211], v[120:123], v[216:219], v[208:211]
v_mfma_f32_16x16x32_bf16 v[212:215], v[124:127], v[216:219], v[212:215]
Lcj_78:
s_waitcnt lgkmcnt(0)
v_mfma_f32_16x16x32_bf16 v[144:147], v[96:99], v[64:67], v[144:147]
ds_read_b128 v[80:83], v133 offset:32768
ds_read_b64_tr_b16 v[112:113], v134 offset:36864
v_mfma_f32_16x16x32_bf16 v[148:151], v[100:103], v[64:67], v[148:151]
ds_read_b64_tr_b16 v[114:115], v134 offset:37376
ds_read_b64_tr_b16 v[116:117], v135 offset:36864
v_mfma_f32_16x16x32_bf16 v[152:155], v[104:107], v[64:67], v[152:155]
ds_read_b64_tr_b16 v[118:119], v135 offset:37376
ds_read_b128 v[84:87], v133 offset:34816
v_mfma_f32_16x16x32_bf16 v[156:159], v[108:111], v[64:67], v[156:159]
ds_read_b64_tr_b16 v[120:121], v134 offset:45056
ds_read_b64_tr_b16 v[122:123], v134 offset:45568
v_mfma_f32_16x16x32_bf16 v[160:163], v[96:99], v[68:71], v[160:163]
ds_read_b64_tr_b16 v[124:125], v135 offset:45056
v_mfma_f32_16x16x32_bf16 v[164:167], v[100:103], v[68:71], v[164:167]
ds_read_b64_tr_b16 v[126:127], v135 offset:45568
v_mfma_f32_16x16x32_bf16 v[168:171], v[104:107], v[68:71], v[168:171]
ds_read_b128 v[88:91], v133 offset:36864
v_mfma_f32_16x16x32_bf16 v[172:175], v[108:111], v[68:71], v[172:175]
ds_read_b128 v[92:95], v133 offset:38912
v_mfma_f32_16x16x32_bf16 v[176:179], v[96:99], v[72:75], v[176:179]
v_mfma_f32_16x16x32_bf16 v[180:183], v[100:103], v[72:75], v[180:183]
v_mfma_f32_16x16x32_bf16 v[184:187], v[104:107], v[72:75], v[184:187]
v_mfma_f32_16x16x32_bf16 v[188:191], v[108:111], v[72:75], v[188:191]
v_mfma_f32_16x16x32_bf16 v[192:195], v[96:99], v[76:79], v[192:195]
v_mfma_f32_16x16x32_bf16 v[196:199], v[100:103], v[76:79], v[196:199]
v_mfma_f32_16x16x32_bf16 v[200:203], v[104:107], v[76:79], v[200:203]
v_mfma_f32_16x16x32_bf16 v[204:207], v[108:111], v[76:79], v[204:207]
s_cmp_eq_u32 s38, 1
s_cbranch_scc1 Lcs_79
v_mfma_f32_16x16x32_bf16 v[208:211], v[96:99], v[216:219], v[208:211]
v_mfma_f32_16x16x32_bf16 v[212:215], v[100:103], v[216:219], v[212:215]
s_branch Lcj_80
Lcs_79:
v_mfma_f32_16x16x32_bf16 v[208:211], v[104:107], v[216:219], v[208:211]
v_mfma_f32_16x16x32_bf16 v[212:215], v[108:111], v[216:219], v[212:215]
Lcj_80:
s_waitcnt lgkmcnt(0)
v_mfma_f32_16x16x32_bf16 v[144:147], v[112:115], v[80:83], v[144:147]
v_mfma_f32_16x16x32_bf16 v[148:151], v[116:119], v[80:83], v[148:151]
v_mfma_f32_16x16x32_bf16 v[152:155], v[120:123], v[80:83], v[152:155]
v_mfma_f32_16x16x32_bf16 v[156:159], v[124:127], v[80:83], v[156:159]
v_mfma_f32_16x16x32_bf16 v[160:163], v[112:115], v[84:87], v[160:163]
v_mfma_f32_16x16x32_bf16 v[164:167], v[116:119], v[84:87], v[164:167]
v_mfma_f32_16x16x32_bf16 v[168:171], v[120:123], v[84:87], v[168:171]
v_mfma_f32_16x16x32_bf16 v[172:175], v[124:127], v[84:87], v[172:175]
v_mfma_f32_16x16x32_bf16 v[176:179], v[112:115], v[88:91], v[176:179]
v_mfma_f32_16x16x32_bf16 v[180:183], v[116:119], v[88:91], v[180:183]
v_mfma_f32_16x16x32_bf16 v[184:187], v[120:123], v[88:91], v[184:187]
v_mfma_f32_16x16x32_bf16 v[188:191], v[124:127], v[88:91], v[188:191]
v_mfma_f32_16x16x32_bf16 v[192:195], v[112:115], v[92:95], v[192:195]
v_mfma_f32_16x16x32_bf16 v[196:199], v[116:119], v[92:95], v[196:199]
v_mfma_f32_16x16x32_bf16 v[200:203], v[120:123], v[92:95], v[200:203]
v_mfma_f32_16x16x32_bf16 v[204:207], v[124:127], v[92:95], v[204:207]
s_cmp_eq_u32 s38, 1
s_cbranch_scc1 Lcs_81
v_mfma_f32_16x16x32_bf16 v[208:211], v[112:115], v[216:219], v[208:211]
v_mfma_f32_16x16x32_bf16 v[212:215], v[116:119], v[216:219], v[212:215]
s_branch Lcj_82
Lcs_81:
v_mfma_f32_16x16x32_bf16 v[208:211], v[120:123], v[216:219], v[208:211]
v_mfma_f32_16x16x32_bf16 v[212:215], v[124:127], v[216:219], v[212:215]
Lcj_82:
s_lshl_b32 s20, s38, 8
s_lshl_b32 s21, s39, 7
s_add_u32 s20, s20, s21
s_add_u32 s20, s20, 148992
v_lshl_add_u32 v230, v247, 4, s20
s_mov_b32 s22, 0x00010001
s_mov_b32 s23, 0x00010001
s_mov_b64 exec, s[22:23]
s_nop 2
ds_write_b128 v230, v[208:211]
ds_write_b128 v230, v[212:215] offset:64
s_mov_b64 exec, -1
s_waitcnt lgkmcnt(0)
s_barrier
s_mul_i32 s20, s37, 7
s_lshl_b32 s21, s3, 1
s_add_u32 s20, s20, s21
v_lshlrev_b32 v228, 4, v250
s_add_u32 s22, s20, 0
s_lshl_b32 s23, s22, 16
s_add_u32 s23, s23, 12582912
s_cmp_lt_u32 s22, 54
s_cselect_b32 s23, s23, 0x40000000
v_add_u32 v242, s23, v228
s_add_u32 s22, s20, 1
s_lshl_b32 s23, s22, 16
s_add_u32 s23, s23, 12582912
s_cmp_lt_u32 s22, 54
s_cselect_b32 s23, s23, 0x40000000
s_cmp_eq_u32 s3, 3
s_cselect_b32 s23, 0x40000000, s23
v_add_u32 v243, s23, v228
s_mov_b32 s45, 0
s_and_b32 s45, s45, 15
s_add_u32 s41, s45, 0
s_and_b32 s41, s41, 15
s_lshl_b32 s41, s41, 12
buffer_load_dwordx4 v[0:3], v242, s[8:11], s41 offen offset:0 sc1
buffer_load_dwordx4 v[4:7], v243, s[8:11], s41 offen offset:0 sc1
buffer_load_dwordx4 v[8:11], v242, s[8:11], s41 offen offset:1024 sc1
buffer_load_dwordx4 v[12:15], v243, s[8:11], s41 offen offset:1024 sc1
buffer_load_dwordx4 v[16:19], v242, s[8:11], s41 offen offset:2048 sc1
buffer_load_dwordx4 v[20:23], v243, s[8:11], s41 offen offset:2048 sc1
buffer_load_dwordx4 v[24:27], v242, s[8:11], s41 offen offset:3072 sc1
buffer_load_dwordx4 v[28:31], v243, s[8:11], s41 offen offset:3072 sc1
s_add_u32 s41, s45, 1
s_and_b32 s41, s41, 15
s_lshl_b32 s41, s41, 12
buffer_load_dwordx4 v[32:35], v242, s[8:11], s41 offen offset:0 sc1
buffer_load_dwordx4 v[36:39], v243, s[8:11], s41 offen offset:0 sc1
buffer_load_dwordx4 v[40:43], v242, s[8:11], s41 offen offset:1024 sc1
buffer_load_dwordx4 v[44:47], v243, s[8:11], s41 offen offset:1024 sc1
buffer_load_dwordx4 v[48:51], v242, s[8:11], s41 offen offset:2048 sc1
buffer_load_dwordx4 v[52:55], v243, s[8:11], s41 offen offset:2048 sc1
buffer_load_dwordx4 v[56:59], v242, s[8:11], s41 offen offset:3072 sc1
buffer_load_dwordx4 v[60:63], v243, s[8:11], s41 offen offset:3072 sc1
s_add_u32 s41, s45, 2
s_and_b32 s41, s41, 15
s_lshl_b32 s41, s41, 12
buffer_load_dwordx4 v[64:67], v242, s[8:11], s41 offen offset:0 sc1
buffer_load_dwordx4 v[68:71], v243, s[8:11], s41 offen offset:0 sc1
buffer_load_dwordx4 v[72:75], v242, s[8:11], s41 offen offset:1024 sc1
buffer_load_dwordx4 v[76:79], v243, s[8:11], s41 offen offset:1024 sc1
buffer_load_dwordx4 v[80:83], v242, s[8:11], s41 offen offset:2048 sc1
buffer_load_dwordx4 v[84:87], v243, s[8:11], s41 offen offset:2048 sc1
buffer_load_dwordx4 v[88:91], v242, s[8:11], s41 offen offset:3072 sc1
buffer_load_dwordx4 v[92:95], v243, s[8:11], s41 offen offset:3072 sc1
v_lshlrev_b32 v230, 4, v247
s_lshl_b32 s20, s39, 7
s_add_u32 s20, s20, 148992
v_add_u32 v230, s20, v230
ds_read_b128 v[96:99], v230 offset:0
ds_read_b128 v[100:103], v230 offset:64
ds_read_b128 v[104:107], v230 offset:256
ds_read_b128 v[108:111], v230 offset:320
s_cmp_lt_u32 s33, 15
s_cselect_b32 s20, 0x10000000, 0
s_mov_b32 s16, s84
s_mov_b32 s17, s85
s_mov_b32 s18, s20
s_mov_b32 s19, 0x20000
s_waitcnt lgkmcnt(0)
s_mov_b32 s20, 0
v_pk_mul_f32 v[112:113], v[96:97], v[136:137] op_sel:[0,1] op_sel_hi:[1,1]
v_pk_mul_f32 v[114:115], v[98:99], v[136:137] op_sel:[0,1] op_sel_hi:[1,1]
v_pk_fma_f32 v[144:145], v[144:145], v[136:137], v[112:113] op_sel:[0,0,0] op_sel_hi:[1,0,1]
v_pk_fma_f32 v[146:147], v[146:147], v[136:137], v[114:115] op_sel:[0,0,0] op_sel_hi:[1,0,1]
v_pk_mul_f32 v[112:113], v[100:101], v[136:137] op_sel:[0,1] op_sel_hi:[1,1]
v_pk_mul_f32 v[114:115], v[102:103], v[136:137] op_sel:[0,1] op_sel_hi:[1,1]
v_pk_fma_f32 v[148:149], v[148:149], v[136:137], v[112:113] op_sel:[0,0,0] op_sel_hi:[1,0,1]
v_pk_fma_f32 v[150:151], v[150:151], v[136:137], v[114:115] op_sel:[0,0,0] op_sel_hi:[1,0,1]
v_cvt_pk_bf16_f32 v116, v144, v145
v_cvt_pk_bf16_f32 v117, v146, v147
v_cvt_pk_bf16_f32 v118, v148, v149
v_cvt_pk_bf16_f32 v119, v150, v151
s_nop 1
v_permlane16_swap_b32 v116, v118
v_permlane16_swap_b32 v117, v119
buffer_store_dwordx4 v[116:119], v252, s[16:19], s20 offen offset:0 sc1
v_pk_mul_f32 v[112:113], v[104:105], v[136:137] op_sel:[0,1] op_sel_hi:[1,1]
v_pk_mul_f32 v[114:115], v[106:107], v[136:137] op_sel:[0,1] op_sel_hi:[1,1]
v_pk_fma_f32 v[152:153], v[152:153], v[136:137], v[112:113] op_sel:[0,0,0] op_sel_hi:[1,0,1]
v_pk_fma_f32 v[154:155], v[154:155], v[136:137], v[114:115] op_sel:[0,0,0] op_sel_hi:[1,0,1]
v_pk_mul_f32 v[112:113], v[108:109], v[136:137] op_sel:[0,1] op_sel_hi:[1,1]
v_pk_mul_f32 v[114:115], v[110:111], v[136:137] op_sel:[0,1] op_sel_hi:[1,1]
v_pk_fma_f32 v[156:157], v[156:157], v[136:137], v[112:113] op_sel:[0,0,0] op_sel_hi:[1,0,1]
v_pk_fma_f32 v[158:159], v[158:159], v[136:137], v[114:115] op_sel:[0,0,0] op_sel_hi:[1,0,1]
v_cvt_pk_bf16_f32 v120, v152, v153
v_cvt_pk_bf16_f32 v121, v154, v155
v_cvt_pk_bf16_f32 v122, v156, v157
v_cvt_pk_bf16_f32 v123, v158, v159
s_nop 1
v_permlane16_swap_b32 v120, v122
v_permlane16_swap_b32 v121, v123
buffer_store_dwordx4 v[120:123], v252, s[16:19], s20 offen offset:2048 sc1
s_mov_b32 s20, 61440
v_pk_mul_f32 v[112:113], v[96:97], v[138:139] op_sel:[0,1] op_sel_hi:[1,1]
v_pk_mul_f32 v[114:115], v[98:99], v[138:139] op_sel:[0,1] op_sel_hi:[1,1]
v_pk_fma_f32 v[160:161], v[160:161], v[138:139], v[112:113] op_sel:[0,0,0] op_sel_hi:[1,0,1]
v_pk_fma_f32 v[162:163], v[162:163], v[138:139], v[114:115] op_sel:[0,0,0] op_sel_hi:[1,0,1]
v_pk_mul_f32 v[112:113], v[100:101], v[138:139] op_sel:[0,1] op_sel_hi:[1,1]
v_pk_mul_f32 v[114:115], v[102:103], v[138:139] op_sel:[0,1] op_sel_hi:[1,1]
v_pk_fma_f32 v[164:165], v[164:165], v[138:139], v[112:113] op_sel:[0,0,0] op_sel_hi:[1,0,1]
v_pk_fma_f32 v[166:167], v[166:167], v[138:139], v[114:115] op_sel:[0,0,0] op_sel_hi:[1,0,1]
v_cvt_pk_bf16_f32 v116, v160, v161
v_cvt_pk_bf16_f32 v117, v162, v163
v_cvt_pk_bf16_f32 v118, v164, v165
v_cvt_pk_bf16_f32 v119, v166, v167
s_nop 1
v_permlane16_swap_b32 v116, v118
v_permlane16_swap_b32 v117, v119
buffer_store_dwordx4 v[116:119], v252, s[16:19], s20 offen offset:0 sc1
v_pk_mul_f32 v[112:113], v[104:105], v[138:139] op_sel:[0,1] op_sel_hi:[1,1]
v_pk_mul_f32 v[114:115], v[106:107], v[138:139] op_sel:[0,1] op_sel_hi:[1,1]
v_pk_fma_f32 v[168:169], v[168:169], v[138:139], v[112:113] op_sel:[0,0,0] op_sel_hi:[1,0,1]
v_pk_fma_f32 v[170:171], v[170:171], v[138:139], v[114:115] op_sel:[0,0,0] op_sel_hi:[1,0,1]
v_pk_mul_f32 v[112:113], v[108:109], v[138:139] op_sel:[0,1] op_sel_hi:[1,1]
v_pk_mul_f32 v[114:115], v[110:111], v[138:139] op_sel:[0,1] op_sel_hi:[1,1]
v_pk_fma_f32 v[172:173], v[172:173], v[138:139], v[112:113] op_sel:[0,0,0] op_sel_hi:[1,0,1]
v_pk_fma_f32 v[174:175], v[174:175], v[138:139], v[114:115] op_sel:[0,0,0] op_sel_hi:[1,0,1]
v_cvt_pk_bf16_f32 v120, v168, v169
v_cvt_pk_bf16_f32 v121, v170, v171
v_cvt_pk_bf16_f32 v122, v172, v173
v_cvt_pk_bf16_f32 v123, v174, v175
s_nop 1
v_permlane16_swap_b32 v120, v122
v_permlane16_swap_b32 v121, v123
buffer_store_dwordx4 v[120:123], v252, s[16:19], s20 offen offset:2048 sc1
s_mov_b32 s20, 122880
v_pk_mul_f32 v[112:113], v[96:97], v[140:141] op_sel:[0,1] op_sel_hi:[1,1]
v_pk_mul_f32 v[114:115], v[98:99], v[140:141] op_sel:[0,1] op_sel_hi:[1,1]
v_pk_fma_f32 v[176:177], v[176:177], v[140:141], v[112:113] op_sel:[0,0,0] op_sel_hi:[1,0,1]
v_pk_fma_f32 v[178:179], v[178:179], v[140:141], v[114:115] op_sel:[0,0,0] op_sel_hi:[1,0,1]
v_pk_mul_f32 v[112:113], v[100:101], v[140:141] op_sel:[0,1] op_sel_hi:[1,1]
v_pk_mul_f32 v[114:115], v[102:103], v[140:141] op_sel:[0,1] op_sel_hi:[1,1]
v_pk_fma_f32 v[180:181], v[180:181], v[140:141], v[112:113] op_sel:[0,0,0] op_sel_hi:[1,0,1]
v_pk_fma_f32 v[182:183], v[182:183], v[140:141], v[114:115] op_sel:[0,0,0] op_sel_hi:[1,0,1]
v_cvt_pk_bf16_f32 v116, v176, v177
v_cvt_pk_bf16_f32 v117, v178, v179
v_cvt_pk_bf16_f32 v118, v180, v181
v_cvt_pk_bf16_f32 v119, v182, v183
s_nop 1
v_permlane16_swap_b32 v116, v118
v_permlane16_swap_b32 v117, v119
buffer_store_dwordx4 v[116:119], v252, s[16:19], s20 offen offset:0 sc1
v_pk_mul_f32 v[112:113], v[104:105], v[140:141] op_sel:[0,1] op_sel_hi:[1,1]
v_pk_mul_f32 v[114:115], v[106:107], v[140:141] op_sel:[0,1] op_sel_hi:[1,1]
v_pk_fma_f32 v[184:185], v[184:185], v[140:141], v[112:113] op_sel:[0,0,0] op_sel_hi:[1,0,1]
v_pk_fma_f32 v[186:187], v[186:187], v[140:141], v[114:115] op_sel:[0,0,0] op_sel_hi:[1,0,1]
v_pk_mul_f32 v[112:113], v[108:109], v[140:141] op_sel:[0,1] op_sel_hi:[1,1]
v_pk_mul_f32 v[114:115], v[110:111], v[140:141] op_sel:[0,1] op_sel_hi:[1,1]
v_pk_fma_f32 v[188:189], v[188:189], v[140:141], v[112:113] op_sel:[0,0,0] op_sel_hi:[1,0,1]
v_pk_fma_f32 v[190:191], v[190:191], v[140:141], v[114:115] op_sel:[0,0,0] op_sel_hi:[1,0,1]
v_cvt_pk_bf16_f32 v120, v184, v185
v_cvt_pk_bf16_f32 v121, v186, v187
v_cvt_pk_bf16_f32 v122, v188, v189
v_cvt_pk_bf16_f32 v123, v190, v191
s_nop 1
v_permlane16_swap_b32 v120, v122
v_permlane16_swap_b32 v121, v123
buffer_store_dwordx4 v[120:123], v252, s[16:19], s20 offen offset:2048 sc1
s_mov_b32 s20, 184320
v_pk_mul_f32 v[112:113], v[96:97], v[142:143] op_sel:[0,1] op_sel_hi:[1,1]
v_pk_mul_f32 v[114:115], v[98:99], v[142:143] op_sel:[0,1] op_sel_hi:[1,1]
v_pk_fma_f32 v[192:193], v[192:193], v[142:143], v[112:113] op_sel:[0,0,0] op_sel_hi:[1,0,1]
v_pk_fma_f32 v[194:195], v[194:195], v[142:143], v[114:115] op_sel:[0,0,0] op_sel_hi:[1,0,1]
v_pk_mul_f32 v[112:113], v[100:101], v[142:143] op_sel:[0,1] op_sel_hi:[1,1]
v_pk_mul_f32 v[114:115], v[102:103], v[142:143] op_sel:[0,1] op_sel_hi:[1,1]
v_pk_fma_f32 v[196:197], v[196:197], v[142:143], v[112:113] op_sel:[0,0,0] op_sel_hi:[1,0,1]
v_pk_fma_f32 v[198:199], v[198:199], v[142:143], v[114:115] op_sel:[0,0,0] op_sel_hi:[1,0,1]
v_cvt_pk_bf16_f32 v116, v192, v193
v_cvt_pk_bf16_f32 v117, v194, v195
v_cvt_pk_bf16_f32 v118, v196, v197
v_cvt_pk_bf16_f32 v119, v198, v199
s_nop 1
v_permlane16_swap_b32 v116, v118
v_permlane16_swap_b32 v117, v119
buffer_store_dwordx4 v[116:119], v252, s[16:19], s20 offen offset:0 sc1
v_pk_mul_f32 v[112:113], v[104:105], v[142:143] op_sel:[0,1] op_sel_hi:[1,1]
v_pk_mul_f32 v[114:115], v[106:107], v[142:143] op_sel:[0,1] op_sel_hi:[1,1]
v_pk_fma_f32 v[200:201], v[200:201], v[142:143], v[112:113] op_sel:[0,0,0] op_sel_hi:[1,0,1]
v_pk_fma_f32 v[202:203], v[202:203], v[142:143], v[114:115] op_sel:[0,0,0] op_sel_hi:[1,0,1]
v_pk_mul_f32 v[112:113], v[108:109], v[142:143] op_sel:[0,1] op_sel_hi:[1,1]
v_pk_mul_f32 v[114:115], v[110:111], v[142:143] op_sel:[0,1] op_sel_hi:[1,1]
v_pk_fma_f32 v[204:205], v[204:205], v[142:143], v[112:113] op_sel:[0,0,0] op_sel_hi:[1,0,1]
v_pk_fma_f32 v[206:207], v[206:207], v[142:143], v[114:115] op_sel:[0,0,0] op_sel_hi:[1,0,1]
v_cvt_pk_bf16_f32 v120, v200, v201
v_cvt_pk_bf16_f32 v121, v202, v203
v_cvt_pk_bf16_f32 v122, v204, v205
v_cvt_pk_bf16_f32 v123, v206, v207
s_nop 1
v_permlane16_swap_b32 v120, v122
v_permlane16_swap_b32 v121, v123
buffer_store_dwordx4 v[120:123], v252, s[16:19], s20 offen offset:2048 sc1
s_waitcnt vmcnt(33)
v_lshlrev_b32 v220, 16, v220
v_lshlrev_b32 v221, 16, v221
v_lshlrev_b32 v222, 16, v222
v_lshlrev_b32 v223, 16, v223
v_mov_b32 v144, v220
v_mov_b32 v145, v220
v_mov_b32 v146, v220
v_mov_b32 v147, v220
v_mov_b32 v148, v220
v_mov_b32 v149, v220
v_mov_b32 v150, v220
v_mov_b32 v151, v220
v_mov_b32 v152, v221
v_mov_b32 v153, v221
v_mov_b32 v154, v221
v_mov_b32 v155, v221
v_mov_b32 v156, v221
v_mov_b32 v157, v221
v_mov_b32 v158, v221
v_mov_b32 v159, v221
v_mov_b32 v160, v222
v_mov_b32 v161, v222
v_mov_b32 v162, v222
v_mov_b32 v163, v222
v_mov_b32 v164, v222
v_mov_b32 v165, v222
v_mov_b32 v166, v222
v_mov_b32 v167, v222
v_mov_b32 v168, v223
v_mov_b32 v169, v223
v_mov_b32 v170, v223
v_mov_b32 v171, v223
v_mov_b32 v172, v223
v_mov_b32 v173, v223
v_mov_b32 v174, v223
v_mov_b32 v175, v223
v_lshrrev_b32 v114, 1, v246
v_xor_b32 v114, v114, v247
v_lshlrev_b32 v115, 7, v246
v_lshl_add_u32 v136, v114, 4, v115
v_xor_b32 v137, 64, v136
v_add_u32 v138, 65536, v136
v_add_u32 v139, 65536, v137
v_lshlrev_b32 v116, 8, v253
v_lshl_add_u32 v116, v246, 4, v116
s_lshl_b32 s20, s36, 2
s_mul_i32 s20, s20, 28672
s_mul_i32 s21, s37, 14
s_lshl_b32 s22, s3, 2
s_add_u32 s21, s21, s22
s_lshl_b32 s23, s21, 8
s_add_u32 s20, s20, s23
v_add_u32 v116, s20, v116
v_add_u32 v117, s22, v253
v_add_u32 v118, s21, v253
v_cmp_gt_u32 vcc, 14, v117
v_mov_b32 v119, 0x40000000
s_nop 0
v_cndmask_b32 v116, v119, v116, vcc
v_cmp_gt_u32 vcc, 108, v118
s_nop 0
s_nop 0
v_cndmask_b32 v116, v119, v116, vcc
v_add_u32 v244, 8388608, v116
v_add_u32 v245, 16777216, v116
v_mov_b32 v240, 0xbdd2d3e8
v_mov_b32 v241, 0xc0135761
s_barrier
ds_read_b128 v[176:179], v136 offset:0
ds_read_b128 v[180:183], v136 offset:2048
ds_read_b128 v[184:187], v136 offset:4096
ds_read_b128 v[188:191], v136 offset:6144
s_waitcnt lgkmcnt(0)
s_waitcnt vmcnt(30)
v_mfma_f32_16x16x32_bf16 v[144:147], v[0:3], v[176:179], v[144:147]
ds_read_b128 v[192:195], v137 offset:0
ds_read_b128 v[196:199], v137 offset:2048
v_mfma_f32_16x16x32_bf16 v[152:155], v[0:3], v[180:183], v[152:155]
ds_read_b128 v[200:203], v137 offset:4096
v_mfma_f32_16x16x32_bf16 v[160:163], v[0:3], v[184:187], v[160:163]
ds_read_b128 v[204:207], v137 offset:6144
v_mfma_f32_16x16x32_bf16 v[168:171], v[0:3], v[188:191], v[168:171]
s_add_u32 s41, s45, 3
s_and_b32 s41, s41, 15
s_lshl_b32 s41, s41, 12
buffer_load_dwordx4 v[0:3], v242, s[8:11], s41 offen offset:0 sc1
v_mfma_f32_16x16x32_bf16 v[148:151], v[4:7], v[176:179], v[148:151]
v_mfma_f32_16x16x32_bf16 v[156:159], v[4:7], v[180:183], v[156:159]
v_mfma_f32_16x16x32_bf16 v[164:167], v[4:7], v[184:187], v[164:167]
v_mfma_f32_16x16x32_bf16 v[172:175], v[4:7], v[188:191], v[172:175]
buffer_load_dwordx4 v[4:7], v243, s[8:11], s41 offen offset:0 sc1
s_waitcnt lgkmcnt(0)
s_waitcnt vmcnt(30)
v_mfma_f32_16x16x32_bf16 v[144:147], v[8:11], v[192:195], v[144:147]
ds_read_b128 v[176:179], v136 offset:8192
ds_read_b128 v[180:183], v136 offset:10240
v_mfma_f32_16x16x32_bf16 v[152:155], v[8:11], v[196:199], v[152:155]
ds_read_b128 v[184:187], v136 offset:12288
v_mfma_f32_16x16x32_bf16 v[160:163], v[8:11], v[200:203], v[160:163]
ds_read_b128 v[188:191], v136 offset:14336
v_mfma_f32_16x16x32_bf16 v[168:171], v[8:11], v[204:207], v[168:171]
buffer_load_dwordx4 v[8:11], v242, s[8:11], s41 offen offset:1024 sc1
v_mfma_f32_16x16x32_bf16 v[148:151], v[12:15], v[192:195], v[148:151]
v_mfma_f32_16x16x32_bf16 v[156:159], v[12:15], v[196:199], v[156:159]
v_mfma_f32_16x16x32_bf16 v[164:167], v[12:15], v[200:203], v[164:167]
v_mfma_f32_16x16x32_bf16 v[172:175], v[12:15], v[204:207], v[172:175]
buffer_load_dwordx4 v[12:15], v243, s[8:11], s41 offen offset:1024 sc1
s_waitcnt lgkmcnt(0)
s_waitcnt vmcnt(30)
v_mfma_f32_16x16x32_bf16 v[144:147], v[16:19], v[176:179], v[144:147]
ds_read_b128 v[192:195], v137 offset:8192
ds_read_b128 v[196:199], v137 offset:10240
v_mfma_f32_16x16x32_bf16 v[152:155], v[16:19], v[180:183], v[152:155]
ds_read_b128 v[200:203], v137 offset:12288
v_mfma_f32_16x16x32_bf16 v[160:163], v[16:19], v[184:187], v[160:163]
ds_read_b128 v[204:207], v137 offset:14336
v_mfma_f32_16x16x32_bf16 v[168:171], v[16:19], v[188:191], v[168:171]
buffer_load_dwordx4 v[16:19], v242, s[8:11], s41 offen offset:2048 sc1
v_mfma_f32_16x16x32_bf16 v[148:151], v[20:23], v[176:179], v[148:151]
v_mfma_f32_16x16x32_bf16 v[156:159], v[20:23], v[180:183], v[156:159]
v_mfma_f32_16x16x32_bf16 v[164:167], v[20:23], v[184:187], v[164:167]
v_mfma_f32_16x16x32_bf16 v[172:175], v[20:23], v[188:191], v[172:175]
buffer_load_dwordx4 v[20:23], v243, s[8:11], s41 offen offset:2048 sc1
s_waitcnt lgkmcnt(0)
s_barrier
s_waitcnt vmcnt(30)
v_mfma_f32_16x16x32_bf16 v[144:147], v[24:27], v[192:195], v[144:147]
ds_read_b128 v[176:179], v136 offset:16384
ds_read_b128 v[180:183], v136 offset:18432
v_mfma_f32_16x16x32_bf16 v[152:155], v[24:27], v[196:199], v[152:155]
ds_read_b128 v[184:187], v136 offset:20480
v_mfma_f32_16x16x32_bf16 v[160:163], v[24:27], v[200:203], v[160:163]
ds_read_b128 v[188:191], v136 offset:22528
v_mfma_f32_16x16x32_bf16 v[168:171], v[24:27], v[204:207], v[168:171]
buffer_load_dwordx4 v[24:27], v242, s[8:11], s41 offen offset:3072 sc1
v_mfma_f32_16x16x32_bf16 v[148:151], v[28:31], v[192:195], v[148:151]
v_mfma_f32_16x16x32_bf16 v[156:159], v[28:31], v[196:199], v[156:159]
v_mfma_f32_16x16x32_bf16 v[164:167], v[28:31], v[200:203], v[164:167]
v_mfma_f32_16x16x32_bf16 v[172:175], v[28:31], v[204:207], v[172:175]
buffer_load_dwordx4 v[28:31], v243, s[8:11], s41 offen offset:3072 sc1
s_waitcnt lgkmcnt(0)
s_waitcnt vmcnt(30)
v_mfma_f32_16x16x32_bf16 v[144:147], v[32:35], v[176:179], v[144:147]
ds_read_b128 v[192:195], v137 offset:16384
ds_read_b128 v[196:199], v137 offset:18432
v_mfma_f32_16x16x32_bf16 v[152:155], v[32:35], v[180:183], v[152:155]
ds_read_b128 v[200:203], v137 offset:20480
v_mfma_f32_16x16x32_bf16 v[160:163], v[32:35], v[184:187], v[160:163]
ds_read_b128 v[204:207], v137 offset:22528
v_mfma_f32_16x16x32_bf16 v[168:171], v[32:35], v[188:191], v[168:171]
s_add_u32 s41, s45, 4
s_and_b32 s41, s41, 15
s_lshl_b32 s41, s41, 12
buffer_load_dwordx4 v[32:35], v242, s[8:11], s41 offen offset:0 sc1
v_mfma_f32_16x16x32_bf16 v[148:151], v[36:39], v[176:179], v[148:151]
v_mfma_f32_16x16x32_bf16 v[156:159], v[36:39], v[180:183], v[156:159]
v_mfma_f32_16x16x32_bf16 v[164:167], v[36:39], v[184:187], v[164:167]
v_mfma_f32_16x16x32_bf16 v[172:175], v[36:39], v[188:191], v[172:175]
buffer_load_dwordx4 v[36:39], v243, s[8:11], s41 offen offset:0 sc1
s_waitcnt lgkmcnt(0)
s_waitcnt vmcnt(30)
v_mfma_f32_16x16x32_bf16 v[144:147], v[40:43], v[192:195], v[144:147]
ds_read_b128 v[176:179], v136 offset:24576
ds_read_b128 v[180:183], v136 offset:26624
v_mfma_f32_16x16x32_bf16 v[152:155], v[40:43], v[196:199], v[152:155]
ds_read_b128 v[184:187], v136 offset:28672
v_mfma_f32_16x16x32_bf16 v[160:163], v[40:43], v[200:203], v[160:163]
ds_read_b128 v[188:191], v136 offset:30720
v_mfma_f32_16x16x32_bf16 v[168:171], v[40:43], v[204:207], v[168:171]
buffer_load_dwordx4 v[40:43], v242, s[8:11], s41 offen offset:1024 sc1
v_mfma_f32_16x16x32_bf16 v[148:151], v[44:47], v[192:195], v[148:151]
v_mfma_f32_16x16x32_bf16 v[156:159], v[44:47], v[196:199], v[156:159]
v_mfma_f32_16x16x32_bf16 v[164:167], v[44:47], v[200:203], v[164:167]
v_mfma_f32_16x16x32_bf16 v[172:175], v[44:47], v[204:207], v[172:175]
buffer_load_dwordx4 v[44:47], v243, s[8:11], s41 offen offset:1024 sc1
s_waitcnt lgkmcnt(0)
s_waitcnt vmcnt(30)
v_mfma_f32_16x16x32_bf16 v[144:147], v[48:51], v[176:179], v[144:147]
ds_read_b128 v[192:195], v137 offset:24576
ds_read_b128 v[196:199], v137 offset:26624
v_mfma_f32_16x16x32_bf16 v[152:155], v[48:51], v[180:183], v[152:155]
ds_read_b128 v[200:203], v137 offset:28672
v_mfma_f32_16x16x32_bf16 v[160:163], v[48:51], v[184:187], v[160:163]
ds_read_b128 v[204:207], v137 offset:30720
v_mfma_f32_16x16x32_bf16 v[168:171], v[48:51], v[188:191], v[168:171]
buffer_load_dwordx4 v[48:51], v242, s[8:11], s41 offen offset:2048 sc1
v_mfma_f32_16x16x32_bf16 v[148:151], v[52:55], v[176:179], v[148:151]
v_mfma_f32_16x16x32_bf16 v[156:159], v[52:55], v[180:183], v[156:159]
v_mfma_f32_16x16x32_bf16 v[164:167], v[52:55], v[184:187], v[164:167]
v_mfma_f32_16x16x32_bf16 v[172:175], v[52:55], v[188:191], v[172:175]
buffer_load_dwordx4 v[52:55], v243, s[8:11], s41 offen offset:2048 sc1
s_waitcnt lgkmcnt(0)
s_waitcnt vmcnt(14)
s_barrier
v_mfma_f32_16x16x32_bf16 v[144:147], v[56:59], v[192:195], v[144:147]
ds_read_b128 v[176:179], v136 offset:32768
ds_read_b128 v[180:183], v136 offset:34816
v_mfma_f32_16x16x32_bf16 v[152:155], v[56:59], v[196:199], v[152:155]
ds_read_b128 v[184:187], v136 offset:36864
v_mfma_f32_16x16x32_bf16 v[160:163], v[56:59], v[200:203], v[160:163]
ds_read_b128 v[188:191], v136 offset:38912
v_mfma_f32_16x16x32_bf16 v[168:171], v[56:59], v[204:207], v[168:171]
buffer_load_dwordx4 v[56:59], v242, s[8:11], s41 offen offset:3072 sc1
v_mfma_f32_16x16x32_bf16 v[148:151], v[60:63], v[192:195], v[148:151]
v_mfma_f32_16x16x32_bf16 v[156:159], v[60:63], v[196:199], v[156:159]
v_mfma_f32_16x16x32_bf16 v[164:167], v[60:63], v[200:203], v[164:167]
v_mfma_f32_16x16x32_bf16 v[172:175], v[60:63], v[204:207], v[172:175]
buffer_load_dwordx4 v[60:63], v243, s[8:11], s41 offen offset:3072 sc1
s_waitcnt lgkmcnt(0)
v_mfma_f32_16x16x32_bf16 v[144:147], v[64:67], v[176:179], v[144:147]
ds_read_b128 v[192:195], v137 offset:32768
ds_read_b128 v[196:199], v137 offset:34816
v_mfma_f32_16x16x32_bf16 v[152:155], v[64:67], v[180:183], v[152:155]
ds_read_b128 v[200:203], v137 offset:36864
v_mfma_f32_16x16x32_bf16 v[160:163], v[64:67], v[184:187], v[160:163]
ds_read_b128 v[204:207], v137 offset:38912
v_mfma_f32_16x16x32_bf16 v[168:171], v[64:67], v[188:191], v[168:171]
s_add_u32 s41, s45, 5
s_and_b32 s41, s41, 15
s_lshl_b32 s41, s41, 12
buffer_load_dwordx4 v[64:67], v242, s[8:11], s41 offen offset:0 sc1
v_mfma_f32_16x16x32_bf16 v[148:151], v[68:71], v[176:179], v[148:151]
v_mfma_f32_16x16x32_bf16 v[156:159], v[68:71], v[180:183], v[156:159]
v_mfma_f32_16x16x32_bf16 v[164:167], v[68:71], v[184:187], v[164:167]
v_mfma_f32_16x16x32_bf16 v[172:175], v[68:71], v[188:191], v[172:175]
buffer_load_dwordx4 v[68:71], v243, s[8:11], s41 offen offset:0 sc1
s_waitcnt lgkmcnt(0)
v_mfma_f32_16x16x32_bf16 v[144:147], v[72:75], v[192:195], v[144:147]
ds_read_b128 v[176:179], v136 offset:40960
ds_read_b128 v[180:183], v136 offset:43008
v_mfma_f32_16x16x32_bf16 v[152:155], v[72:75], v[196:199], v[152:155]
ds_read_b128 v[184:187], v136 offset:45056
v_mfma_f32_16x16x32_bf16 v[160:163], v[72:75], v[200:203], v[160:163]
ds_read_b128 v[188:191], v136 offset:47104
v_mfma_f32_16x16x32_bf16 v[168:171], v[72:75], v[204:207], v[168:171]
buffer_load_dwordx4 v[72:75], v242, s[8:11], s41 offen offset:1024 sc1
v_mfma_f32_16x16x32_bf16 v[148:151], v[76:79], v[192:195], v[148:151]
v_mfma_f32_16x16x32_bf16 v[156:159], v[76:79], v[196:199], v[156:159]
v_mfma_f32_16x16x32_bf16 v[164:167], v[76:79], v[200:203], v[164:167]
v_mfma_f32_16x16x32_bf16 v[172:175], v[76:79], v[204:207], v[172:175]
buffer_load_dwordx4 v[76:79], v243, s[8:11], s41 offen offset:1024 sc1
s_waitcnt lgkmcnt(0)
v_mfma_f32_16x16x32_bf16 v[144:147], v[80:83], v[176:179], v[144:147]
ds_read_b128 v[192:195], v137 offset:40960
ds_read_b128 v[196:199], v137 offset:43008
v_mfma_f32_16x16x32_bf16 v[152:155], v[80:83], v[180:183], v[152:155]
ds_read_b128 v[200:203], v137 offset:45056
v_mfma_f32_16x16x32_bf16 v[160:163], v[80:83], v[184:187], v[160:163]
ds_read_b128 v[204:207], v137 offset:47104
v_mfma_f32_16x16x32_bf16 v[168:171], v[80:83], v[188:191], v[168:171]
buffer_load_dwordx4 v[80:83], v242, s[8:11], s41 offen offset:2048 sc1
v_mfma_f32_16x16x32_bf16 v[148:151], v[84:87], v[176:179], v[148:151]
v_mfma_f32_16x16x32_bf16 v[156:159], v[84:87], v[180:183], v[156:159]
v_mfma_f32_16x16x32_bf16 v[164:167], v[84:87], v[184:187], v[164:167]
v_mfma_f32_16x16x32_bf16 v[172:175], v[84:87], v[188:191], v[172:175]
buffer_load_dwordx4 v[84:87], v243, s[8:11], s41 offen offset:2048 sc1
s_waitcnt lgkmcnt(0)
s_barrier
v_mfma_f32_16x16x32_bf16 v[144:147], v[88:91], v[192:195], v[144:147]
ds_read_b128 v[176:179], v136 offset:49152
ds_read_b128 v[180:183], v136 offset:51200
v_mfma_f32_16x16x32_bf16 v[152:155], v[88:91], v[196:199], v[152:155]
ds_read_b128 v[184:187], v136 offset:53248
v_mfma_f32_16x16x32_bf16 v[160:163], v[88:91], v[200:203], v[160:163]
ds_read_b128 v[188:191], v136 offset:55296
v_mfma_f32_16x16x32_bf16 v[168:171], v[88:91], v[204:207], v[168:171]
buffer_load_dwordx4 v[88:91], v242, s[8:11], s41 offen offset:3072 sc1
v_mfma_f32_16x16x32_bf16 v[148:151], v[92:95], v[192:195], v[148:151]
v_mfma_f32_16x16x32_bf16 v[156:159], v[92:95], v[196:199], v[156:159]
v_mfma_f32_16x16x32_bf16 v[164:167], v[92:95], v[200:203], v[164:167]
v_mfma_f32_16x16x32_bf16 v[172:175], v[92:95], v[204:207], v[172:175]
buffer_load_dwordx4 v[92:95], v243, s[8:11], s41 offen offset:3072 sc1
s_waitcnt lgkmcnt(0)
s_waitcnt vmcnt(22)
v_mfma_f32_16x16x32_bf16 v[144:147], v[0:3], v[176:179], v[144:147]
ds_read_b128 v[192:195], v137 offset:49152
ds_read_b128 v[196:199], v137 offset:51200
v_mfma_f32_16x16x32_bf16 v[152:155], v[0:3], v[180:183], v[152:155]
ds_read_b128 v[200:203], v137 offset:53248
v_mfma_f32_16x16x32_bf16 v[160:163], v[0:3], v[184:187], v[160:163]
ds_read_b128 v[204:207], v137 offset:55296
v_mfma_f32_16x16x32_bf16 v[168:171], v[0:3], v[188:191], v[168:171]
s_add_u32 s41, s45, 6
s_and_b32 s41, s41, 15
s_lshl_b32 s41, s41, 12
buffer_load_dwordx4 v[0:3], v242, s[8:11], s41 offen offset:0 sc1
v_mfma_f32_16x16x32_bf16 v[148:151], v[4:7], v[176:179], v[148:151]
v_mfma_f32_16x16x32_bf16 v[156:159], v[4:7], v[180:183], v[156:159]
v_mfma_f32_16x16x32_bf16 v[164:167], v[4:7], v[184:187], v[164:167]
v_mfma_f32_16x16x32_bf16 v[172:175], v[4:7], v[188:191], v[172:175]
buffer_load_dwordx4 v[4:7], v243, s[8:11], s41 offen offset:0 sc1
s_waitcnt lgkmcnt(0)
s_waitcnt vmcnt(22)
v_mfma_f32_16x16x32_bf16 v[144:147], v[8:11], v[192:195], v[144:147]
ds_read_b128 v[176:179], v136 offset:57344
ds_read_b128 v[180:183], v136 offset:59392
v_mfma_f32_16x16x32_bf16 v[152:155], v[8:11], v[196:199], v[152:155]
ds_read_b128 v[184:187], v136 offset:61440
v_mfma_f32_16x16x32_bf16 v[160:163], v[8:11], v[200:203], v[160:163]
ds_read_b128 v[188:191], v136 offset:63488
v_mfma_f32_16x16x32_bf16 v[168:171], v[8:11], v[204:207], v[168:171]
buffer_load_dwordx4 v[8:11], v242, s[8:11], s41 offen offset:1024 sc1
v_mfma_f32_16x16x32_bf16 v[148:151], v[12:15], v[192:195], v[148:151]
v_mfma_f32_16x16x32_bf16 v[156:159], v[12:15], v[196:199], v[156:159]
v_mfma_f32_16x16x32_bf16 v[164:167], v[12:15], v[200:203], v[164:167]
v_mfma_f32_16x16x32_bf16 v[172:175], v[12:15], v[204:207], v[172:175]
buffer_load_dwordx4 v[12:15], v243, s[8:11], s41 offen offset:1024 sc1
s_waitcnt lgkmcnt(0)
s_waitcnt vmcnt(22)
v_mfma_f32_16x16x32_bf16 v[144:147], v[16:19], v[176:179], v[144:147]
ds_read_b128 v[192:195], v137 offset:57344
ds_read_b128 v[196:199], v137 offset:59392
v_mfma_f32_16x16x32_bf16 v[152:155], v[16:19], v[180:183], v[152:155]
ds_read_b128 v[200:203], v137 offset:61440
v_mfma_f32_16x16x32_bf16 v[160:163], v[16:19], v[184:187], v[160:163]
ds_read_b128 v[204:207], v137 offset:63488
v_mfma_f32_16x16x32_bf16 v[168:171], v[16:19], v[188:191], v[168:171]
buffer_load_dwordx4 v[16:19], v242, s[8:11], s41 offen offset:2048 sc1
v_mfma_f32_16x16x32_bf16 v[148:151], v[20:23], v[176:179], v[148:151]
v_mfma_f32_16x16x32_bf16 v[156:159], v[20:23], v[180:183], v[156:159]
v_mfma_f32_16x16x32_bf16 v[164:167], v[20:23], v[184:187], v[164:167]
v_mfma_f32_16x16x32_bf16 v[172:175], v[20:23], v[188:191], v[172:175]
buffer_load_dwordx4 v[20:23], v243, s[8:11], s41 offen offset:2048 sc1
s_waitcnt lgkmcnt(0)
s_barrier
s_waitcnt vmcnt(22)
v_mfma_f32_16x16x32_bf16 v[144:147], v[24:27], v[192:195], v[144:147]
ds_read_b128 v[176:179], v138 offset:0
ds_read_b128 v[180:183], v138 offset:2048
v_mfma_f32_16x16x32_bf16 v[152:155], v[24:27], v[196:199], v[152:155]
ds_read_b128 v[184:187], v138 offset:4096
v_mfma_f32_16x16x32_bf16 v[160:163], v[24:27], v[200:203], v[160:163]
ds_read_b128 v[188:191], v138 offset:6144
v_mfma_f32_16x16x32_bf16 v[168:171], v[24:27], v[204:207], v[168:171]
buffer_load_dwordx4 v[24:27], v242, s[8:11], s41 offen offset:3072 sc1
v_mfma_f32_16x16x32_bf16 v[148:151], v[28:31], v[192:195], v[148:151]
v_mfma_f32_16x16x32_bf16 v[156:159], v[28:31], v[196:199], v[156:159]
v_mfma_f32_16x16x32_bf16 v[164:167], v[28:31], v[200:203], v[164:167]
v_mfma_f32_16x16x32_bf16 v[172:175], v[28:31], v[204:207], v[172:175]
buffer_load_dwordx4 v[28:31], v243, s[8:11], s41 offen offset:3072 sc1
s_waitcnt lgkmcnt(0)
s_waitcnt vmcnt(22)
v_mfma_f32_16x16x32_bf16 v[144:147], v[32:35], v[176:179], v[144:147]
ds_read_b128 v[192:195], v139 offset:0
ds_read_b128 v[196:199], v139 offset:2048
v_mfma_f32_16x16x32_bf16 v[152:155], v[32:35], v[180:183], v[152:155]
ds_read_b128 v[200:203], v139 offset:4096
v_mfma_f32_16x16x32_bf16 v[160:163], v[32:35], v[184:187], v[160:163]
ds_read_b128 v[204:207], v139 offset:6144
v_mfma_f32_16x16x32_bf16 v[168:171], v[32:35], v[188:191], v[168:171]
s_add_u32 s41, s45, 7
s_and_b32 s41, s41, 15
s_lshl_b32 s41, s41, 12
buffer_load_dwordx4 v[32:35], v242, s[8:11], s41 offen offset:0 sc1
v_mfma_f32_16x16x32_bf16 v[148:151], v[36:39], v[176:179], v[148:151]
v_mfma_f32_16x16x32_bf16 v[156:159], v[36:39], v[180:183], v[156:159]
v_mfma_f32_16x16x32_bf16 v[164:167], v[36:39], v[184:187], v[164:167]
v_mfma_f32_16x16x32_bf16 v[172:175], v[36:39], v[188:191], v[172:175]
buffer_load_dwordx4 v[36:39], v243, s[8:11], s41 offen offset:0 sc1
s_waitcnt lgkmcnt(0)
s_waitcnt vmcnt(22)
v_mfma_f32_16x16x32_bf16 v[144:147], v[40:43], v[192:195], v[144:147]
ds_read_b128 v[176:179], v138 offset:8192
ds_read_b128 v[180:183], v138 offset:10240
v_mfma_f32_16x16x32_bf16 v[152:155], v[40:43], v[196:199], v[152:155]
ds_read_b128 v[184:187], v138 offset:12288
v_mfma_f32_16x16x32_bf16 v[160:163], v[40:43], v[200:203], v[160:163]
ds_read_b128 v[188:191], v138 offset:14336
v_mfma_f32_16x16x32_bf16 v[168:171], v[40:43], v[204:207], v[168:171]
buffer_load_dwordx4 v[40:43], v242, s[8:11], s41 offen offset:1024 sc1
v_mfma_f32_16x16x32_bf16 v[148:151], v[44:47], v[192:195], v[148:151]
v_mfma_f32_16x16x32_bf16 v[156:159], v[44:47], v[196:199], v[156:159]
v_mfma_f32_16x16x32_bf16 v[164:167], v[44:47], v[200:203], v[164:167]
v_mfma_f32_16x16x32_bf16 v[172:175], v[44:47], v[204:207], v[172:175]
buffer_load_dwordx4 v[44:47], v243, s[8:11], s41 offen offset:1024 sc1
s_waitcnt lgkmcnt(0)
s_waitcnt vmcnt(22)
v_mfma_f32_16x16x32_bf16 v[144:147], v[48:51], v[176:179], v[144:147]
ds_read_b128 v[192:195], v139 offset:8192
ds_read_b128 v[196:199], v139 offset:10240
v_mfma_f32_16x16x32_bf16 v[152:155], v[48:51], v[180:183], v[152:155]
ds_read_b128 v[200:203], v139 offset:12288
v_mfma_f32_16x16x32_bf16 v[160:163], v[48:51], v[184:187], v[160:163]
ds_read_b128 v[204:207], v139 offset:14336
v_mfma_f32_16x16x32_bf16 v[168:171], v[48:51], v[188:191], v[168:171]
buffer_load_dwordx4 v[48:51], v242, s[8:11], s41 offen offset:2048 sc1
v_mfma_f32_16x16x32_bf16 v[148:151], v[52:55], v[176:179], v[148:151]
v_mfma_f32_16x16x32_bf16 v[156:159], v[52:55], v[180:183], v[156:159]
v_mfma_f32_16x16x32_bf16 v[164:167], v[52:55], v[184:187], v[164:167]
v_mfma_f32_16x16x32_bf16 v[172:175], v[52:55], v[188:191], v[172:175]
buffer_load_dwordx4 v[52:55], v243, s[8:11], s41 offen offset:2048 sc1
s_waitcnt lgkmcnt(0)
s_barrier
s_waitcnt vmcnt(22)
v_mfma_f32_16x16x32_bf16 v[144:147], v[56:59], v[192:195], v[144:147]
ds_read_b128 v[176:179], v136 offset:0
ds_read_b128 v[180:183], v136 offset:2048
v_mfma_f32_16x16x32_bf16 v[152:155], v[56:59], v[196:199], v[152:155]
ds_read_b128 v[184:187], v136 offset:4096
v_mfma_f32_16x16x32_bf16 v[160:163], v[56:59], v[200:203], v[160:163]
ds_read_b128 v[188:191], v136 offset:6144
v_mfma_f32_16x16x32_bf16 v[168:171], v[56:59], v[204:207], v[168:171]
buffer_load_dwordx4 v[56:59], v242, s[8:11], s41 offen offset:3072 sc1
v_mfma_f32_16x16x32_bf16 v[148:151], v[60:63], v[192:195], v[148:151]
v_mfma_f32_16x16x32_bf16 v[156:159], v[60:63], v[196:199], v[156:159]
v_mfma_f32_16x16x32_bf16 v[164:167], v[60:63], v[200:203], v[164:167]
v_mfma_f32_16x16x32_bf16 v[172:175], v[60:63], v[204:207], v[172:175]
buffer_load_dwordx4 v[60:63], v243, s[8:11], s41 offen offset:3072 sc1
s_waitcnt lgkmcnt(0)
s_waitcnt vmcnt(22)
v_mfma_f32_16x16x32_bf16 v[144:147], v[64:67], v[176:179], v[144:147]
ds_read_b128 v[192:195], v137 offset:0
ds_read_b128 v[196:199], v137 offset:2048
v_mfma_f32_16x16x32_bf16 v[152:155], v[64:67], v[180:183], v[152:155]
ds_read_b128 v[200:203], v137 offset:4096
v_mfma_f32_16x16x32_bf16 v[160:163], v[64:67], v[184:187], v[160:163]
ds_read_b128 v[204:207], v137 offset:6144
v_mfma_f32_16x16x32_bf16 v[168:171], v[64:67], v[188:191], v[168:171]
s_add_u32 s41, s45, 8
s_and_b32 s41, s41, 15
s_lshl_b32 s41, s41, 12
buffer_load_dwordx4 v[64:67], v242, s[8:11], s41 offen offset:0 sc1
v_mfma_f32_16x16x32_bf16 v[148:151], v[68:71], v[176:179], v[148:151]
v_mfma_f32_16x16x32_bf16 v[156:159], v[68:71], v[180:183], v[156:159]
v_mfma_f32_16x16x32_bf16 v[164:167], v[68:71], v[184:187], v[164:167]
v_mfma_f32_16x16x32_bf16 v[172:175], v[68:71], v[188:191], v[172:175]
buffer_load_dwordx4 v[68:71], v243, s[8:11], s41 offen offset:0 sc1
s_waitcnt lgkmcnt(0)
s_waitcnt vmcnt(22)
v_mfma_f32_16x16x32_bf16 v[144:147], v[72:75], v[192:195], v[144:147]
ds_read_b128 v[176:179], v136 offset:8192
ds_read_b128 v[180:183], v136 offset:10240
v_mfma_f32_16x16x32_bf16 v[152:155], v[72:75], v[196:199], v[152:155]
ds_read_b128 v[184:187], v136 offset:12288
v_mfma_f32_16x16x32_bf16 v[160:163], v[72:75], v[200:203], v[160:163]
ds_read_b128 v[188:191], v136 offset:14336
v_mfma_f32_16x16x32_bf16 v[168:171], v[72:75], v[204:207], v[168:171]
buffer_load_dwordx4 v[72:75], v242, s[8:11], s41 offen offset:1024 sc1
v_mfma_f32_16x16x32_bf16 v[148:151], v[76:79], v[192:195], v[148:151]
v_mfma_f32_16x16x32_bf16 v[156:159], v[76:79], v[196:199], v[156:159]
v_mfma_f32_16x16x32_bf16 v[164:167], v[76:79], v[200:203], v[164:167]
v_mfma_f32_16x16x32_bf16 v[172:175], v[76:79], v[204:207], v[172:175]
buffer_load_dwordx4 v[76:79], v243, s[8:11], s41 offen offset:1024 sc1
s_waitcnt lgkmcnt(0)
s_waitcnt vmcnt(22)
v_mfma_f32_16x16x32_bf16 v[144:147], v[80:83], v[176:179], v[144:147]
ds_read_b128 v[192:195], v137 offset:8192
ds_read_b128 v[196:199], v137 offset:10240
v_mfma_f32_16x16x32_bf16 v[152:155], v[80:83], v[180:183], v[152:155]
ds_read_b128 v[200:203], v137 offset:12288
v_mfma_f32_16x16x32_bf16 v[160:163], v[80:83], v[184:187], v[160:163]
ds_read_b128 v[204:207], v137 offset:14336
v_mfma_f32_16x16x32_bf16 v[168:171], v[80:83], v[188:191], v[168:171]
buffer_load_dwordx4 v[80:83], v242, s[8:11], s41 offen offset:2048 sc1
v_mfma_f32_16x16x32_bf16 v[148:151], v[84:87], v[176:179], v[148:151]
v_mfma_f32_16x16x32_bf16 v[156:159], v[84:87], v[180:183], v[156:159]
v_mfma_f32_16x16x32_bf16 v[164:167], v[84:87], v[184:187], v[164:167]
v_mfma_f32_16x16x32_bf16 v[172:175], v[84:87], v[188:191], v[172:175]
buffer_load_dwordx4 v[84:87], v243, s[8:11], s41 offen offset:2048 sc1
s_waitcnt lgkmcnt(0)
s_barrier
s_waitcnt vmcnt(22)
v_mfma_f32_16x16x32_bf16 v[144:147], v[88:91], v[192:195], v[144:147]
ds_read_b128 v[176:179], v136 offset:16384
ds_read_b128 v[180:183], v136 offset:18432
v_mfma_f32_16x16x32_bf16 v[152:155], v[88:91], v[196:199], v[152:155]
ds_read_b128 v[184:187], v136 offset:20480
v_mfma_f32_16x16x32_bf16 v[160:163], v[88:91], v[200:203], v[160:163]
ds_read_b128 v[188:191], v136 offset:22528
v_mfma_f32_16x16x32_bf16 v[168:171], v[88:91], v[204:207], v[168:171]
buffer_load_dwordx4 v[88:91], v242, s[8:11], s41 offen offset:3072 sc1
v_mfma_f32_16x16x32_bf16 v[148:151], v[92:95], v[192:195], v[148:151]
v_mfma_f32_16x16x32_bf16 v[156:159], v[92:95], v[196:199], v[156:159]
v_mfma_f32_16x16x32_bf16 v[164:167], v[92:95], v[200:203], v[164:167]
v_mfma_f32_16x16x32_bf16 v[172:175], v[92:95], v[204:207], v[172:175]
buffer_load_dwordx4 v[92:95], v243, s[8:11], s41 offen offset:3072 sc1
s_waitcnt lgkmcnt(0)
s_waitcnt vmcnt(22)
v_mfma_f32_16x16x32_bf16 v[144:147], v[0:3], v[176:179], v[144:147]
ds_read_b128 v[192:195], v137 offset:16384
ds_read_b128 v[196:199], v137 offset:18432
v_mfma_f32_16x16x32_bf16 v[152:155], v[0:3], v[180:183], v[152:155]
ds_read_b128 v[200:203], v137 offset:20480
v_mfma_f32_16x16x32_bf16 v[160:163], v[0:3], v[184:187], v[160:163]
ds_read_b128 v[204:207], v137 offset:22528
v_mfma_f32_16x16x32_bf16 v[168:171], v[0:3], v[188:191], v[168:171]
s_add_u32 s41, s45, 9
s_and_b32 s41, s41, 15
s_lshl_b32 s41, s41, 12
buffer_load_dwordx4 v[0:3], v242, s[8:11], s41 offen offset:0 sc1
v_mfma_f32_16x16x32_bf16 v[148:151], v[4:7], v[176:179], v[148:151]
v_mfma_f32_16x16x32_bf16 v[156:159], v[4:7], v[180:183], v[156:159]
v_mfma_f32_16x16x32_bf16 v[164:167], v[4:7], v[184:187], v[164:167]
v_mfma_f32_16x16x32_bf16 v[172:175], v[4:7], v[188:191], v[172:175]
buffer_load_dwordx4 v[4:7], v243, s[8:11], s41 offen offset:0 sc1
s_waitcnt lgkmcnt(0)
s_waitcnt vmcnt(22)
v_mfma_f32_16x16x32_bf16 v[144:147], v[8:11], v[192:195], v[144:147]
ds_read_b128 v[176:179], v136 offset:24576
ds_read_b128 v[180:183], v136 offset:26624
v_mfma_f32_16x16x32_bf16 v[152:155], v[8:11], v[196:199], v[152:155]
ds_read_b128 v[184:187], v136 offset:28672
v_mfma_f32_16x16x32_bf16 v[160:163], v[8:11], v[200:203], v[160:163]
ds_read_b128 v[188:191], v136 offset:30720
v_mfma_f32_16x16x32_bf16 v[168:171], v[8:11], v[204:207], v[168:171]
buffer_load_dwordx4 v[8:11], v242, s[8:11], s41 offen offset:1024 sc1
v_mfma_f32_16x16x32_bf16 v[148:151], v[12:15], v[192:195], v[148:151]
v_mfma_f32_16x16x32_bf16 v[156:159], v[12:15], v[196:199], v[156:159]
v_mfma_f32_16x16x32_bf16 v[164:167], v[12:15], v[200:203], v[164:167]
v_mfma_f32_16x16x32_bf16 v[172:175], v[12:15], v[204:207], v[172:175]
buffer_load_dwordx4 v[12:15], v243, s[8:11], s41 offen offset:1024 sc1
s_waitcnt lgkmcnt(0)
s_waitcnt vmcnt(22)
v_mfma_f32_16x16x32_bf16 v[144:147], v[16:19], v[176:179], v[144:147]
ds_read_b128 v[192:195], v137 offset:24576
ds_read_b128 v[196:199], v137 offset:26624
v_mfma_f32_16x16x32_bf16 v[152:155], v[16:19], v[180:183], v[152:155]
ds_read_b128 v[200:203], v137 offset:28672
v_mfma_f32_16x16x32_bf16 v[160:163], v[16:19], v[184:187], v[160:163]
ds_read_b128 v[204:207], v137 offset:30720
v_mfma_f32_16x16x32_bf16 v[168:171], v[16:19], v[188:191], v[168:171]
buffer_load_dwordx4 v[16:19], v242, s[8:11], s41 offen offset:2048 sc1
v_mfma_f32_16x16x32_bf16 v[148:151], v[20:23], v[176:179], v[148:151]
v_mfma_f32_16x16x32_bf16 v[156:159], v[20:23], v[180:183], v[156:159]
v_mfma_f32_16x16x32_bf16 v[164:167], v[20:23], v[184:187], v[164:167]
v_mfma_f32_16x16x32_bf16 v[172:175], v[20:23], v[188:191], v[172:175]
buffer_load_dwordx4 v[20:23], v243, s[8:11], s41 offen offset:2048 sc1
s_waitcnt lgkmcnt(0)
s_barrier
s_waitcnt vmcnt(22)
v_mfma_f32_16x16x32_bf16 v[144:147], v[24:27], v[192:195], v[144:147]
ds_read_b128 v[176:179], v136 offset:32768
ds_read_b128 v[180:183], v136 offset:34816
v_mfma_f32_16x16x32_bf16 v[152:155], v[24:27], v[196:199], v[152:155]
ds_read_b128 v[184:187], v136 offset:36864
v_mfma_f32_16x16x32_bf16 v[160:163], v[24:27], v[200:203], v[160:163]
ds_read_b128 v[188:191], v136 offset:38912
v_mfma_f32_16x16x32_bf16 v[168:171], v[24:27], v[204:207], v[168:171]
buffer_load_dwordx4 v[24:27], v242, s[8:11], s41 offen offset:3072 sc1
v_mfma_f32_16x16x32_bf16 v[148:151], v[28:31], v[192:195], v[148:151]
v_mfma_f32_16x16x32_bf16 v[156:159], v[28:31], v[196:199], v[156:159]
v_mfma_f32_16x16x32_bf16 v[164:167], v[28:31], v[200:203], v[164:167]
v_mfma_f32_16x16x32_bf16 v[172:175], v[28:31], v[204:207], v[172:175]
buffer_load_dwordx4 v[28:31], v243, s[8:11], s41 offen offset:3072 sc1
s_waitcnt lgkmcnt(0)
s_waitcnt vmcnt(22)
v_mfma_f32_16x16x32_bf16 v[144:147], v[32:35], v[176:179], v[144:147]
ds_read_b128 v[192:195], v137 offset:32768
ds_read_b128 v[196:199], v137 offset:34816
v_mfma_f32_16x16x32_bf16 v[152:155], v[32:35], v[180:183], v[152:155]
ds_read_b128 v[200:203], v137 offset:36864
v_mfma_f32_16x16x32_bf16 v[160:163], v[32:35], v[184:187], v[160:163]
ds_read_b128 v[204:207], v137 offset:38912
v_mfma_f32_16x16x32_bf16 v[168:171], v[32:35], v[188:191], v[168:171]
s_add_u32 s41, s45, 10
s_and_b32 s41, s41, 15
s_lshl_b32 s41, s41, 12
buffer_load_dwordx4 v[32:35], v242, s[8:11], s41 offen offset:0 sc1
v_mfma_f32_16x16x32_bf16 v[148:151], v[36:39], v[176:179], v[148:151]
v_mfma_f32_16x16x32_bf16 v[156:159], v[36:39], v[180:183], v[156:159]
v_mfma_f32_16x16x32_bf16 v[164:167], v[36:39], v[184:187], v[164:167]
v_mfma_f32_16x16x32_bf16 v[172:175], v[36:39], v[188:191], v[172:175]
buffer_load_dwordx4 v[36:39], v243, s[8:11], s41 offen offset:0 sc1
s_waitcnt lgkmcnt(0)
s_waitcnt vmcnt(22)
v_mfma_f32_16x16x32_bf16 v[144:147], v[40:43], v[192:195], v[144:147]
ds_read_b128 v[176:179], v136 offset:40960
ds_read_b128 v[180:183], v136 offset:43008
v_mfma_f32_16x16x32_bf16 v[152:155], v[40:43], v[196:199], v[152:155]
ds_read_b128 v[184:187], v136 offset:45056
v_mfma_f32_16x16x32_bf16 v[160:163], v[40:43], v[200:203], v[160:163]
ds_read_b128 v[188:191], v136 offset:47104
v_mfma_f32_16x16x32_bf16 v[168:171], v[40:43], v[204:207], v[168:171]
buffer_load_dwordx4 v[40:43], v242, s[8:11], s41 offen offset:1024 sc1
v_mfma_f32_16x16x32_bf16 v[148:151], v[44:47], v[192:195], v[148:151]
v_mfma_f32_16x16x32_bf16 v[156:159], v[44:47], v[196:199], v[156:159]
v_mfma_f32_16x16x32_bf16 v[164:167], v[44:47], v[200:203], v[164:167]
v_mfma_f32_16x16x32_bf16 v[172:175], v[44:47], v[204:207], v[172:175]
buffer_load_dwordx4 v[44:47], v243, s[8:11], s41 offen offset:1024 sc1
s_waitcnt lgkmcnt(0)
s_waitcnt vmcnt(22)
v_mfma_f32_16x16x32_bf16 v[144:147], v[48:51], v[176:179], v[144:147]
ds_read_b128 v[192:195], v137 offset:40960
ds_read_b128 v[196:199], v137 offset:43008
v_mfma_f32_16x16x32_bf16 v[152:155], v[48:51], v[180:183], v[152:155]
ds_read_b128 v[200:203], v137 offset:45056
v_mfma_f32_16x16x32_bf16 v[160:163], v[48:51], v[184:187], v[160:163]
ds_read_b128 v[204:207], v137 offset:47104
v_mfma_f32_16x16x32_bf16 v[168:171], v[48:51], v[188:191], v[168:171]
buffer_load_dwordx4 v[48:51], v242, s[8:11], s41 offen offset:2048 sc1
v_mfma_f32_16x16x32_bf16 v[148:151], v[52:55], v[176:179], v[148:151]
v_mfma_f32_16x16x32_bf16 v[156:159], v[52:55], v[180:183], v[156:159]
v_mfma_f32_16x16x32_bf16 v[164:167], v[52:55], v[184:187], v[164:167]
v_mfma_f32_16x16x32_bf16 v[172:175], v[52:55], v[188:191], v[172:175]
buffer_load_dwordx4 v[52:55], v243, s[8:11], s41 offen offset:2048 sc1
s_waitcnt lgkmcnt(0)
s_barrier
s_waitcnt vmcnt(22)
v_mfma_f32_16x16x32_bf16 v[144:147], v[56:59], v[192:195], v[144:147]
ds_read_b128 v[176:179], v136 offset:49152
ds_read_b128 v[180:183], v136 offset:51200
v_mfma_f32_16x16x32_bf16 v[152:155], v[56:59], v[196:199], v[152:155]
ds_read_b128 v[184:187], v136 offset:53248
v_mfma_f32_16x16x32_bf16 v[160:163], v[56:59], v[200:203], v[160:163]
ds_read_b128 v[188:191], v136 offset:55296
v_mfma_f32_16x16x32_bf16 v[168:171], v[56:59], v[204:207], v[168:171]
buffer_load_dwordx4 v[56:59], v242, s[8:11], s41 offen offset:3072 sc1
v_mfma_f32_16x16x32_bf16 v[148:151], v[60:63], v[192:195], v[148:151]
v_mfma_f32_16x16x32_bf16 v[156:159], v[60:63], v[196:199], v[156:159]
v_mfma_f32_16x16x32_bf16 v[164:167], v[60:63], v[200:203], v[164:167]
v_mfma_f32_16x16x32_bf16 v[172:175], v[60:63], v[204:207], v[172:175]
buffer_load_dwordx4 v[60:63], v243, s[8:11], s41 offen offset:3072 sc1
s_waitcnt lgkmcnt(0)
s_waitcnt vmcnt(22)
v_mfma_f32_16x16x32_bf16 v[144:147], v[64:67], v[176:179], v[144:147]
ds_read_b128 v[192:195], v137 offset:49152
ds_read_b128 v[196:199], v137 offset:51200
v_mfma_f32_16x16x32_bf16 v[152:155], v[64:67], v[180:183], v[152:155]
ds_read_b128 v[200:203], v137 offset:53248
v_mfma_f32_16x16x32_bf16 v[160:163], v[64:67], v[184:187], v[160:163]
ds_read_b128 v[204:207], v137 offset:55296
v_mfma_f32_16x16x32_bf16 v[168:171], v[64:67], v[188:191], v[168:171]
s_add_u32 s41, s45, 11
s_and_b32 s41, s41, 15
s_lshl_b32 s41, s41, 12
buffer_load_dwordx4 v[64:67], v242, s[8:11], s41 offen offset:0 sc1
v_mfma_f32_16x16x32_bf16 v[148:151], v[68:71], v[176:179], v[148:151]
v_mfma_f32_16x16x32_bf16 v[156:159], v[68:71], v[180:183], v[156:159]
v_mfma_f32_16x16x32_bf16 v[164:167], v[68:71], v[184:187], v[164:167]
v_mfma_f32_16x16x32_bf16 v[172:175], v[68:71], v[188:191], v[172:175]
buffer_load_dwordx4 v[68:71], v243, s[8:11], s41 offen offset:0 sc1
s_waitcnt lgkmcnt(0)
s_waitcnt vmcnt(22)
v_mfma_f32_16x16x32_bf16 v[144:147], v[72:75], v[192:195], v[144:147]
ds_read_b128 v[176:179], v136 offset:57344
ds_read_b128 v[180:183], v136 offset:59392
v_mfma_f32_16x16x32_bf16 v[152:155], v[72:75], v[196:199], v[152:155]
ds_read_b128 v[184:187], v136 offset:61440
v_mfma_f32_16x16x32_bf16 v[160:163], v[72:75], v[200:203], v[160:163]
ds_read_b128 v[188:191], v136 offset:63488
v_mfma_f32_16x16x32_bf16 v[168:171], v[72:75], v[204:207], v[168:171]
buffer_load_dwordx4 v[72:75], v242, s[8:11], s41 offen offset:1024 sc1
v_mfma_f32_16x16x32_bf16 v[148:151], v[76:79], v[192:195], v[148:151]
v_mfma_f32_16x16x32_bf16 v[156:159], v[76:79], v[196:199], v[156:159]
v_mfma_f32_16x16x32_bf16 v[164:167], v[76:79], v[200:203], v[164:167]
v_mfma_f32_16x16x32_bf16 v[172:175], v[76:79], v[204:207], v[172:175]
buffer_load_dwordx4 v[76:79], v243, s[8:11], s41 offen offset:1024 sc1
s_waitcnt lgkmcnt(0)
s_waitcnt vmcnt(22)
v_mfma_f32_16x16x32_bf16 v[144:147], v[80:83], v[176:179], v[144:147]
ds_read_b128 v[192:195], v137 offset:57344
ds_read_b128 v[196:199], v137 offset:59392
v_mfma_f32_16x16x32_bf16 v[152:155], v[80:83], v[180:183], v[152:155]
ds_read_b128 v[200:203], v137 offset:61440
v_mfma_f32_16x16x32_bf16 v[160:163], v[80:83], v[184:187], v[160:163]
ds_read_b128 v[204:207], v137 offset:63488
v_mfma_f32_16x16x32_bf16 v[168:171], v[80:83], v[188:191], v[168:171]
buffer_load_dwordx4 v[80:83], v242, s[8:11], s41 offen offset:2048 sc1
v_mfma_f32_16x16x32_bf16 v[148:151], v[84:87], v[176:179], v[148:151]
v_mfma_f32_16x16x32_bf16 v[156:159], v[84:87], v[180:183], v[156:159]
v_mfma_f32_16x16x32_bf16 v[164:167], v[84:87], v[184:187], v[164:167]
v_mfma_f32_16x16x32_bf16 v[172:175], v[84:87], v[188:191], v[172:175]
buffer_load_dwordx4 v[84:87], v243, s[8:11], s41 offen offset:2048 sc1
s_waitcnt lgkmcnt(0)
s_barrier
s_mov_b32 s42, 0
buffer_load_dwordx4 v[96:99], v244, s[8:11], s42 offen sc1
s_mov_b32 s42, 28672
buffer_load_dwordx4 v[100:103], v244, s[8:11], s42 offen sc1
s_mov_b32 s42, 57344
buffer_load_dwordx4 v[104:107], v244, s[8:11], s42 offen sc1
s_mov_b32 s42, 86016
buffer_load_dwordx4 v[108:111], v244, s[8:11], s42 offen sc1
s_waitcnt vmcnt(26)
v_mfma_f32_16x16x32_bf16 v[144:147], v[88:91], v[192:195], v[144:147]
ds_read_b128 v[176:179], v138 offset:0
ds_read_b128 v[180:183], v138 offset:2048
v_mfma_f32_16x16x32_bf16 v[152:155], v[88:91], v[196:199], v[152:155]
ds_read_b128 v[184:187], v138 offset:4096
v_mfma_f32_16x16x32_bf16 v[160:163], v[88:91], v[200:203], v[160:163]
ds_read_b128 v[188:191], v138 offset:6144
v_mfma_f32_16x16x32_bf16 v[168:171], v[88:91], v[204:207], v[168:171]
buffer_load_dwordx4 v[88:91], v242, s[8:11], s41 offen offset:3072 sc1
v_mfma_f32_16x16x32_bf16 v[148:151], v[92:95], v[192:195], v[148:151]
v_mfma_f32_16x16x32_bf16 v[156:159], v[92:95], v[196:199], v[156:159]
v_mfma_f32_16x16x32_bf16 v[164:167], v[92:95], v[200:203], v[164:167]
v_mfma_f32_16x16x32_bf16 v[172:175], v[92:95], v[204:207], v[172:175]
buffer_load_dwordx4 v[92:95], v243, s[8:11], s41 offen offset:3072 sc1
s_waitcnt lgkmcnt(0)
s_waitcnt vmcnt(26)
v_mfma_f32_16x16x32_bf16 v[144:147], v[0:3], v[176:179], v[144:147]
ds_read_b128 v[192:195], v139 offset:0
ds_read_b128 v[196:199], v139 offset:2048
v_mfma_f32_16x16x32_bf16 v[152:155], v[0:3], v[180:183], v[152:155]
ds_read_b128 v[200:203], v139 offset:4096
v_mfma_f32_16x16x32_bf16 v[160:163], v[0:3], v[184:187], v[160:163]
ds_read_b128 v[204:207], v139 offset:6144
v_mfma_f32_16x16x32_bf16 v[168:171], v[0:3], v[188:191], v[168:171]
s_add_u32 s41, s45, 12
s_and_b32 s41, s41, 15
s_lshl_b32 s41, s41, 12
buffer_load_dwordx4 v[0:3], v242, s[8:11], s41 offen offset:0 sc1
v_mfma_f32_16x16x32_bf16 v[148:151], v[4:7], v[176:179], v[148:151]
v_mfma_f32_16x16x32_bf16 v[156:159], v[4:7], v[180:183], v[156:159]
v_mfma_f32_16x16x32_bf16 v[164:167], v[4:7], v[184:187], v[164:167]
v_mfma_f32_16x16x32_bf16 v[172:175], v[4:7], v[188:191], v[172:175]
buffer_load_dwordx4 v[4:7], v243, s[8:11], s41 offen offset:0 sc1
s_waitcnt lgkmcnt(0)
s_waitcnt vmcnt(26)
v_mfma_f32_16x16x32_bf16 v[144:147], v[8:11], v[192:195], v[144:147]
ds_read_b128 v[176:179], v138 offset:8192
ds_read_b128 v[180:183], v138 offset:10240
v_mfma_f32_16x16x32_bf16 v[152:155], v[8:11], v[196:199], v[152:155]
ds_read_b128 v[184:187], v138 offset:12288
v_mfma_f32_16x16x32_bf16 v[160:163], v[8:11], v[200:203], v[160:163]
ds_read_b128 v[188:191], v138 offset:14336
v_mfma_f32_16x16x32_bf16 v[168:171], v[8:11], v[204:207], v[168:171]
buffer_load_dwordx4 v[8:11], v242, s[8:11], s41 offen offset:1024 sc1
v_mfma_f32_16x16x32_bf16 v[148:151], v[12:15], v[192:195], v[148:151]
v_mfma_f32_16x16x32_bf16 v[156:159], v[12:15], v[196:199], v[156:159]
v_mfma_f32_16x16x32_bf16 v[164:167], v[12:15], v[200:203], v[164:167]
v_mfma_f32_16x16x32_bf16 v[172:175], v[12:15], v[204:207], v[172:175]
buffer_load_dwordx4 v[12:15], v243, s[8:11], s41 offen offset:1024 sc1
s_waitcnt lgkmcnt(0)
s_waitcnt vmcnt(26)
v_mfma_f32_16x16x32_bf16 v[144:147], v[16:19], v[176:179], v[144:147]
ds_read_b128 v[192:195], v139 offset:8192
ds_read_b128 v[196:199], v139 offset:10240
v_mfma_f32_16x16x32_bf16 v[152:155], v[16:19], v[180:183], v[152:155]
ds_read_b128 v[200:203], v139 offset:12288
v_mfma_f32_16x16x32_bf16 v[160:163], v[16:19], v[184:187], v[160:163]
ds_read_b128 v[204:207], v139 offset:14336
v_mfma_f32_16x16x32_bf16 v[168:171], v[16:19], v[188:191], v[168:171]
buffer_load_dwordx4 v[16:19], v242, s[8:11], s41 offen offset:2048 sc1
v_mfma_f32_16x16x32_bf16 v[148:151], v[20:23], v[176:179], v[148:151]
v_mfma_f32_16x16x32_bf16 v[156:159], v[20:23], v[180:183], v[156:159]
v_mfma_f32_16x16x32_bf16 v[164:167], v[20:23], v[184:187], v[164:167]
v_mfma_f32_16x16x32_bf16 v[172:175], v[20:23], v[188:191], v[172:175]
buffer_load_dwordx4 v[20:23], v243, s[8:11], s41 offen offset:2048 sc1
s_waitcnt lgkmcnt(0)
s_barrier
s_waitcnt vmcnt(26)
v_mfma_f32_16x16x32_bf16 v[144:147], v[24:27], v[192:195], v[144:147]
ds_read_b128 v[176:179], v136 offset:0
ds_read_b128 v[180:183], v136 offset:2048
v_mfma_f32_16x16x32_bf16 v[152:155], v[24:27], v[196:199], v[152:155]
ds_read_b128 v[184:187], v136 offset:4096
v_mfma_f32_16x16x32_bf16 v[160:163], v[24:27], v[200:203], v[160:163]
ds_read_b128 v[188:191], v136 offset:6144
v_mfma_f32_16x16x32_bf16 v[168:171], v[24:27], v[204:207], v[168:171]
buffer_load_dwordx4 v[24:27], v242, s[8:11], s41 offen offset:3072 sc1
v_mfma_f32_16x16x32_bf16 v[148:151], v[28:31], v[192:195], v[148:151]
v_mfma_f32_16x16x32_bf16 v[156:159], v[28:31], v[196:199], v[156:159]
v_mfma_f32_16x16x32_bf16 v[164:167], v[28:31], v[200:203], v[164:167]
v_mfma_f32_16x16x32_bf16 v[172:175], v[28:31], v[204:207], v[172:175]
buffer_load_dwordx4 v[28:31], v243, s[8:11], s41 offen offset:3072 sc1
s_waitcnt lgkmcnt(0)
s_waitcnt vmcnt(26)
v_mfma_f32_16x16x32_bf16 v[144:147], v[32:35], v[176:179], v[144:147]
ds_read_b128 v[192:195], v137 offset:0
ds_read_b128 v[196:199], v137 offset:2048
v_mfma_f32_16x16x32_bf16 v[152:155], v[32:35], v[180:183], v[152:155]
ds_read_b128 v[200:203], v137 offset:4096
v_mfma_f32_16x16x32_bf16 v[160:163], v[32:35], v[184:187], v[160:163]
ds_read_b128 v[204:207], v137 offset:6144
v_mfma_f32_16x16x32_bf16 v[168:171], v[32:35], v[188:191], v[168:171]
s_add_u32 s41, s45, 13
s_and_b32 s41, s41, 15
s_lshl_b32 s41, s41, 12
buffer_load_dwordx4 v[32:35], v242, s[8:11], s41 offen offset:0 sc1
v_mfma_f32_16x16x32_bf16 v[148:151], v[36:39], v[176:179], v[148:151]
v_mfma_f32_16x16x32_bf16 v[156:159], v[36:39], v[180:183], v[156:159]
v_mfma_f32_16x16x32_bf16 v[164:167], v[36:39], v[184:187], v[164:167]
v_mfma_f32_16x16x32_bf16 v[172:175], v[36:39], v[188:191], v[172:175]
buffer_load_dwordx4 v[36:39], v243, s[8:11], s41 offen offset:0 sc1
s_waitcnt lgkmcnt(0)
s_waitcnt vmcnt(26)
v_mfma_f32_16x16x32_bf16 v[144:147], v[40:43], v[192:195], v[144:147]
ds_read_b128 v[176:179], v136 offset:8192
ds_read_b128 v[180:183], v136 offset:10240
v_mfma_f32_16x16x32_bf16 v[152:155], v[40:43], v[196:199], v[152:155]
ds_read_b128 v[184:187], v136 offset:12288
v_mfma_f32_16x16x32_bf16 v[160:163], v[40:43], v[200:203], v[160:163]
ds_read_b128 v[188:191], v136 offset:14336
v_mfma_f32_16x16x32_bf16 v[168:171], v[40:43], v[204:207], v[168:171]
buffer_load_dwordx4 v[40:43], v242, s[8:11], s41 offen offset:1024 sc1
v_mfma_f32_16x16x32_bf16 v[148:151], v[44:47], v[192:195], v[148:151]
v_mfma_f32_16x16x32_bf16 v[156:159], v[44:47], v[196:199], v[156:159]
v_mfma_f32_16x16x32_bf16 v[164:167], v[44:47], v[200:203], v[164:167]
v_mfma_f32_16x16x32_bf16 v[172:175], v[44:47], v[204:207], v[172:175]
buffer_load_dwordx4 v[44:47], v243, s[8:11], s41 offen offset:1024 sc1
s_waitcnt lgkmcnt(0)
s_waitcnt vmcnt(26)
v_mfma_f32_16x16x32_bf16 v[144:147], v[48:51], v[176:179], v[144:147]
ds_read_b128 v[192:195], v137 offset:8192
ds_read_b128 v[196:199], v137 offset:10240
v_mfma_f32_16x16x32_bf16 v[152:155], v[48:51], v[180:183], v[152:155]
ds_read_b128 v[200:203], v137 offset:12288
v_mfma_f32_16x16x32_bf16 v[160:163], v[48:51], v[184:187], v[160:163]
ds_read_b128 v[204:207], v137 offset:14336
v_mfma_f32_16x16x32_bf16 v[168:171], v[48:51], v[188:191], v[168:171]
buffer_load_dwordx4 v[48:51], v242, s[8:11], s41 offen offset:2048 sc1
v_mfma_f32_16x16x32_bf16 v[148:151], v[52:55], v[176:179], v[148:151]
v_mfma_f32_16x16x32_bf16 v[156:159], v[52:55], v[180:183], v[156:159]
v_mfma_f32_16x16x32_bf16 v[164:167], v[52:55], v[184:187], v[164:167]
v_mfma_f32_16x16x32_bf16 v[172:175], v[52:55], v[188:191], v[172:175]
buffer_load_dwordx4 v[52:55], v243, s[8:11], s41 offen offset:2048 sc1
s_waitcnt lgkmcnt(0)
s_barrier
s_waitcnt vmcnt(26)
v_mfma_f32_16x16x32_bf16 v[144:147], v[56:59], v[192:195], v[144:147]
ds_read_b128 v[176:179], v136 offset:16384
ds_read_b128 v[180:183], v136 offset:18432
v_mfma_f32_16x16x32_bf16 v[152:155], v[56:59], v[196:199], v[152:155]
ds_read_b128 v[184:187], v136 offset:20480
v_mfma_f32_16x16x32_bf16 v[160:163], v[56:59], v[200:203], v[160:163]
ds_read_b128 v[188:191], v136 offset:22528
v_mfma_f32_16x16x32_bf16 v[168:171], v[56:59], v[204:207], v[168:171]
buffer_load_dwordx4 v[56:59], v242, s[8:11], s41 offen offset:3072 sc1
v_mfma_f32_16x16x32_bf16 v[148:151], v[60:63], v[192:195], v[148:151]
v_mfma_f32_16x16x32_bf16 v[156:159], v[60:63], v[196:199], v[156:159]
v_mfma_f32_16x16x32_bf16 v[164:167], v[60:63], v[200:203], v[164:167]
v_mfma_f32_16x16x32_bf16 v[172:175], v[60:63], v[204:207], v[172:175]
buffer_load_dwordx4 v[60:63], v243, s[8:11], s41 offen offset:3072 sc1
s_waitcnt lgkmcnt(0)
s_waitcnt vmcnt(26)
v_mfma_f32_16x16x32_bf16 v[144:147], v[64:67], v[176:179], v[144:147]
ds_read_b128 v[192:195], v137 offset:16384
ds_read_b128 v[196:199], v137 offset:18432
v_mfma_f32_16x16x32_bf16 v[152:155], v[64:67], v[180:183], v[152:155]
ds_read_b128 v[200:203], v137 offset:20480
v_mfma_f32_16x16x32_bf16 v[160:163], v[64:67], v[184:187], v[160:163]
ds_read_b128 v[204:207], v137 offset:22528
v_mfma_f32_16x16x32_bf16 v[168:171], v[64:67], v[188:191], v[168:171]
s_add_u32 s41, s45, 14
s_and_b32 s41, s41, 15
s_lshl_b32 s41, s41, 12
buffer_load_dwordx4 v[64:67], v242, s[8:11], s41 offen offset:0 sc1
v_mfma_f32_16x16x32_bf16 v[148:151], v[68:71], v[176:179], v[148:151]
v_mfma_f32_16x16x32_bf16 v[156:159], v[68:71], v[180:183], v[156:159]
v_mfma_f32_16x16x32_bf16 v[164:167], v[68:71], v[184:187], v[164:167]
v_mfma_f32_16x16x32_bf16 v[172:175], v[68:71], v[188:191], v[172:175]
buffer_load_dwordx4 v[68:71], v243, s[8:11], s41 offen offset:0 sc1
s_waitcnt lgkmcnt(0)
s_waitcnt vmcnt(26)
v_mfma_f32_16x16x32_bf16 v[144:147], v[72:75], v[192:195], v[144:147]
ds_read_b128 v[176:179], v136 offset:24576
ds_read_b128 v[180:183], v136 offset:26624
v_mfma_f32_16x16x32_bf16 v[152:155], v[72:75], v[196:199], v[152:155]
ds_read_b128 v[184:187], v136 offset:28672
v_mfma_f32_16x16x32_bf16 v[160:163], v[72:75], v[200:203], v[160:163]
ds_read_b128 v[188:191], v136 offset:30720
v_mfma_f32_16x16x32_bf16 v[168:171], v[72:75], v[204:207], v[168:171]
buffer_load_dwordx4 v[72:75], v242, s[8:11], s41 offen offset:1024 sc1
v_mfma_f32_16x16x32_bf16 v[148:151], v[76:79], v[192:195], v[148:151]
v_mfma_f32_16x16x32_bf16 v[156:159], v[76:79], v[196:199], v[156:159]
v_mfma_f32_16x16x32_bf16 v[164:167], v[76:79], v[200:203], v[164:167]
v_mfma_f32_16x16x32_bf16 v[172:175], v[76:79], v[204:207], v[172:175]
buffer_load_dwordx4 v[76:79], v243, s[8:11], s41 offen offset:1024 sc1
s_waitcnt lgkmcnt(0)
s_waitcnt vmcnt(22)
v_mfma_f32_16x16x32_bf16 v[144:147], v[80:83], v[176:179], v[144:147]
v_lshlrev_b32 v208, 16, v96
v_and_b32 v209, 0xffff0000, v96
ds_read_b128 v[192:195], v137 offset:24576
ds_read_b128 v[196:199], v137 offset:26624
v_mfma_f32_16x16x32_bf16 v[152:155], v[80:83], v[180:183], v[152:155]
v_mul_f32 v112, v208, v208
v_mul_f32 v113, v209, v209
ds_read_b128 v[200:203], v137 offset:28672
v_mfma_f32_16x16x32_bf16 v[160:163], v[80:83], v[184:187], v[160:163]
v_fma_f32 v112, v112, v240, v241
v_fma_f32 v113, v113, v240, v241
ds_read_b128 v[204:207], v137 offset:30720
v_mfma_f32_16x16x32_bf16 v[168:171], v[80:83], v[188:191], v[168:171]
buffer_load_dwordx4 v[80:83], v242, s[8:11], s41 offen offset:2048 sc1
v_mul_f32 v112, v112, v208
v_mul_f32 v113, v113, v209
v_mfma_f32_16x16x32_bf16 v[148:151], v[84:87], v[176:179], v[148:151]
v_exp_f32 v112, v112
v_exp_f32 v113, v113
v_mfma_f32_16x16x32_bf16 v[156:159], v[84:87], v[180:183], v[156:159]
v_add_f32 v112, 1.0, v112
v_add_f32 v113, 1.0, v113
v_mfma_f32_16x16x32_bf16 v[164:167], v[84:87], v[184:187], v[164:167]
v_rcp_f32 v112, v112
v_rcp_f32 v113, v113
v_mfma_f32_16x16x32_bf16 v[172:175], v[84:87], v[188:191], v[172:175]
buffer_load_dwordx4 v[84:87], v243, s[8:11], s41 offen offset:2048 sc1
v_mul_f32 v208, v208, v112
v_mul_f32 v209, v209, v113
s_waitcnt lgkmcnt(0)
s_barrier
s_waitcnt vmcnt(22)
v_mfma_f32_16x16x32_bf16 v[144:147], v[88:91], v[192:195], v[144:147]
v_lshlrev_b32 v210, 16, v97
v_and_b32 v211, 0xffff0000, v97
ds_read_b128 v[176:179], v136 offset:32768
ds_read_b128 v[180:183], v136 offset:34816
v_mfma_f32_16x16x32_bf16 v[152:155], v[88:91], v[196:199], v[152:155]
v_mul_f32 v114, v210, v210
v_mul_f32 v115, v211, v211
ds_read_b128 v[184:187], v136 offset:36864
v_mfma_f32_16x16x32_bf16 v[160:163], v[88:91], v[200:203], v[160:163]
v_fma_f32 v114, v114, v240, v241
v_fma_f32 v115, v115, v240, v241
ds_read_b128 v[188:191], v136 offset:38912
v_mfma_f32_16x16x32_bf16 v[168:171], v[88:91], v[204:207], v[168:171]
buffer_load_dwordx4 v[88:91], v242, s[8:11], s41 offen offset:3072 sc1
v_mul_f32 v114, v114, v210
v_mul_f32 v115, v115, v211
v_mfma_f32_16x16x32_bf16 v[148:151], v[92:95], v[192:195], v[148:151]
v_exp_f32 v114, v114
v_exp_f32 v115, v115
v_mfma_f32_16x16x32_bf16 v[156:159], v[92:95], v[196:199], v[156:159]
v_add_f32 v114, 1.0, v114
v_add_f32 v115, 1.0, v115
v_mfma_f32_16x16x32_bf16 v[164:167], v[92:95], v[200:203], v[164:167]
v_rcp_f32 v114, v114
v_rcp_f32 v115, v115
v_mfma_f32_16x16x32_bf16 v[172:175], v[92:95], v[204:207], v[172:175]
buffer_load_dwordx4 v[92:95], v243, s[8:11], s41 offen offset:3072 sc1
v_mul_f32 v210, v210, v114
v_mul_f32 v211, v211, v115
s_waitcnt lgkmcnt(0)
s_waitcnt vmcnt(22)
v_mfma_f32_16x16x32_bf16 v[144:147], v[0:3], v[176:179], v[144:147]
v_lshlrev_b32 v212, 16, v98
v_and_b32 v213, 0xffff0000, v98
ds_read_b128 v[192:195], v137 offset:32768
ds_read_b128 v[196:199], v137 offset:34816
v_mfma_f32_16x16x32_bf16 v[152:155], v[0:3], v[180:183], v[152:155]
v_mul_f32 v112, v212, v212
v_mul_f32 v113, v213, v213
ds_read_b128 v[200:203], v137 offset:36864
v_mfma_f32_16x16x32_bf16 v[160:163], v[0:3], v[184:187], v[160:163]
v_fma_f32 v112, v112, v240, v241
v_fma_f32 v113, v113, v240, v241
ds_read_b128 v[204:207], v137 offset:38912
v_mfma_f32_16x16x32_bf16 v[168:171], v[0:3], v[188:191], v[168:171]
s_add_u32 s41, s45, 15
s_and_b32 s41, s41, 15
s_lshl_b32 s41, s41, 12
buffer_load_dwordx4 v[0:3], v242, s[8:11], s41 offen offset:0 sc1
v_mul_f32 v112, v112, v212
v_mul_f32 v113, v113, v213
v_mfma_f32_16x16x32_bf16 v[148:151], v[4:7], v[176:179], v[148:151]
v_exp_f32 v112, v112
v_exp_f32 v113, v113
v_mfma_f32_16x16x32_bf16 v[156:159], v[4:7], v[180:183], v[156:159]
v_add_f32 v112, 1.0, v112
v_add_f32 v113, 1.0, v113
v_mfma_f32_16x16x32_bf16 v[164:167], v[4:7], v[184:187], v[164:167]
v_rcp_f32 v112, v112
v_rcp_f32 v113, v113
v_mfma_f32_16x16x32_bf16 v[172:175], v[4:7], v[188:191], v[172:175]
buffer_load_dwordx4 v[4:7], v243, s[8:11], s41 offen offset:0 sc1
v_mul_f32 v212, v212, v112
v_mul_f32 v213, v213, v113
s_waitcnt lgkmcnt(0)
s_waitcnt vmcnt(22)
v_mfma_f32_16x16x32_bf16 v[144:147], v[8:11], v[192:195], v[144:147]
v_lshlrev_b32 v214, 16, v99
v_and_b32 v215, 0xffff0000, v99
ds_read_b128 v[176:179], v136 offset:40960
ds_read_b128 v[180:183], v136 offset:43008
v_mfma_f32_16x16x32_bf16 v[152:155], v[8:11], v[196:199], v[152:155]
v_mul_f32 v114, v214, v214
v_mul_f32 v115, v215, v215
ds_read_b128 v[184:187], v136 offset:45056
v_mfma_f32_16x16x32_bf16 v[160:163], v[8:11], v[200:203], v[160:163]
v_fma_f32 v114, v114, v240, v241
v_fma_f32 v115, v115, v240, v241
ds_read_b128 v[188:191], v136 offset:47104
v_mfma_f32_16x16x32_bf16 v[168:171], v[8:11], v[204:207], v[168:171]
buffer_load_dwordx4 v[8:11], v242, s[8:11], s41 offen offset:1024 sc1
v_mul_f32 v114, v114, v214
v_mul_f32 v115, v115, v215
v_mfma_f32_16x16x32_bf16 v[148:151], v[12:15], v[192:195], v[148:151]
v_exp_f32 v114, v114
v_exp_f32 v115, v115
v_mfma_f32_16x16x32_bf16 v[156:159], v[12:15], v[196:199], v[156:159]
v_add_f32 v114, 1.0, v114
v_add_f32 v115, 1.0, v115
v_mfma_f32_16x16x32_bf16 v[164:167], v[12:15], v[200:203], v[164:167]
v_rcp_f32 v114, v114
v_rcp_f32 v115, v115
v_mfma_f32_16x16x32_bf16 v[172:175], v[12:15], v[204:207], v[172:175]
buffer_load_dwordx4 v[12:15], v243, s[8:11], s41 offen offset:1024 sc1
v_mul_f32 v214, v214, v114
v_mul_f32 v215, v215, v115
s_waitcnt lgkmcnt(0)
s_waitcnt vmcnt(22)
v_mfma_f32_16x16x32_bf16 v[144:147], v[16:19], v[176:179], v[144:147]
v_lshlrev_b32 v216, 16, v100
v_and_b32 v217, 0xffff0000, v100
ds_read_b128 v[192:195], v137 offset:40960
ds_read_b128 v[196:199], v137 offset:43008
v_mfma_f32_16x16x32_bf16 v[152:155], v[16:19], v[180:183], v[152:155]
v_mul_f32 v112, v216, v216
v_mul_f32 v113, v217, v217
ds_read_b128 v[200:203], v137 offset:45056
v_mfma_f32_16x16x32_bf16 v[160:163], v[16:19], v[184:187], v[160:163]
v_fma_f32 v112, v112, v240, v241
v_fma_f32 v113, v113, v240, v241
ds_read_b128 v[204:207], v137 offset:47104
v_mfma_f32_16x16x32_bf16 v[168:171], v[16:19], v[188:191], v[168:171]
buffer_load_dwordx4 v[16:19], v242, s[8:11], s41 offen offset:2048 sc1
v_mul_f32 v112, v112, v216
v_mul_f32 v113, v113, v217
v_mfma_f32_16x16x32_bf16 v[148:151], v[20:23], v[176:179], v[148:151]
v_exp_f32 v112, v112
v_exp_f32 v113, v113
v_mfma_f32_16x16x32_bf16 v[156:159], v[20:23], v[180:183], v[156:159]
v_add_f32 v112, 1.0, v112
v_add_f32 v113, 1.0, v113
v_mfma_f32_16x16x32_bf16 v[164:167], v[20:23], v[184:187], v[164:167]
v_rcp_f32 v112, v112
v_rcp_f32 v113, v113
v_mfma_f32_16x16x32_bf16 v[172:175], v[20:23], v[188:191], v[172:175]
buffer_load_dwordx4 v[20:23], v243, s[8:11], s41 offen offset:2048 sc1
v_mul_f32 v216, v216, v112
v_mul_f32 v217, v217, v113
s_waitcnt lgkmcnt(0)
s_barrier
s_waitcnt vmcnt(22)
v_mfma_f32_16x16x32_bf16 v[144:147], v[24:27], v[192:195], v[144:147]
v_lshlrev_b32 v218, 16, v101
v_and_b32 v219, 0xffff0000, v101
ds_read_b128 v[176:179], v136 offset:49152
ds_read_b128 v[180:183], v136 offset:51200
v_mfma_f32_16x16x32_bf16 v[152:155], v[24:27], v[196:199], v[152:155]
v_mul_f32 v114, v218, v218
v_mul_f32 v115, v219, v219
ds_read_b128 v[184:187], v136 offset:53248
v_mfma_f32_16x16x32_bf16 v[160:163], v[24:27], v[200:203], v[160:163]
v_fma_f32 v114, v114, v240, v241
v_fma_f32 v115, v115, v240, v241
ds_read_b128 v[188:191], v136 offset:55296
v_mfma_f32_16x16x32_bf16 v[168:171], v[24:27], v[204:207], v[168:171]
buffer_load_dwordx4 v[24:27], v242, s[8:11], s41 offen offset:3072 sc1
v_mul_f32 v114, v114, v218
v_mul_f32 v115, v115, v219
v_mfma_f32_16x16x32_bf16 v[148:151], v[28:31], v[192:195], v[148:151]
v_exp_f32 v114, v114
v_exp_f32 v115, v115
v_mfma_f32_16x16x32_bf16 v[156:159], v[28:31], v[196:199], v[156:159]
v_add_f32 v114, 1.0, v114
v_add_f32 v115, 1.0, v115
v_mfma_f32_16x16x32_bf16 v[164:167], v[28:31], v[200:203], v[164:167]
v_rcp_f32 v114, v114
v_rcp_f32 v115, v115
v_mfma_f32_16x16x32_bf16 v[172:175], v[28:31], v[204:207], v[172:175]
buffer_load_dwordx4 v[28:31], v243, s[8:11], s41 offen offset:3072 sc1
v_mul_f32 v218, v218, v114
v_mul_f32 v219, v219, v115
s_waitcnt lgkmcnt(0)
s_waitcnt vmcnt(22)
v_mfma_f32_16x16x32_bf16 v[144:147], v[32:35], v[176:179], v[144:147]
v_lshlrev_b32 v220, 16, v102
v_and_b32 v221, 0xffff0000, v102
ds_read_b128 v[192:195], v137 offset:49152
ds_read_b128 v[196:199], v137 offset:51200
v_mfma_f32_16x16x32_bf16 v[152:155], v[32:35], v[180:183], v[152:155]
v_mul_f32 v112, v220, v220
v_mul_f32 v113, v221, v221
ds_read_b128 v[200:203], v137 offset:53248
v_mfma_f32_16x16x32_bf16 v[160:163], v[32:35], v[184:187], v[160:163]
v_fma_f32 v112, v112, v240, v241
v_fma_f32 v113, v113, v240, v241
ds_read_b128 v[204:207], v137 offset:55296
v_mfma_f32_16x16x32_bf16 v[168:171], v[32:35], v[188:191], v[168:171]
v_mul_f32 v112, v112, v220
v_mul_f32 v113, v113, v221
v_mfma_f32_16x16x32_bf16 v[148:151], v[36:39], v[176:179], v[148:151]
v_exp_f32 v112, v112
v_exp_f32 v113, v113
v_mfma_f32_16x16x32_bf16 v[156:159], v[36:39], v[180:183], v[156:159]
v_add_f32 v112, 1.0, v112
v_add_f32 v113, 1.0, v113
v_mfma_f32_16x16x32_bf16 v[164:167], v[36:39], v[184:187], v[164:167]
v_rcp_f32 v112, v112
v_rcp_f32 v113, v113
v_mfma_f32_16x16x32_bf16 v[172:175], v[36:39], v[188:191], v[172:175]
v_mul_f32 v220, v220, v112
v_mul_f32 v221, v221, v113
s_waitcnt lgkmcnt(0)
s_waitcnt vmcnt(20)
v_mfma_f32_16x16x32_bf16 v[144:147], v[40:43], v[192:195], v[144:147]
v_lshlrev_b32 v222, 16, v103
v_and_b32 v223, 0xffff0000, v103
ds_read_b128 v[176:179], v136 offset:57344
ds_read_b128 v[180:183], v136 offset:59392
v_mfma_f32_16x16x32_bf16 v[152:155], v[40:43], v[196:199], v[152:155]
v_mul_f32 v114, v222, v222
v_mul_f32 v115, v223, v223
ds_read_b128 v[184:187], v136 offset:61440
v_mfma_f32_16x16x32_bf16 v[160:163], v[40:43], v[200:203], v[160:163]
v_fma_f32 v114, v114, v240, v241
v_fma_f32 v115, v115, v240, v241
ds_read_b128 v[188:191], v136 offset:63488
v_mfma_f32_16x16x32_bf16 v[168:171], v[40:43], v[204:207], v[168:171]
v_mul_f32 v114, v114, v222
v_mul_f32 v115, v115, v223
v_mfma_f32_16x16x32_bf16 v[148:151], v[44:47], v[192:195], v[148:151]
v_exp_f32 v114, v114
v_exp_f32 v115, v115
v_mfma_f32_16x16x32_bf16 v[156:159], v[44:47], v[196:199], v[156:159]
v_add_f32 v114, 1.0, v114
v_add_f32 v115, 1.0, v115
v_mfma_f32_16x16x32_bf16 v[164:167], v[44:47], v[200:203], v[164:167]
v_rcp_f32 v114, v114
v_rcp_f32 v115, v115
v_mfma_f32_16x16x32_bf16 v[172:175], v[44:47], v[204:207], v[172:175]
v_mul_f32 v222, v222, v114
v_mul_f32 v223, v223, v115
s_waitcnt lgkmcnt(0)
s_waitcnt vmcnt(18)
v_mfma_f32_16x16x32_bf16 v[144:147], v[48:51], v[176:179], v[144:147]
v_lshlrev_b32 v224, 16, v104
v_and_b32 v225, 0xffff0000, v104
ds_read_b128 v[192:195], v137 offset:57344
ds_read_b128 v[196:199], v137 offset:59392
v_mfma_f32_16x16x32_bf16 v[152:155], v[48:51], v[180:183], v[152:155]
v_mul_f32 v112, v224, v224
v_mul_f32 v113, v225, v225
ds_read_b128 v[200:203], v137 offset:61440
v_mfma_f32_16x16x32_bf16 v[160:163], v[48:51], v[184:187], v[160:163]
v_fma_f32 v112, v112, v240, v241
v_fma_f32 v113, v113, v240, v241
ds_read_b128 v[204:207], v137 offset:63488
v_mfma_f32_16x16x32_bf16 v[168:171], v[48:51], v[188:191], v[168:171]
v_mul_f32 v112, v112, v224
v_mul_f32 v113, v113, v225
v_mfma_f32_16x16x32_bf16 v[148:151], v[52:55], v[176:179], v[148:151]
v_exp_f32 v112, v112
v_exp_f32 v113, v113
v_mfma_f32_16x16x32_bf16 v[156:159], v[52:55], v[180:183], v[156:159]
v_add_f32 v112, 1.0, v112
v_add_f32 v113, 1.0, v113
v_mfma_f32_16x16x32_bf16 v[164:167], v[52:55], v[184:187], v[164:167]
v_rcp_f32 v112, v112
v_rcp_f32 v113, v113
v_mfma_f32_16x16x32_bf16 v[172:175], v[52:55], v[188:191], v[172:175]
v_mul_f32 v224, v224, v112
v_mul_f32 v225, v225, v113
s_waitcnt lgkmcnt(0)
s_barrier
s_waitcnt vmcnt(16)
v_mfma_f32_16x16x32_bf16 v[144:147], v[56:59], v[192:195], v[144:147]
v_lshlrev_b32 v226, 16, v105
v_and_b32 v227, 0xffff0000, v105
ds_read_b128 v[176:179], v138 offset:0
ds_read_b128 v[180:183], v138 offset:2048
v_mfma_f32_16x16x32_bf16 v[152:155], v[56:59], v[196:199], v[152:155]
v_mul_f32 v114, v226, v226
v_mul_f32 v115, v227, v227
ds_read_b128 v[184:187], v138 offset:4096
v_mfma_f32_16x16x32_bf16 v[160:163], v[56:59], v[200:203], v[160:163]
v_fma_f32 v114, v114, v240, v241
v_fma_f32 v115, v115, v240, v241
ds_read_b128 v[188:191], v138 offset:6144
v_mfma_f32_16x16x32_bf16 v[168:171], v[56:59], v[204:207], v[168:171]
v_mul_f32 v114, v114, v226
v_mul_f32 v115, v115, v227
v_mfma_f32_16x16x32_bf16 v[148:151], v[60:63], v[192:195], v[148:151]
v_exp_f32 v114, v114
v_exp_f32 v115, v115
v_mfma_f32_16x16x32_bf16 v[156:159], v[60:63], v[196:199], v[156:159]
v_add_f32 v114, 1.0, v114
v_add_f32 v115, 1.0, v115
v_mfma_f32_16x16x32_bf16 v[164:167], v[60:63], v[200:203], v[164:167]
v_rcp_f32 v114, v114
v_rcp_f32 v115, v115
v_mfma_f32_16x16x32_bf16 v[172:175], v[60:63], v[204:207], v[172:175]
v_mul_f32 v226, v226, v114
v_mul_f32 v227, v227, v115
s_waitcnt lgkmcnt(0)
s_waitcnt vmcnt(14)
v_mfma_f32_16x16x32_bf16 v[144:147], v[64:67], v[176:179], v[144:147]
v_lshlrev_b32 v228, 16, v106
v_and_b32 v229, 0xffff0000, v106
ds_read_b128 v[192:195], v139 offset:0
ds_read_b128 v[196:199], v139 offset:2048
v_mfma_f32_16x16x32_bf16 v[152:155], v[64:67], v[180:183], v[152:155]
v_mul_f32 v112, v228, v228
v_mul_f32 v113, v229, v229
ds_read_b128 v[200:203], v139 offset:4096
v_mfma_f32_16x16x32_bf16 v[160:163], v[64:67], v[184:187], v[160:163]
v_fma_f32 v112, v112, v240, v241
v_fma_f32 v113, v113, v240, v241
ds_read_b128 v[204:207], v139 offset:6144
v_mfma_f32_16x16x32_bf16 v[168:171], v[64:67], v[188:191], v[168:171]
v_mul_f32 v112, v112, v228
v_mul_f32 v113, v113, v229
v_mfma_f32_16x16x32_bf16 v[148:151], v[68:71], v[176:179], v[148:151]
v_exp_f32 v112, v112
v_exp_f32 v113, v113
v_mfma_f32_16x16x32_bf16 v[156:159], v[68:71], v[180:183], v[156:159]
v_add_f32 v112, 1.0, v112
v_add_f32 v113, 1.0, v113
v_mfma_f32_16x16x32_bf16 v[164:167], v[68:71], v[184:187], v[164:167]
v_rcp_f32 v112, v112
v_rcp_f32 v113, v113
v_mfma_f32_16x16x32_bf16 v[172:175], v[68:71], v[188:191], v[172:175]
v_mul_f32 v228, v228, v112
v_mul_f32 v229, v229, v113
s_waitcnt lgkmcnt(0)
s_waitcnt vmcnt(12)
v_mfma_f32_16x16x32_bf16 v[144:147], v[72:75], v[192:195], v[144:147]
v_lshlrev_b32 v230, 16, v107
v_and_b32 v231, 0xffff0000, v107
ds_read_b128 v[176:179], v138 offset:8192
ds_read_b128 v[180:183], v138 offset:10240
v_mfma_f32_16x16x32_bf16 v[152:155], v[72:75], v[196:199], v[152:155]
v_mul_f32 v114, v230, v230
v_mul_f32 v115, v231, v231
ds_read_b128 v[184:187], v138 offset:12288
v_mfma_f32_16x16x32_bf16 v[160:163], v[72:75], v[200:203], v[160:163]
v_fma_f32 v114, v114, v240, v241
v_fma_f32 v115, v115, v240, v241
ds_read_b128 v[188:191], v138 offset:14336
v_mfma_f32_16x16x32_bf16 v[168:171], v[72:75], v[204:207], v[168:171]
v_mul_f32 v114, v114, v230
v_mul_f32 v115, v115, v231
v_mfma_f32_16x16x32_bf16 v[148:151], v[76:79], v[192:195], v[148:151]
v_exp_f32 v114, v114
v_exp_f32 v115, v115
v_mfma_f32_16x16x32_bf16 v[156:159], v[76:79], v[196:199], v[156:159]
v_add_f32 v114, 1.0, v114
v_add_f32 v115, 1.0, v115
v_mfma_f32_16x16x32_bf16 v[164:167], v[76:79], v[200:203], v[164:167]
v_rcp_f32 v114, v114
v_rcp_f32 v115, v115
v_mfma_f32_16x16x32_bf16 v[172:175], v[76:79], v[204:207], v[172:175]
v_mul_f32 v230, v230, v114
v_mul_f32 v231, v231, v115
s_waitcnt lgkmcnt(0)
s_waitcnt vmcnt(10)
v_mfma_f32_16x16x32_bf16 v[144:147], v[80:83], v[176:179], v[144:147]
v_lshlrev_b32 v232, 16, v108
v_and_b32 v233, 0xffff0000, v108
ds_read_b128 v[192:195], v139 offset:8192
ds_read_b128 v[196:199], v139 offset:10240
v_mfma_f32_16x16x32_bf16 v[152:155], v[80:83], v[180:183], v[152:155]
v_mul_f32 v112, v232, v232
v_mul_f32 v113, v233, v233
ds_read_b128 v[200:203], v139 offset:12288
v_mfma_f32_16x16x32_bf16 v[160:163], v[80:83], v[184:187], v[160:163]
v_fma_f32 v112, v112, v240, v241
v_fma_f32 v113, v113, v240, v241
ds_read_b128 v[204:207], v139 offset:14336
v_mfma_f32_16x16x32_bf16 v[168:171], v[80:83], v[188:191], v[168:171]
v_mul_f32 v112, v112, v232
v_mul_f32 v113, v113, v233
v_lshlrev_b32 v244, 4, v250
s_lshl_b32 s20, s36, 2
s_add_u32 s20, s20, s3
s_mul_i32 s43, s20, 20480
s_add_u32 s43, s43, 20971520
s_mul_i32 s44, s20, 28672
s_add_u32 s44, s44, 16777216
v_mfma_f32_16x16x32_bf16 v[148:151], v[84:87], v[176:179], v[148:151]
v_exp_f32 v112, v112
v_exp_f32 v113, v113
v_mfma_f32_16x16x32_bf16 v[156:159], v[84:87], v[180:183], v[156:159]
v_add_f32 v112, 1.0, v112
v_add_f32 v113, 1.0, v113
v_mfma_f32_16x16x32_bf16 v[164:167], v[84:87], v[184:187], v[164:167]
v_rcp_f32 v112, v112
v_rcp_f32 v113, v113
v_mfma_f32_16x16x32_bf16 v[172:175], v[84:87], v[188:191], v[172:175]
v_mul_f32 v232, v232, v112
v_mul_f32 v233, v233, v113
s_waitcnt lgkmcnt(0)
s_barrier
s_waitcnt vmcnt(8)
v_mfma_f32_16x16x32_bf16 v[144:147], v[88:91], v[192:195], v[144:147]
v_lshlrev_b32 v234, 16, v109
v_and_b32 v235, 0xffff0000, v109
ds_read_b128 v[176:179], v136 offset:0
ds_read_b128 v[180:183], v136 offset:2048
v_mfma_f32_16x16x32_bf16 v[152:155], v[88:91], v[196:199], v[152:155]
v_mul_f32 v114, v234, v234
v_mul_f32 v115, v235, v235
ds_read_b128 v[184:187], v136 offset:4096
v_mfma_f32_16x16x32_bf16 v[160:163], v[88:91], v[200:203], v[160:163]
v_fma_f32 v114, v114, v240, v241
v_fma_f32 v115, v115, v240, v241
ds_read_b128 v[188:191], v136 offset:6144
v_mfma_f32_16x16x32_bf16 v[168:171], v[88:91], v[204:207], v[168:171]
v_mul_f32 v114, v114, v234
v_mul_f32 v115, v115, v235
v_mfma_f32_16x16x32_bf16 v[148:151], v[92:95], v[192:195], v[148:151]
v_exp_f32 v114, v114
v_exp_f32 v115, v115
v_mfma_f32_16x16x32_bf16 v[156:159], v[92:95], v[196:199], v[156:159]
v_add_f32 v114, 1.0, v114
v_add_f32 v115, 1.0, v115
v_mfma_f32_16x16x32_bf16 v[164:167], v[92:95], v[200:203], v[164:167]
v_rcp_f32 v114, v114
v_rcp_f32 v115, v115
v_mfma_f32_16x16x32_bf16 v[172:175], v[92:95], v[204:207], v[172:175]
v_mul_f32 v234, v234, v114
v_mul_f32 v235, v235, v115
s_waitcnt lgkmcnt(0)
s_waitcnt vmcnt(6)
v_mfma_f32_16x16x32_bf16 v[144:147], v[0:3], v[176:179], v[144:147]
v_lshlrev_b32 v236, 16, v110
v_and_b32 v237, 0xffff0000, v110
ds_read_b128 v[192:195], v137 offset:0
ds_read_b128 v[196:199], v137 offset:2048
v_mfma_f32_16x16x32_bf16 v[152:155], v[0:3], v[180:183], v[152:155]
v_mul_f32 v112, v236, v236
v_mul_f32 v113, v237, v237
ds_read_b128 v[200:203], v137 offset:4096
v_mfma_f32_16x16x32_bf16 v[160:163], v[0:3], v[184:187], v[160:163]
v_fma_f32 v112, v112, v240, v241
v_fma_f32 v113, v113, v240, v241
ds_read_b128 v[204:207], v137 offset:6144
v_mfma_f32_16x16x32_bf16 v[168:171], v[0:3], v[188:191], v[168:171]
v_mul_f32 v112, v112, v236
v_mul_f32 v113, v113, v237
v_mfma_f32_16x16x32_bf16 v[148:151], v[4:7], v[176:179], v[148:151]
v_exp_f32 v112, v112
v_exp_f32 v113, v113
v_mfma_f32_16x16x32_bf16 v[156:159], v[4:7], v[180:183], v[156:159]
v_add_f32 v112, 1.0, v112
v_add_f32 v113, 1.0, v113
v_mfma_f32_16x16x32_bf16 v[164:167], v[4:7], v[184:187], v[164:167]
v_rcp_f32 v112, v112
v_rcp_f32 v113, v113
v_mfma_f32_16x16x32_bf16 v[172:175], v[4:7], v[188:191], v[172:175]
v_mul_f32 v236, v236, v112
v_mul_f32 v237, v237, v113
s_waitcnt lgkmcnt(0)
s_waitcnt vmcnt(4)
v_mfma_f32_16x16x32_bf16 v[144:147], v[8:11], v[192:195], v[144:147]
v_lshlrev_b32 v238, 16, v111
v_and_b32 v239, 0xffff0000, v111
ds_read_b128 v[176:179], v136 offset:8192
ds_read_b128 v[180:183], v136 offset:10240
v_mfma_f32_16x16x32_bf16 v[152:155], v[8:11], v[196:199], v[152:155]
v_mul_f32 v114, v238, v238
v_mul_f32 v115, v239, v239
ds_read_b128 v[184:187], v136 offset:12288
v_mfma_f32_16x16x32_bf16 v[160:163], v[8:11], v[200:203], v[160:163]
v_fma_f32 v114, v114, v240, v241
v_fma_f32 v115, v115, v240, v241
ds_read_b128 v[188:191], v136 offset:14336
v_mfma_f32_16x16x32_bf16 v[168:171], v[8:11], v[204:207], v[168:171]
v_mul_f32 v114, v114, v238
v_mul_f32 v115, v115, v239
v_mfma_f32_16x16x32_bf16 v[148:151], v[12:15], v[192:195], v[148:151]
v_exp_f32 v114, v114
v_exp_f32 v115, v115
v_mfma_f32_16x16x32_bf16 v[156:159], v[12:15], v[196:199], v[156:159]
v_add_f32 v114, 1.0, v114
v_add_f32 v115, 1.0, v115
v_mfma_f32_16x16x32_bf16 v[164:167], v[12:15], v[200:203], v[164:167]
v_rcp_f32 v114, v114
v_rcp_f32 v115, v115
v_mfma_f32_16x16x32_bf16 v[172:175], v[12:15], v[204:207], v[172:175]
v_mul_f32 v238, v238, v114
v_mul_f32 v239, v239, v115
s_waitcnt lgkmcnt(0)
s_waitcnt vmcnt(2)
v_mfma_f32_16x16x32_bf16 v[144:147], v[16:19], v[176:179], v[144:147]
ds_read_b128 v[192:195], v137 offset:8192
ds_read_b128 v[196:199], v137 offset:10240
v_mfma_f32_16x16x32_bf16 v[152:155], v[16:19], v[180:183], v[152:155]
ds_read_b128 v[200:203], v137 offset:12288
v_mfma_f32_16x16x32_bf16 v[160:163], v[16:19], v[184:187], v[160:163]
ds_read_b128 v[204:207], v137 offset:14336
v_mfma_f32_16x16x32_bf16 v[168:171], v[16:19], v[188:191], v[168:171]
v_mfma_f32_16x16x32_bf16 v[148:151], v[20:23], v[176:179], v[148:151]
v_mfma_f32_16x16x32_bf16 v[156:159], v[20:23], v[180:183], v[156:159]
v_mfma_f32_16x16x32_bf16 v[164:167], v[20:23], v[184:187], v[164:167]
v_mfma_f32_16x16x32_bf16 v[172:175], v[20:23], v[188:191], v[172:175]
s_waitcnt lgkmcnt(0)
s_barrier
s_waitcnt vmcnt(0)
v_mfma_f32_16x16x32_bf16 v[144:147], v[24:27], v[192:195], v[144:147]
v_add_u32 v136, 0x10000, v244
v_add_u32 v137, 0x20000, v244
v_mfma_f32_16x16x32_bf16 v[152:155], v[24:27], v[196:199], v[152:155]
ds_read_b128 v[0:3], v136 offset:57344
ds_read_b128 v[4:7], v136 offset:58368
v_mfma_f32_16x16x32_bf16 v[160:163], v[24:27], v[200:203], v[160:163]
ds_read_b128 v[8:11], v136 offset:59392
ds_read_b128 v[12:15], v136 offset:60416
v_mfma_f32_16x16x32_bf16 v[168:171], v[24:27], v[204:207], v[168:171]
ds_read_b128 v[16:19], v136 offset:61440
s_add_u32 s20, s43, 0
buffer_load_dwordx4 v[32:35], v244, s[8:11], s20 offen offset:0 sc1
v_mfma_f32_16x16x32_bf16 v[148:151], v[28:31], v[192:195], v[148:151]
s_add_u32 s20, s43, 0
buffer_load_dwordx4 v[36:39], v244, s[8:11], s20 offen offset:1024 sc1
s_add_u32 s20, s43, 0
buffer_load_dwordx4 v[40:43], v244, s[8:11], s20 offen offset:2048 sc1
v_mfma_f32_16x16x32_bf16 v[156:159], v[28:31], v[196:199], v[156:159]
s_add_u32 s20, s43, 0
buffer_load_dwordx4 v[44:47], v244, s[8:11], s20 offen offset:3072 sc1
s_add_u32 s20, s43, 4096
buffer_load_dwordx4 v[48:51], v244, s[8:11], s20 offen offset:0 sc1
v_mfma_f32_16x16x32_bf16 v[164:167], v[28:31], v[200:203], v[164:167]
s_add_u32 s20, s43, 4096
buffer_load_dwordx4 v[52:55], v244, s[8:11], s20 offen offset:1024 sc1
s_add_u32 s20, s43, 4096
buffer_load_dwordx4 v[56:59], v244, s[8:11], s20 offen offset:2048 sc1
v_mfma_f32_16x16x32_bf16 v[172:175], v[28:31], v[204:207], v[172:175]
s_add_u32 s20, s43, 4096
buffer_load_dwordx4 v[60:63], v244, s[8:11], s20 offen offset:3072 sc1
s_add_u32 s20, s43, 8192
buffer_load_dwordx4 v[64:67], v244, s[8:11], s20 offen offset:0 sc1
s_add_u32 s20, s43, 8192
buffer_load_dwordx4 v[68:71], v244, s[8:11], s20 offen offset:1024 sc1
s_add_u32 s20, s43, 8192
buffer_load_dwordx4 v[72:75], v244, s[8:11], s20 offen offset:2048 sc1
s_add_u32 s20, s43, 8192
buffer_load_dwordx4 v[76:79], v244, s[8:11], s20 offen offset:3072 sc1
s_add_u32 s20, s43, 12288
buffer_load_dwordx4 v[80:83], v244, s[8:11], s20 offen offset:0 sc1
s_add_u32 s20, s43, 12288
buffer_load_dwordx4 v[84:87], v244, s[8:11], s20 offen offset:1024 sc1
s_add_u32 s20, s43, 12288
buffer_load_dwordx4 v[88:91], v244, s[8:11], s20 offen offset:2048 sc1
s_add_u32 s20, s43, 12288
buffer_load_dwordx4 v[92:95], v244, s[8:11], s20 offen offset:3072 sc1
s_add_u32 s20, s43, 16384
buffer_load_dwordx4 v[96:99], v244, s[8:11], s20 offen offset:0 sc1
s_add_u32 s20, s43, 16384
buffer_load_dwordx4 v[100:103], v244, s[8:11], s20 offen offset:1024 sc1
s_add_u32 s20, s43, 16384
buffer_load_dwordx4 v[104:107], v244, s[8:11], s20 offen offset:2048 sc1
s_add_u32 s20, s43, 16384
buffer_load_dwordx4 v[108:111], v244, s[8:11], s20 offen offset:3072 sc1
ds_read_b128 v[176:179], v136 offset:62464
ds_read_b128 v[180:183], v136 offset:63488
ds_read_b128 v[184:187], v136 offset:64512
ds_read_b128 v[188:191], v137 offset:0
ds_read_b128 v[192:195], v137 offset:1024
v_permlane16_swap_b32 v144, v148
v_permlane16_swap_b32 v145, v149
v_permlane16_swap_b32 v146, v150
v_permlane16_swap_b32 v147, v151
v_pk_mul_f32 v[144:145], v[144:145], v[208:209]
v_pk_mul_f32 v[146:147], v[146:147], v[210:211]
v_pk_mul_f32 v[148:149], v[148:149], v[212:213]
v_pk_mul_f32 v[150:151], v[150:151], v[214:215]
v_cvt_pk_bf16_f32 v132, v144, v145
v_cvt_pk_bf16_f32 v133, v146, v147
v_cvt_pk_bf16_f32 v134, v148, v149
v_cvt_pk_bf16_f32 v135, v150, v151
s_mov_b32 s42, 0
buffer_store_dwordx4 v[132:135], v245, s[8:11], s42 offen sc1
v_permlane16_swap_b32 v152, v156
v_permlane16_swap_b32 v153, v157
v_permlane16_swap_b32 v154, v158
v_permlane16_swap_b32 v155, v159
v_pk_mul_f32 v[152:153], v[152:153], v[216:217]
v_pk_mul_f32 v[154:155], v[154:155], v[218:219]
v_pk_mul_f32 v[156:157], v[156:157], v[220:221]
v_pk_mul_f32 v[158:159], v[158:159], v[222:223]
v_cvt_pk_bf16_f32 v140, v152, v153
v_cvt_pk_bf16_f32 v141, v154, v155
v_cvt_pk_bf16_f32 v142, v156, v157
v_cvt_pk_bf16_f32 v143, v158, v159
s_mov_b32 s42, 28672
buffer_store_dwordx4 v[140:143], v245, s[8:11], s42 offen sc1
v_permlane16_swap_b32 v160, v164
v_permlane16_swap_b32 v161, v165
v_permlane16_swap_b32 v162, v166
v_permlane16_swap_b32 v163, v167
v_pk_mul_f32 v[160:161], v[160:161], v[224:225]
v_pk_mul_f32 v[162:163], v[162:163], v[226:227]
v_pk_mul_f32 v[164:165], v[164:165], v[228:229]
v_pk_mul_f32 v[166:167], v[166:167], v[230:231]
v_cvt_pk_bf16_f32 v132, v160, v161
v_cvt_pk_bf16_f32 v133, v162, v163
v_cvt_pk_bf16_f32 v134, v164, v165
v_cvt_pk_bf16_f32 v135, v166, v167
s_mov_b32 s42, 57344
buffer_store_dwordx4 v[132:135], v245, s[8:11], s42 offen sc1
v_permlane16_swap_b32 v168, v172
v_permlane16_swap_b32 v169, v173
v_permlane16_swap_b32 v170, v174
v_permlane16_swap_b32 v171, v175
v_pk_mul_f32 v[168:169], v[168:169], v[232:233]
v_pk_mul_f32 v[170:171], v[170:171], v[234:235]
v_pk_mul_f32 v[172:173], v[172:173], v[236:237]
v_pk_mul_f32 v[174:175], v[174:175], v[238:239]
v_cvt_pk_bf16_f32 v140, v168, v169
v_cvt_pk_bf16_f32 v141, v170, v171
v_cvt_pk_bf16_f32 v142, v172, v173
v_cvt_pk_bf16_f32 v143, v174, v175
s_mov_b32 s42, 86016
buffer_store_dwordx4 v[140:143], v245, s[8:11], s42 offen sc1
s_lshl_b32 s20, s36, 5
s_lshl_b32 s21, s37, 2
s_add_u32 s20, s20, s21
s_add_u32 s20, s20, s3
s_lshl_b32 s20, s20, 2
s_add_u32 s20, s20, 31477760
v_mov_b32 v166, 0x40000000
v_mov_b32 v168, s20
v_cmp_eq_u32 vcc, 0, v250
v_mov_b32 v167, s34
s_nop 0
v_cndmask_b32 v166, v166, v168, vcc
s_lshl_b32 s20, s36, 6
s_lshl_b32 s21, s3, 4
s_add_u32 s20, s20, s21
v_add_u32 v168, s20, v246
v_mul_u32_u24 v168, 1280, v168
s_mul_i32 s20, s37, 160
v_add_u32 v168, s20, v168
v_lshl_add_u32 v164, v253, 4, v168
v_lshl_add_u32 v165, v247, 3, v168
s_mov_b32 s16, s64
s_mov_b32 s17, s65
s_mov_b32 s18, 0x280000
s_mov_b32 s19, 0x20000
buffer_load_dwordx4 v[20:23], v164, s[16:19], 0 offen
buffer_load_dwordx4 v[24:27], v164, s[16:19], 0 offen offset:64
buffer_load_dwordx2 v[28:29], v165, s[16:19], 0 offen offset:128
s_waitcnt vmcnt(26)
s_waitcnt lgkmcnt(5)
v_mfma_f32_16x16x32_bf16 v[112:115], v[0:3], v[32:35], 0
ds_read_b128 v[196:199], v137 offset:2048
ds_read_b128 v[200:203], v137 offset:3072
v_mfma_f32_16x16x32_bf16 v[116:119], v[4:7], v[32:35], 0
ds_read_b128 v[204:207], v137 offset:4096
ds_read_b128 v[208:211], v137 offset:5120
v_mfma_f32_16x16x32_bf16 v[120:123], v[8:11], v[32:35], 0
ds_read_b128 v[212:215], v137 offset:6144
v_mfma_f32_16x16x32_bf16 v[124:127], v[12:15], v[32:35], 0
v_mfma_f32_16x16x32_bf16 v[128:131], v[16:19], v[32:35], 0
s_waitcnt vmcnt(25)
s_waitcnt lgkmcnt(5)
v_mfma_f32_16x16x32_bf16 v[112:115], v[176:179], v[36:39], v[112:115]
ds_read_b128 v[0:3], v137 offset:7168
ds_read_b128 v[4:7], v137 offset:8192
v_mfma_f32_16x16x32_bf16 v[116:119], v[180:183], v[36:39], v[116:119]
ds_read_b128 v[8:11], v137 offset:9216
ds_read_b128 v[12:15], v137 offset:10240
v_mfma_f32_16x16x32_bf16 v[120:123], v[184:187], v[36:39], v[120:123]
ds_read_b128 v[16:19], v137 offset:11264
v_mfma_f32_16x16x32_bf16 v[124:127], v[188:191], v[36:39], v[124:127]
v_mfma_f32_16x16x32_bf16 v[128:131], v[192:195], v[36:39], v[128:131]
s_barrier
s_waitcnt vmcnt(24)
s_waitcnt lgkmcnt(5)
v_mfma_f32_16x16x32_bf16 v[112:115], v[196:199], v[40:43], v[112:115]
ds_read_b128 v[176:179], v137 offset:12288
ds_read_b128 v[180:183], v137 offset:13312
v_mfma_f32_16x16x32_bf16 v[116:119], v[200:203], v[40:43], v[116:119]
ds_read_b128 v[184:187], v137 offset:14336
ds_read_b128 v[188:191], v137 offset:15360
v_mfma_f32_16x16x32_bf16 v[120:123], v[204:207], v[40:43], v[120:123]
ds_read_b128 v[192:195], v137 offset:16384
v_mfma_f32_16x16x32_bf16 v[124:127], v[208:211], v[40:43], v[124:127]
v_mfma_f32_16x16x32_bf16 v[128:131], v[212:215], v[40:43], v[128:131]
s_waitcnt vmcnt(23)
s_waitcnt lgkmcnt(5)
v_mfma_f32_16x16x32_bf16 v[112:115], v[0:3], v[44:47], v[112:115]
ds_read_b128 v[196:199], v137 offset:17408
ds_read_b128 v[200:203], v137 offset:18432
v_mfma_f32_16x16x32_bf16 v[116:119], v[4:7], v[44:47], v[116:119]
ds_read_b128 v[204:207], v137 offset:19456
ds_read_b128 v[208:211], v137 offset:20480
v_mfma_f32_16x16x32_bf16 v[120:123], v[8:11], v[44:47], v[120:123]
ds_read_b128 v[212:215], v137 offset:21504
v_mfma_f32_16x16x32_bf16 v[124:127], v[12:15], v[44:47], v[124:127]
v_mfma_f32_16x16x32_bf16 v[128:131], v[16:19], v[44:47], v[128:131]
s_waitcnt vmcnt(22)
s_waitcnt lgkmcnt(5)
v_mfma_f32_16x16x32_bf16 v[112:115], v[176:179], v[48:51], v[112:115]
ds_read_b128 v[0:3], v137 offset:22528
ds_read_b128 v[4:7], v137 offset:23552
v_mfma_f32_16x16x32_bf16 v[116:119], v[180:183], v[48:51], v[116:119]
ds_read_b128 v[8:11], v137 offset:24576
ds_read_b128 v[12:15], v137 offset:25600
v_mfma_f32_16x16x32_bf16 v[120:123], v[184:187], v[48:51], v[120:123]
ds_read_b128 v[16:19], v137 offset:26624
v_mfma_f32_16x16x32_bf16 v[124:127], v[188:191], v[48:51], v[124:127]
v_mfma_f32_16x16x32_bf16 v[128:131], v[192:195], v[48:51], v[128:131]
s_waitcnt vmcnt(21)
s_waitcnt lgkmcnt(5)
v_mfma_f32_16x16x32_bf16 v[112:115], v[196:199], v[52:55], v[112:115]
ds_read_b128 v[176:179], v137 offset:27648
ds_read_b128 v[180:183], v137 offset:28672
v_mfma_f32_16x16x32_bf16 v[116:119], v[200:203], v[52:55], v[116:119]
ds_read_b128 v[184:187], v137 offset:29696
ds_read_b128 v[188:191], v137 offset:30720
v_mfma_f32_16x16x32_bf16 v[120:123], v[204:207], v[52:55], v[120:123]
ds_read_b128 v[192:195], v137 offset:31744
v_mfma_f32_16x16x32_bf16 v[124:127], v[208:211], v[52:55], v[124:127]
v_mfma_f32_16x16x32_bf16 v[128:131], v[212:215], v[52:55], v[128:131]
s_waitcnt vmcnt(3)
buffer_store_dword v167, v166, s[8:11], 0 offen sc1
s_barrier
s_waitcnt lgkmcnt(5)
v_mfma_f32_16x16x32_bf16 v[112:115], v[0:3], v[56:59], v[112:115]
ds_read_b128 v[196:199], v136 offset:16384
ds_read_b128 v[200:203], v136 offset:17408
v_mfma_f32_16x16x32_bf16 v[116:119], v[4:7], v[56:59], v[116:119]
ds_read_b128 v[204:207], v136 offset:18432
ds_read_b128 v[208:211], v136 offset:19456
v_mfma_f32_16x16x32_bf16 v[120:123], v[8:11], v[56:59], v[120:123]
ds_read_b128 v[212:215], v136 offset:20480
v_mfma_f32_16x16x32_bf16 v[124:127], v[12:15], v[56:59], v[124:127]
v_mfma_f32_16x16x32_bf16 v[128:131], v[16:19], v[56:59], v[128:131]
s_waitcnt lgkmcnt(5)
v_mfma_f32_16x16x32_bf16 v[112:115], v[176:179], v[60:63], v[112:115]
ds_read_b128 v[0:3], v136 offset:21504
ds_read_b128 v[4:7], v136 offset:22528
v_mfma_f32_16x16x32_bf16 v[116:119], v[180:183], v[60:63], v[116:119]
ds_read_b128 v[8:11], v136 offset:23552
ds_read_b128 v[12:15], v136 offset:24576
v_mfma_f32_16x16x32_bf16 v[120:123], v[184:187], v[60:63], v[120:123]
ds_read_b128 v[16:19], v136 offset:25600
v_mfma_f32_16x16x32_bf16 v[124:127], v[188:191], v[60:63], v[124:127]
v_mfma_f32_16x16x32_bf16 v[128:131], v[192:195], v[60:63], v[128:131]
s_waitcnt lgkmcnt(5)
v_mfma_f32_16x16x32_bf16 v[112:115], v[196:199], v[64:67], v[112:115]
ds_read_b128 v[176:179], v136 offset:26624
ds_read_b128 v[180:183], v136 offset:27648
v_mfma_f32_16x16x32_bf16 v[116:119], v[200:203], v[64:67], v[116:119]
ds_read_b128 v[184:187], v136 offset:28672
ds_read_b128 v[188:191], v136 offset:29696
v_mfma_f32_16x16x32_bf16 v[120:123], v[204:207], v[64:67], v[120:123]
ds_read_b128 v[192:195], v136 offset:30720
v_mfma_f32_16x16x32_bf16 v[124:127], v[208:211], v[64:67], v[124:127]
v_mfma_f32_16x16x32_bf16 v[128:131], v[212:215], v[64:67], v[128:131]
s_waitcnt lgkmcnt(5)
v_mfma_f32_16x16x32_bf16 v[112:115], v[0:3], v[68:71], v[112:115]
ds_read_b128 v[196:199], v136 offset:31744
ds_read_b128 v[200:203], v136 offset:32768
v_mfma_f32_16x16x32_bf16 v[116:119], v[4:7], v[68:71], v[116:119]
ds_read_b128 v[204:207], v136 offset:33792
ds_read_b128 v[208:211], v136 offset:34816
v_mfma_f32_16x16x32_bf16 v[120:123], v[8:11], v[68:71], v[120:123]
ds_read_b128 v[212:215], v136 offset:35840
v_mfma_f32_16x16x32_bf16 v[124:127], v[12:15], v[68:71], v[124:127]
v_mfma_f32_16x16x32_bf16 v[128:131], v[16:19], v[68:71], v[128:131]
s_barrier
s_waitcnt lgkmcnt(5)
v_mfma_f32_16x16x32_bf16 v[112:115], v[176:179], v[72:75], v[112:115]
ds_read_b128 v[0:3], v136 offset:36864
ds_read_b128 v[4:7], v136 offset:37888
v_mfma_f32_16x16x32_bf16 v[116:119], v[180:183], v[72:75], v[116:119]
ds_read_b128 v[8:11], v136 offset:38912
ds_read_b128 v[12:15], v136 offset:39936
v_mfma_f32_16x16x32_bf16 v[120:123], v[184:187], v[72:75], v[120:123]
ds_read_b128 v[16:19], v136 offset:40960
v_mfma_f32_16x16x32_bf16 v[124:127], v[188:191], v[72:75], v[124:127]
v_mfma_f32_16x16x32_bf16 v[128:131], v[192:195], v[72:75], v[128:131]
s_waitcnt lgkmcnt(5)
v_mfma_f32_16x16x32_bf16 v[112:115], v[196:199], v[76:79], v[112:115]
ds_read_b128 v[176:179], v136 offset:41984
ds_read_b128 v[180:183], v136 offset:43008
v_mfma_f32_16x16x32_bf16 v[116:119], v[200:203], v[76:79], v[116:119]
ds_read_b128 v[184:187], v136 offset:44032
ds_read_b128 v[188:191], v136 offset:45056
v_mfma_f32_16x16x32_bf16 v[120:123], v[204:207], v[76:79], v[120:123]
ds_read_b128 v[192:195], v136 offset:46080
v_mfma_f32_16x16x32_bf16 v[124:127], v[208:211], v[76:79], v[124:127]
v_mfma_f32_16x16x32_bf16 v[128:131], v[212:215], v[76:79], v[128:131]
s_waitcnt lgkmcnt(5)
v_mfma_f32_16x16x32_bf16 v[112:115], v[0:3], v[80:83], v[112:115]
ds_read_b128 v[196:199], v136 offset:47104
ds_read_b128 v[200:203], v136 offset:48128
v_mfma_f32_16x16x32_bf16 v[116:119], v[4:7], v[80:83], v[116:119]
ds_read_b128 v[204:207], v136 offset:49152
ds_read_b128 v[208:211], v136 offset:50176
v_mfma_f32_16x16x32_bf16 v[120:123], v[8:11], v[80:83], v[120:123]
ds_read_b128 v[212:215], v136 offset:51200
v_mfma_f32_16x16x32_bf16 v[124:127], v[12:15], v[80:83], v[124:127]
v_mfma_f32_16x16x32_bf16 v[128:131], v[16:19], v[80:83], v[128:131]
s_waitcnt lgkmcnt(5)
v_mfma_f32_16x16x32_bf16 v[112:115], v[176:179], v[84:87], v[112:115]
ds_read_b128 v[0:3], v136 offset:52224
ds_read_b128 v[4:7], v136 offset:53248
v_mfma_f32_16x16x32_bf16 v[116:119], v[180:183], v[84:87], v[116:119]
ds_read_b128 v[8:11], v136 offset:54272
ds_read_b128 v[12:15], v136 offset:55296
v_mfma_f32_16x16x32_bf16 v[120:123], v[184:187], v[84:87], v[120:123]
ds_read_b128 v[16:19], v136 offset:56320
v_mfma_f32_16x16x32_bf16 v[124:127], v[188:191], v[84:87], v[124:127]
v_mfma_f32_16x16x32_bf16 v[128:131], v[192:195], v[84:87], v[128:131]
s_barrier
s_waitcnt lgkmcnt(5)
v_mfma_f32_16x16x32_bf16 v[112:115], v[196:199], v[88:91], v[112:115]
ds_read_b128 v[176:179], v244 offset:16384
ds_read_b128 v[180:183], v244 offset:17408
v_mfma_f32_16x16x32_bf16 v[116:119], v[200:203], v[88:91], v[116:119]
ds_read_b128 v[184:187], v244 offset:18432
ds_read_b128 v[188:191], v244 offset:19456
v_mfma_f32_16x16x32_bf16 v[120:123], v[204:207], v[88:91], v[120:123]
ds_read_b128 v[192:195], v244 offset:20480
v_mfma_f32_16x16x32_bf16 v[124:127], v[208:211], v[88:91], v[124:127]
v_mfma_f32_16x16x32_bf16 v[128:131], v[212:215], v[88:91], v[128:131]
s_waitcnt lgkmcnt(5)
v_mfma_f32_16x16x32_bf16 v[112:115], v[0:3], v[92:95], v[112:115]
ds_read_b128 v[196:199], v244 offset:21504
ds_read_b128 v[200:203], v244 offset:22528
v_mfma_f32_16x16x32_bf16 v[116:119], v[4:7], v[92:95], v[116:119]
ds_read_b128 v[204:207], v244 offset:23552
ds_read_b128 v[208:211], v244 offset:24576
v_mfma_f32_16x16x32_bf16 v[120:123], v[8:11], v[92:95], v[120:123]
ds_read_b128 v[212:215], v244 offset:25600
v_mfma_f32_16x16x32_bf16 v[124:127], v[12:15], v[92:95], v[124:127]
v_mfma_f32_16x16x32_bf16 v[128:131], v[16:19], v[92:95], v[128:131]
s_waitcnt lgkmcnt(5)
v_mfma_f32_16x16x32_bf16 v[112:115], v[176:179], v[96:99], v[112:115]
ds_read_b128 v[0:3], v244 offset:26624
ds_read_b128 v[4:7], v244 offset:27648
v_mfma_f32_16x16x32_bf16 v[116:119], v[180:183], v[96:99], v[116:119]
ds_read_b128 v[8:11], v244 offset:28672
ds_read_b128 v[12:15], v244 offset:29696
v_mfma_f32_16x16x32_bf16 v[120:123], v[184:187], v[96:99], v[120:123]
ds_read_b128 v[16:19], v244 offset:30720
v_mfma_f32_16x16x32_bf16 v[124:127], v[188:191], v[96:99], v[124:127]
v_mfma_f32_16x16x32_bf16 v[128:131], v[192:195], v[96:99], v[128:131]
s_waitcnt lgkmcnt(5)
v_mfma_f32_16x16x32_bf16 v[112:115], v[196:199], v[100:103], v[112:115]
ds_read_b128 v[176:179], v244 offset:31744
ds_read_b128 v[180:183], v244 offset:32768
v_mfma_f32_16x16x32_bf16 v[116:119], v[200:203], v[100:103], v[116:119]
ds_read_b128 v[184:187], v244 offset:33792
ds_read_b128 v[188:191], v244 offset:34816
v_mfma_f32_16x16x32_bf16 v[120:123], v[204:207], v[100:103], v[120:123]
ds_read_b128 v[192:195], v244 offset:35840
v_mfma_f32_16x16x32_bf16 v[124:127], v[208:211], v[100:103], v[124:127]
v_mfma_f32_16x16x32_bf16 v[128:131], v[212:215], v[100:103], v[128:131]
s_barrier
s_add_u32 s20, s44, 0
buffer_load_dwordx4 v[32:35], v244, s[8:11], s20 offen offset:0 sc1
s_add_u32 s20, s44, 0
buffer_load_dwordx4 v[36:39], v244, s[8:11], s20 offen offset:1024 sc1
s_add_u32 s20, s44, 0
buffer_load_dwordx4 v[40:43], v244, s[8:11], s20 offen offset:2048 sc1
s_add_u32 s20, s44, 0
buffer_load_dwordx4 v[44:47], v244, s[8:11], s20 offen offset:3072 sc1
s_add_u32 s20, s44, 4096
buffer_load_dwordx4 v[48:51], v244, s[8:11], s20 offen offset:0 sc1
s_add_u32 s20, s44, 4096
buffer_load_dwordx4 v[52:55], v244, s[8:11], s20 offen offset:1024 sc1
s_add_u32 s20, s44, 4096
buffer_load_dwordx4 v[56:59], v244, s[8:11], s20 offen offset:2048 sc1
s_add_u32 s20, s44, 4096
buffer_load_dwordx4 v[60:63], v244, s[8:11], s20 offen offset:3072 sc1
s_add_u32 s20, s44, 8192
buffer_load_dwordx4 v[64:67], v244, s[8:11], s20 offen offset:0 sc1
s_add_u32 s20, s44, 8192
buffer_load_dwordx4 v[68:71], v244, s[8:11], s20 offen offset:1024 sc1
s_waitcnt lgkmcnt(5)
v_mfma_f32_16x16x32_bf16 v[112:115], v[0:3], v[104:107], v[112:115]
ds_read_b128 v[196:199], v244 offset:36864
ds_read_b128 v[200:203], v244 offset:37888
v_mfma_f32_16x16x32_bf16 v[116:119], v[4:7], v[104:107], v[116:119]
ds_read_b128 v[204:207], v244 offset:38912
ds_read_b128 v[208:211], v244 offset:39936
v_mfma_f32_16x16x32_bf16 v[120:123], v[8:11], v[104:107], v[120:123]
ds_read_b128 v[212:215], v244 offset:40960
v_mfma_f32_16x16x32_bf16 v[124:127], v[12:15], v[104:107], v[124:127]
v_mfma_f32_16x16x32_bf16 v[128:131], v[16:19], v[104:107], v[128:131]
s_waitcnt lgkmcnt(5)
v_mfma_f32_16x16x32_bf16 v[112:115], v[176:179], v[108:111], v[112:115]
ds_read_b128 v[0:3], v244 offset:41984
ds_read_b128 v[4:7], v244 offset:43008
v_mfma_f32_16x16x32_bf16 v[116:119], v[180:183], v[108:111], v[116:119]
ds_read_b128 v[8:11], v244 offset:44032
ds_read_b128 v[12:15], v244 offset:45056
v_mfma_f32_16x16x32_bf16 v[120:123], v[184:187], v[108:111], v[120:123]
ds_read_b128 v[16:19], v244 offset:46080
v_mfma_f32_16x16x32_bf16 v[124:127], v[188:191], v[108:111], v[124:127]
v_mfma_f32_16x16x32_bf16 v[128:131], v[192:195], v[108:111], v[128:131]
s_waitcnt vmcnt(9)
s_waitcnt lgkmcnt(5)
v_mfma_f32_16x16x32_bf16 v[144:147], v[196:199], v[32:35], 0
s_add_u32 s20, s44, 8192
buffer_load_dwordx4 v[72:75], v244, s[8:11], s20 offen offset:2048 sc1
ds_read_b128 v[176:179], v244 offset:47104
v_mfma_f32_16x16x32_bf16 v[148:151], v[200:203], v[32:35], 0
ds_read_b128 v[180:183], v244 offset:48128
ds_read_b128 v[184:187], v244 offset:49152
v_mfma_f32_16x16x32_bf16 v[152:155], v[204:207], v[32:35], 0
ds_read_b128 v[188:191], v244 offset:50176
ds_read_b128 v[192:195], v244 offset:51200
v_mfma_f32_16x16x32_bf16 v[156:159], v[208:211], v[32:35], 0
v_mfma_f32_16x16x32_bf16 v[160:163], v[212:215], v[32:35], 0
s_waitcnt vmcnt(9)
s_waitcnt lgkmcnt(5)
v_mfma_f32_16x16x32_bf16 v[144:147], v[0:3], v[36:39], v[144:147]
s_add_u32 s20, s44, 8192
buffer_load_dwordx4 v[76:79], v244, s[8:11], s20 offen offset:3072 sc1
ds_read_b128 v[196:199], v244 offset:52224
v_mfma_f32_16x16x32_bf16 v[148:151], v[4:7], v[36:39], v[148:151]
ds_read_b128 v[200:203], v244 offset:53248
ds_read_b128 v[204:207], v244 offset:54272
v_mfma_f32_16x16x32_bf16 v[152:155], v[8:11], v[36:39], v[152:155]
ds_read_b128 v[208:211], v244 offset:55296
ds_read_b128 v[212:215], v244 offset:56320
v_mfma_f32_16x16x32_bf16 v[156:159], v[12:15], v[36:39], v[156:159]
v_mfma_f32_16x16x32_bf16 v[160:163], v[16:19], v[36:39], v[160:163]
s_barrier
s_waitcnt vmcnt(9)
s_waitcnt lgkmcnt(5)
v_mfma_f32_16x16x32_bf16 v[144:147], v[176:179], v[40:43], v[144:147]
s_add_u32 s20, s44, 12288
buffer_load_dwordx4 v[80:83], v244, s[8:11], s20 offen offset:0 sc1
ds_read_b128 v[0:3], v244 offset:57344
v_mfma_f32_16x16x32_bf16 v[148:151], v[180:183], v[40:43], v[148:151]
ds_read_b128 v[4:7], v244 offset:58368
ds_read_b128 v[8:11], v244 offset:59392
v_mfma_f32_16x16x32_bf16 v[152:155], v[184:187], v[40:43], v[152:155]
ds_read_b128 v[12:15], v244 offset:60416
ds_read_b128 v[16:19], v244 offset:61440
v_mfma_f32_16x16x32_bf16 v[156:159], v[188:191], v[40:43], v[156:159]
v_mfma_f32_16x16x32_bf16 v[160:163], v[192:195], v[40:43], v[160:163]
s_waitcnt vmcnt(9)
s_waitcnt lgkmcnt(5)
v_mfma_f32_16x16x32_bf16 v[144:147], v[196:199], v[44:47], v[144:147]
s_add_u32 s20, s44, 12288
buffer_load_dwordx4 v[84:87], v244, s[8:11], s20 offen offset:1024 sc1
ds_read_b128 v[176:179], v244 offset:62464
v_mfma_f32_16x16x32_bf16 v[148:151], v[200:203], v[44:47], v[148:151]
ds_read_b128 v[180:183], v244 offset:63488
ds_read_b128 v[184:187], v244 offset:64512
v_mfma_f32_16x16x32_bf16 v[152:155], v[204:207], v[44:47], v[152:155]
ds_read_b128 v[188:191], v136 offset:0
ds_read_b128 v[192:195], v136 offset:1024
v_mfma_f32_16x16x32_bf16 v[156:159], v[208:211], v[44:47], v[156:159]
v_mfma_f32_16x16x32_bf16 v[160:163], v[212:215], v[44:47], v[160:163]
s_waitcnt vmcnt(9)
s_waitcnt lgkmcnt(5)
v_mfma_f32_16x16x32_bf16 v[144:147], v[0:3], v[48:51], v[144:147]
s_add_u32 s20, s44, 12288
buffer_load_dwordx4 v[88:91], v244, s[8:11], s20 offen offset:2048 sc1
ds_read_b128 v[196:199], v136 offset:2048
v_mfma_f32_16x16x32_bf16 v[148:151], v[4:7], v[48:51], v[148:151]
ds_read_b128 v[200:203], v136 offset:3072
ds_read_b128 v[204:207], v136 offset:4096
v_mfma_f32_16x16x32_bf16 v[152:155], v[8:11], v[48:51], v[152:155]
ds_read_b128 v[208:211], v136 offset:5120
ds_read_b128 v[212:215], v136 offset:6144
v_mfma_f32_16x16x32_bf16 v[156:159], v[12:15], v[48:51], v[156:159]
v_mfma_f32_16x16x32_bf16 v[160:163], v[16:19], v[48:51], v[160:163]
s_waitcnt vmcnt(9)
s_waitcnt lgkmcnt(5)
v_mfma_f32_16x16x32_bf16 v[144:147], v[176:179], v[52:55], v[144:147]
s_add_u32 s20, s44, 12288
buffer_load_dwordx4 v[92:95], v244, s[8:11], s20 offen offset:3072 sc1
ds_read_b128 v[0:3], v136 offset:7168
v_mfma_f32_16x16x32_bf16 v[148:151], v[180:183], v[52:55], v[148:151]
ds_read_b128 v[4:7], v136 offset:8192
ds_read_b128 v[8:11], v136 offset:9216
v_mfma_f32_16x16x32_bf16 v[152:155], v[184:187], v[52:55], v[152:155]
ds_read_b128 v[12:15], v136 offset:10240
ds_read_b128 v[16:19], v136 offset:11264
v_mfma_f32_16x16x32_bf16 v[156:159], v[188:191], v[52:55], v[156:159]
v_mfma_f32_16x16x32_bf16 v[160:163], v[192:195], v[52:55], v[160:163]
s_barrier
s_waitcnt vmcnt(9)
s_waitcnt lgkmcnt(5)
v_mfma_f32_16x16x32_bf16 v[144:147], v[196:199], v[56:59], v[144:147]
s_add_u32 s20, s44, 16384
buffer_load_dwordx4 v[96:99], v244, s[8:11], s20 offen offset:0 sc1
ds_read_b128 v[176:179], v136 offset:57344
v_mfma_f32_16x16x32_bf16 v[148:151], v[200:203], v[56:59], v[148:151]
ds_read_b128 v[180:183], v136 offset:58368
ds_read_b128 v[184:187], v136 offset:59392
v_mfma_f32_16x16x32_bf16 v[152:155], v[204:207], v[56:59], v[152:155]
ds_read_b128 v[188:191], v136 offset:60416
ds_read_b128 v[192:195], v136 offset:61440
v_mfma_f32_16x16x32_bf16 v[156:159], v[208:211], v[56:59], v[156:159]
v_mfma_f32_16x16x32_bf16 v[160:163], v[212:215], v[56:59], v[160:163]
s_waitcnt vmcnt(9)
s_waitcnt lgkmcnt(5)
v_mfma_f32_16x16x32_bf16 v[144:147], v[0:3], v[60:63], v[144:147]
s_add_u32 s20, s44, 16384
buffer_load_dwordx4 v[100:103], v244, s[8:11], s20 offen offset:1024 sc1
ds_read_b128 v[196:199], v136 offset:62464
v_mfma_f32_16x16x32_bf16 v[148:151], v[4:7], v[60:63], v[148:151]
ds_read_b128 v[200:203], v136 offset:63488
ds_read_b128 v[204:207], v136 offset:64512
v_mfma_f32_16x16x32_bf16 v[152:155], v[8:11], v[60:63], v[152:155]
ds_read_b128 v[208:211], v137 offset:0
ds_read_b128 v[212:215], v137 offset:1024
v_mfma_f32_16x16x32_bf16 v[156:159], v[12:15], v[60:63], v[156:159]
v_mfma_f32_16x16x32_bf16 v[160:163], v[16:19], v[60:63], v[160:163]
s_waitcnt vmcnt(9)
s_waitcnt lgkmcnt(5)
v_mfma_f32_16x16x32_bf16 v[144:147], v[176:179], v[64:67], v[144:147]
s_add_u32 s20, s44, 16384
buffer_load_dwordx4 v[104:107], v244, s[8:11], s20 offen offset:2048 sc1
ds_read_b128 v[0:3], v137 offset:2048
v_mfma_f32_16x16x32_bf16 v[148:151], v[180:183], v[64:67], v[148:151]
ds_read_b128 v[4:7], v137 offset:3072
ds_read_b128 v[8:11], v137 offset:4096
v_mfma_f32_16x16x32_bf16 v[152:155], v[184:187], v[64:67], v[152:155]
ds_read_b128 v[12:15], v137 offset:5120
ds_read_b128 v[16:19], v137 offset:6144
v_mfma_f32_16x16x32_bf16 v[156:159], v[188:191], v[64:67], v[156:159]
v_mfma_f32_16x16x32_bf16 v[160:163], v[192:195], v[64:67], v[160:163]
s_waitcnt vmcnt(9)
s_waitcnt lgkmcnt(5)
v_mfma_f32_16x16x32_bf16 v[144:147], v[196:199], v[68:71], v[144:147]
s_add_u32 s20, s44, 16384
buffer_load_dwordx4 v[108:111], v244, s[8:11], s20 offen offset:3072 sc1
ds_read_b128 v[176:179], v137 offset:7168
v_mfma_f32_16x16x32_bf16 v[148:151], v[200:203], v[68:71], v[148:151]
ds_read_b128 v[180:183], v137 offset:8192
ds_read_b128 v[184:187], v137 offset:9216
v_mfma_f32_16x16x32_bf16 v[152:155], v[204:207], v[68:71], v[152:155]
ds_read_b128 v[188:191], v137 offset:10240
ds_read_b128 v[192:195], v137 offset:11264
v_mfma_f32_16x16x32_bf16 v[156:159], v[208:211], v[68:71], v[156:159]
v_mfma_f32_16x16x32_bf16 v[160:163], v[212:215], v[68:71], v[160:163]
s_barrier
s_waitcnt vmcnt(9)
s_waitcnt lgkmcnt(5)
v_mfma_f32_16x16x32_bf16 v[144:147], v[0:3], v[72:75], v[144:147]
s_add_u32 s20, s44, 20480
buffer_load_dwordx4 v[216:219], v244, s[8:11], s20 offen offset:0 sc1
ds_read_b128 v[196:199], v137 offset:12288
v_mfma_f32_16x16x32_bf16 v[148:151], v[4:7], v[72:75], v[148:151]
ds_read_b128 v[200:203], v137 offset:13312
ds_read_b128 v[204:207], v137 offset:14336
v_mfma_f32_16x16x32_bf16 v[152:155], v[8:11], v[72:75], v[152:155]
ds_read_b128 v[208:211], v137 offset:15360
ds_read_b128 v[212:215], v137 offset:16384
v_mfma_f32_16x16x32_bf16 v[156:159], v[12:15], v[72:75], v[156:159]
v_mfma_f32_16x16x32_bf16 v[160:163], v[16:19], v[72:75], v[160:163]
s_waitcnt vmcnt(9)
s_waitcnt lgkmcnt(5)
v_mfma_f32_16x16x32_bf16 v[144:147], v[176:179], v[76:79], v[144:147]
s_add_u32 s20, s44, 20480
buffer_load_dwordx4 v[220:223], v244, s[8:11], s20 offen offset:1024 sc1
ds_read_b128 v[0:3], v137 offset:17408
v_mfma_f32_16x16x32_bf16 v[148:151], v[180:183], v[76:79], v[148:151]
ds_read_b128 v[4:7], v137 offset:18432
ds_read_b128 v[8:11], v137 offset:19456
v_mfma_f32_16x16x32_bf16 v[152:155], v[184:187], v[76:79], v[152:155]
ds_read_b128 v[12:15], v137 offset:20480
ds_read_b128 v[16:19], v137 offset:21504
v_mfma_f32_16x16x32_bf16 v[156:159], v[188:191], v[76:79], v[156:159]
v_mfma_f32_16x16x32_bf16 v[160:163], v[192:195], v[76:79], v[160:163]
s_waitcnt vmcnt(9)
s_waitcnt lgkmcnt(5)
v_mfma_f32_16x16x32_bf16 v[144:147], v[196:199], v[80:83], v[144:147]
s_add_u32 s20, s44, 20480
buffer_load_dwordx4 v[224:227], v244, s[8:11], s20 offen offset:2048 sc1
ds_read_b128 v[176:179], v137 offset:22528
v_mfma_f32_16x16x32_bf16 v[148:151], v[200:203], v[80:83], v[148:151]
ds_read_b128 v[180:183], v137 offset:23552
ds_read_b128 v[184:187], v137 offset:24576
v_mfma_f32_16x16x32_bf16 v[152:155], v[204:207], v[80:83], v[152:155]
ds_read_b128 v[188:191], v137 offset:25600
ds_read_b128 v[192:195], v137 offset:26624
v_mfma_f32_16x16x32_bf16 v[156:159], v[208:211], v[80:83], v[156:159]
v_mfma_f32_16x16x32_bf16 v[160:163], v[212:215], v[80:83], v[160:163]
s_waitcnt vmcnt(9)
s_waitcnt lgkmcnt(5)
v_mfma_f32_16x16x32_bf16 v[144:147], v[0:3], v[84:87], v[144:147]
s_add_u32 s20, s44, 20480
buffer_load_dwordx4 v[228:231], v244, s[8:11], s20 offen offset:3072 sc1
ds_read_b128 v[196:199], v137 offset:27648
v_mfma_f32_16x16x32_bf16 v[148:151], v[4:7], v[84:87], v[148:151]
ds_read_b128 v[200:203], v137 offset:28672
ds_read_b128 v[204:207], v137 offset:29696
v_mfma_f32_16x16x32_bf16 v[152:155], v[8:11], v[84:87], v[152:155]
ds_read_b128 v[208:211], v137 offset:30720
ds_read_b128 v[212:215], v137 offset:31744
v_mfma_f32_16x16x32_bf16 v[156:159], v[12:15], v[84:87], v[156:159]
v_mfma_f32_16x16x32_bf16 v[160:163], v[16:19], v[84:87], v[160:163]
s_barrier
s_waitcnt vmcnt(9)
s_waitcnt lgkmcnt(5)
v_mfma_f32_16x16x32_bf16 v[144:147], v[176:179], v[88:91], v[144:147]
s_add_u32 s20, s44, 24576
buffer_load_dwordx4 v[232:235], v244, s[8:11], s20 offen offset:0 sc1
ds_read_b128 v[0:3], v136 offset:16384
v_mfma_f32_16x16x32_bf16 v[148:151], v[180:183], v[88:91], v[148:151]
ds_read_b128 v[4:7], v136 offset:17408
ds_read_b128 v[8:11], v136 offset:18432
v_mfma_f32_16x16x32_bf16 v[152:155], v[184:187], v[88:91], v[152:155]
ds_read_b128 v[12:15], v136 offset:19456
ds_read_b128 v[16:19], v136 offset:20480
v_mfma_f32_16x16x32_bf16 v[156:159], v[188:191], v[88:91], v[156:159]
v_mfma_f32_16x16x32_bf16 v[160:163], v[192:195], v[88:91], v[160:163]
s_waitcnt vmcnt(9)
s_waitcnt lgkmcnt(5)
v_mfma_f32_16x16x32_bf16 v[144:147], v[196:199], v[92:95], v[144:147]
s_add_u32 s20, s44, 24576
buffer_load_dwordx4 v[236:239], v244, s[8:11], s20 offen offset:1024 sc1
ds_read_b128 v[176:179], v136 offset:21504
v_mfma_f32_16x16x32_bf16 v[148:151], v[200:203], v[92:95], v[148:151]
ds_read_b128 v[180:183], v136 offset:22528
ds_read_b128 v[184:187], v136 offset:23552
v_mfma_f32_16x16x32_bf16 v[152:155], v[204:207], v[92:95], v[152:155]
ds_read_b128 v[188:191], v136 offset:24576
ds_read_b128 v[192:195], v136 offset:25600
v_mfma_f32_16x16x32_bf16 v[156:159], v[208:211], v[92:95], v[156:159]
v_mfma_f32_16x16x32_bf16 v[160:163], v[212:215], v[92:95], v[160:163]
s_waitcnt vmcnt(9)
s_waitcnt lgkmcnt(5)
v_mfma_f32_16x16x32_bf16 v[144:147], v[0:3], v[96:99], v[144:147]
s_add_u32 s20, s44, 24576
buffer_load_dwordx4 v[240:243], v244, s[8:11], s20 offen offset:2048 sc1
ds_read_b128 v[196:199], v136 offset:26624
v_mfma_f32_16x16x32_bf16 v[148:151], v[4:7], v[96:99], v[148:151]
ds_read_b128 v[200:203], v136 offset:27648
ds_read_b128 v[204:207], v136 offset:28672
v_mfma_f32_16x16x32_bf16 v[152:155], v[8:11], v[96:99], v[152:155]
ds_read_b128 v[208:211], v136 offset:29696
ds_read_b128 v[212:215], v136 offset:30720
v_mfma_f32_16x16x32_bf16 v[156:159], v[12:15], v[96:99], v[156:159]
v_mfma_f32_16x16x32_bf16 v[160:163], v[16:19], v[96:99], v[160:163]
s_waitcnt vmcnt(9)
s_waitcnt lgkmcnt(5)
v_mfma_f32_16x16x32_bf16 v[144:147], v[176:179], v[100:103], v[144:147]
ds_read_b128 v[0:3], v136 offset:31744
ds_read_b128 v[4:7], v136 offset:32768
v_mfma_f32_16x16x32_bf16 v[148:151], v[180:183], v[100:103], v[148:151]
ds_read_b128 v[8:11], v136 offset:33792
ds_read_b128 v[12:15], v136 offset:34816
v_mfma_f32_16x16x32_bf16 v[152:155], v[184:187], v[100:103], v[152:155]
ds_read_b128 v[16:19], v136 offset:35840
v_mfma_f32_16x16x32_bf16 v[156:159], v[188:191], v[100:103], v[156:159]
v_mfma_f32_16x16x32_bf16 v[160:163], v[192:195], v[100:103], v[160:163]
s_barrier
s_waitcnt vmcnt(8)
s_waitcnt lgkmcnt(5)
v_mfma_f32_16x16x32_bf16 v[144:147], v[196:199], v[104:107], v[144:147]
ds_read_b128 v[176:179], v136 offset:36864
ds_read_b128 v[180:183], v136 offset:37888
v_mfma_f32_16x16x32_bf16 v[148:151], v[200:203], v[104:107], v[148:151]
ds_read_b128 v[184:187], v136 offset:38912
ds_read_b128 v[188:191], v136 offset:39936
v_mfma_f32_16x16x32_bf16 v[152:155], v[204:207], v[104:107], v[152:155]
ds_read_b128 v[192:195], v136 offset:40960
v_mfma_f32_16x16x32_bf16 v[156:159], v[208:211], v[104:107], v[156:159]
v_mfma_f32_16x16x32_bf16 v[160:163], v[212:215], v[104:107], v[160:163]
s_waitcnt vmcnt(7)
s_waitcnt lgkmcnt(5)
v_mfma_f32_16x16x32_bf16 v[144:147], v[0:3], v[108:111], v[144:147]
ds_read_b128 v[196:199], v136 offset:41984
ds_read_b128 v[200:203], v136 offset:43008
v_mfma_f32_16x16x32_bf16 v[148:151], v[4:7], v[108:111], v[148:151]
ds_read_b128 v[204:207], v136 offset:44032
ds_read_b128 v[208:211], v136 offset:45056
v_mfma_f32_16x16x32_bf16 v[152:155], v[8:11], v[108:111], v[152:155]
ds_read_b128 v[212:215], v136 offset:46080
v_mfma_f32_16x16x32_bf16 v[156:159], v[12:15], v[108:111], v[156:159]
v_mfma_f32_16x16x32_bf16 v[160:163], v[16:19], v[108:111], v[160:163]
s_waitcnt vmcnt(6)
s_waitcnt lgkmcnt(5)
v_mfma_f32_16x16x32_bf16 v[144:147], v[176:179], v[216:219], v[144:147]
ds_read_b128 v[0:3], v136 offset:47104
ds_read_b128 v[4:7], v136 offset:48128
v_mfma_f32_16x16x32_bf16 v[148:151], v[180:183], v[216:219], v[148:151]
ds_read_b128 v[8:11], v136 offset:49152
ds_read_b128 v[12:15], v136 offset:50176
v_mfma_f32_16x16x32_bf16 v[152:155], v[184:187], v[216:219], v[152:155]
ds_read_b128 v[16:19], v136 offset:51200
v_mfma_f32_16x16x32_bf16 v[156:159], v[188:191], v[216:219], v[156:159]
v_mfma_f32_16x16x32_bf16 v[160:163], v[192:195], v[216:219], v[160:163]
s_waitcnt vmcnt(5)
s_waitcnt lgkmcnt(5)
v_mfma_f32_16x16x32_bf16 v[144:147], v[196:199], v[220:223], v[144:147]
ds_read_b128 v[176:179], v136 offset:52224
ds_read_b128 v[180:183], v136 offset:53248
v_mfma_f32_16x16x32_bf16 v[148:151], v[200:203], v[220:223], v[148:151]
ds_read_b128 v[184:187], v136 offset:54272
ds_read_b128 v[188:191], v136 offset:55296
v_mfma_f32_16x16x32_bf16 v[152:155], v[204:207], v[220:223], v[152:155]
ds_read_b128 v[192:195], v136 offset:56320
v_mfma_f32_16x16x32_bf16 v[156:159], v[208:211], v[220:223], v[156:159]
v_mfma_f32_16x16x32_bf16 v[160:163], v[212:215], v[220:223], v[160:163]
s_barrier
s_waitcnt vmcnt(4)
s_waitcnt lgkmcnt(5)
v_mfma_f32_16x16x32_bf16 v[144:147], v[0:3], v[224:227], v[144:147]
ds_read_b128 v[196:199], v244 offset:0
ds_read_b128 v[200:203], v244 offset:1024
v_mfma_f32_16x16x32_bf16 v[148:151], v[4:7], v[224:227], v[148:151]
ds_read_b128 v[204:207], v244 offset:2048
ds_read_b128 v[208:211], v244 offset:3072
v_mfma_f32_16x16x32_bf16 v[152:155], v[8:11], v[224:227], v[152:155]
ds_read_b128 v[212:215], v244 offset:4096
v_mfma_f32_16x16x32_bf16 v[156:159], v[12:15], v[224:227], v[156:159]
v_mfma_f32_16x16x32_bf16 v[160:163], v[16:19], v[224:227], v[160:163]
s_waitcnt vmcnt(3)
s_waitcnt lgkmcnt(5)
v_mfma_f32_16x16x32_bf16 v[144:147], v[176:179], v[228:231], v[144:147]
ds_read_b128 v[0:3], v244 offset:5120
ds_read_b128 v[4:7], v244 offset:6144
v_mfma_f32_16x16x32_bf16 v[148:151], v[180:183], v[228:231], v[148:151]
ds_read_b128 v[8:11], v244 offset:7168
ds_read_b128 v[12:15], v244 offset:8192
v_mfma_f32_16x16x32_bf16 v[152:155], v[184:187], v[228:231], v[152:155]
ds_read_b128 v[16:19], v244 offset:9216
v_mfma_f32_16x16x32_bf16 v[156:159], v[188:191], v[228:231], v[156:159]
v_mfma_f32_16x16x32_bf16 v[160:163], v[192:195], v[228:231], v[160:163]
s_waitcnt vmcnt(2)
s_waitcnt lgkmcnt(5)
v_mfma_f32_16x16x32_bf16 v[144:147], v[196:199], v[232:235], v[144:147]
ds_read_b128 v[176:179], v244 offset:10240
ds_read_b128 v[180:183], v244 offset:11264
v_mfma_f32_16x16x32_bf16 v[148:151], v[200:203], v[232:235], v[148:151]
ds_read_b128 v[184:187], v244 offset:12288
ds_read_b128 v[188:191], v244 offset:13312
v_mfma_f32_16x16x32_bf16 v[152:155], v[204:207], v[232:235], v[152:155]
ds_read_b128 v[192:195], v244 offset:14336
v_mfma_f32_16x16x32_bf16 v[156:159], v[208:211], v[232:235], v[156:159]
v_mfma_f32_16x16x32_bf16 v[160:163], v[212:215], v[232:235], v[160:163]
s_waitcnt vmcnt(1)
s_waitcnt lgkmcnt(5)
v_mfma_f32_16x16x32_bf16 v[144:147], v[0:3], v[236:239], v[144:147]
v_mfma_f32_16x16x32_bf16 v[148:151], v[4:7], v[236:239], v[148:151]
v_mfma_f32_16x16x32_bf16 v[152:155], v[8:11], v[236:239], v[152:155]
v_mfma_f32_16x16x32_bf16 v[156:159], v[12:15], v[236:239], v[156:159]
v_mfma_f32_16x16x32_bf16 v[160:163], v[16:19], v[236:239], v[160:163]
s_waitcnt vmcnt(0)
s_waitcnt lgkmcnt(0)
v_mfma_f32_16x16x32_bf16 v[144:147], v[176:179], v[240:243], v[144:147]
v_mfma_f32_16x16x32_bf16 v[148:151], v[180:183], v[240:243], v[148:151]
v_mfma_f32_16x16x32_bf16 v[152:155], v[184:187], v[240:243], v[152:155]
v_mfma_f32_16x16x32_bf16 v[156:159], v[188:191], v[240:243], v[156:159]
v_mfma_f32_16x16x32_bf16 v[160:163], v[192:195], v[240:243], v[160:163]
s_mov_b32 s16, s80
s_mov_b32 s17, s81
s_mov_b32 s18, 0x280000
s_mov_b32 s19, 0x20000
v_mov_b32 v168, 0xbfb8aa3b
v_mov_b32 v169, 0xbfb8aa3b
v_mov_b32 v170, 1.0
v_mov_b32 v171, 1.0
s_nop 4
v_permlane16_swap_b32 v112, v116
v_permlane16_swap_b32 v113, v117
v_permlane16_swap_b32 v114, v118
v_permlane16_swap_b32 v115, v119
v_permlane16_swap_b32 v144, v148
v_permlane16_swap_b32 v145, v149
v_permlane16_swap_b32 v146, v150
v_permlane16_swap_b32 v147, v151
s_nop 1
v_pk_mul_f32 v[184:185], v[144:145], v[168:169]
v_pk_mul_f32 v[186:187], v[146:147], v[168:169]
v_pk_mul_f32 v[188:189], v[148:149], v[168:169]
v_pk_mul_f32 v[190:191], v[150:151], v[168:169]
v_exp_f32 v184, v184
v_exp_f32 v185, v185
v_exp_f32 v186, v186
v_exp_f32 v187, v187
v_exp_f32 v188, v188
v_exp_f32 v189, v189
v_exp_f32 v190, v190
v_exp_f32 v191, v191
v_lshlrev_b32 v176, 16, v20
v_and_b32 v177, 0xffff0000, v20
v_lshlrev_b32 v178, 16, v21
v_and_b32 v179, 0xffff0000, v21
v_lshlrev_b32 v180, 16, v22
v_and_b32 v181, 0xffff0000, v22
v_lshlrev_b32 v182, 16, v23
v_and_b32 v183, 0xffff0000, v23
v_pk_add_f32 v[184:185], v[184:185], v[170:171]
v_pk_add_f32 v[186:187], v[186:187], v[170:171]
v_pk_add_f32 v[188:189], v[188:189], v[170:171]
v_pk_add_f32 v[190:191], v[190:191], v[170:171]
v_rcp_f32 v184, v184
v_rcp_f32 v185, v185
v_rcp_f32 v186, v186
v_rcp_f32 v187, v187
v_rcp_f32 v188, v188
v_rcp_f32 v189, v189
v_rcp_f32 v190, v190
v_rcp_f32 v191, v191
v_pk_mul_f32 v[144:145], v[144:145], v[112:113]
v_pk_mul_f32 v[146:147], v[146:147], v[114:115]
v_pk_mul_f32 v[148:149], v[148:149], v[116:117]
v_pk_mul_f32 v[150:151], v[150:151], v[118:119]
s_nop 0
v_pk_fma_f32 v[176:177], v[144:145], v[184:185], v[176:177]
v_pk_fma_f32 v[178:179], v[146:147], v[186:187], v[178:179]
v_pk_fma_f32 v[180:181], v[148:149], v[188:189], v[180:181]
v_pk_fma_f32 v[182:183], v[150:151], v[190:191], v[182:183]
v_cvt_pk_bf16_f32 v20, v176, v177
v_cvt_pk_bf16_f32 v21, v178, v179
v_cvt_pk_bf16_f32 v22, v180, v181
v_cvt_pk_bf16_f32 v23, v182, v183
buffer_store_dwordx4 v[20:23], v164, s[16:19], 0 offen offset:0
v_permlane16_swap_b32 v120, v124
v_permlane16_swap_b32 v121, v125
v_permlane16_swap_b32 v122, v126
v_permlane16_swap_b32 v123, v127
v_permlane16_swap_b32 v152, v156
v_permlane16_swap_b32 v153, v157
v_permlane16_swap_b32 v154, v158
v_permlane16_swap_b32 v155, v159
s_nop 1
v_pk_mul_f32 v[184:185], v[152:153], v[168:169]
v_pk_mul_f32 v[186:187], v[154:155], v[168:169]
v_pk_mul_f32 v[188:189], v[156:157], v[168:169]
v_pk_mul_f32 v[190:191], v[158:159], v[168:169]
v_exp_f32 v184, v184
v_exp_f32 v185, v185
v_exp_f32 v186, v186
v_exp_f32 v187, v187
v_exp_f32 v188, v188
v_exp_f32 v189, v189
v_exp_f32 v190, v190
v_exp_f32 v191, v191
v_lshlrev_b32 v176, 16, v24
v_and_b32 v177, 0xffff0000, v24
v_lshlrev_b32 v178, 16, v25
v_and_b32 v179, 0xffff0000, v25
v_lshlrev_b32 v180, 16, v26
v_and_b32 v181, 0xffff0000, v26
v_lshlrev_b32 v182, 16, v27
v_and_b32 v183, 0xffff0000, v27
v_pk_add_f32 v[184:185], v[184:185], v[170:171]
v_pk_add_f32 v[186:187], v[186:187], v[170:171]
v_pk_add_f32 v[188:189], v[188:189], v[170:171]
v_pk_add_f32 v[190:191], v[190:191], v[170:171]
v_rcp_f32 v184, v184
v_rcp_f32 v185, v185
v_rcp_f32 v186, v186
v_rcp_f32 v187, v187
v_rcp_f32 v188, v188
v_rcp_f32 v189, v189
v_rcp_f32 v190, v190
v_rcp_f32 v191, v191
v_pk_mul_f32 v[152:153], v[152:153], v[120:121]
v_pk_mul_f32 v[154:155], v[154:155], v[122:123]
v_pk_mul_f32 v[156:157], v[156:157], v[124:125]
v_pk_mul_f32 v[158:159], v[158:159], v[126:127]
s_nop 0
v_pk_fma_f32 v[176:177], v[152:153], v[184:185], v[176:177]
v_pk_fma_f32 v[178:179], v[154:155], v[186:187], v[178:179]
v_pk_fma_f32 v[180:181], v[156:157], v[188:189], v[180:181]
v_pk_fma_f32 v[182:183], v[158:159], v[190:191], v[182:183]
v_cvt_pk_bf16_f32 v24, v176, v177
v_cvt_pk_bf16_f32 v25, v178, v179
v_cvt_pk_bf16_f32 v26, v180, v181
v_cvt_pk_bf16_f32 v27, v182, v183
buffer_store_dwordx4 v[24:27], v164, s[16:19], 0 offen offset:64
v_pk_mul_f32 v[184:185], v[160:161], v[168:169]
v_pk_mul_f32 v[186:187], v[162:163], v[168:169]
v_exp_f32 v184, v184
v_exp_f32 v185, v185
v_exp_f32 v186, v186
v_exp_f32 v187, v187
v_lshlrev_b32 v176, 16, v28
v_and_b32 v177, 0xffff0000, v28
v_lshlrev_b32 v178, 16, v29
v_and_b32 v179, 0xffff0000, v29
v_pk_add_f32 v[184:185], v[184:185], v[170:171]
v_pk_add_f32 v[186:187], v[186:187], v[170:171]
v_rcp_f32 v184, v184
v_rcp_f32 v185, v185
v_rcp_f32 v186, v186
v_rcp_f32 v187, v187
v_pk_mul_f32 v[160:161], v[160:161], v[128:129]
v_pk_mul_f32 v[162:163], v[162:163], v[130:131]
s_nop 0
v_pk_fma_f32 v[176:177], v[160:161], v[184:185], v[176:177]
v_pk_fma_f32 v[178:179], v[162:163], v[186:187], v[178:179]
v_cvt_pk_bf16_f32 v28, v176, v177
v_cvt_pk_bf16_f32 v29, v178, v179
buffer_store_dwordx2 v[28:29], v165, s[16:19], 0 offen offset:128
s_endpgm
.p2align 6
L_side:
s_waitcnt lgkmcnt(0)
s_mov_b32 s8, s84
s_mov_b32 s9, s85
s_mov_b32 s10, 0x10000000
s_mov_b32 s11, 0x20000
s_add_u32 s20, s84, 31457280
s_addc_u32 s21, s85, 0
s_load_dword s34, s[20:21], 0
s_mov_b32 s4, s64
s_mov_b32 s5, s65
s_mov_b32 s6, 0x280000
s_mov_b32 s7, 0x20000
s_lshl_b32 s20, s32, 7
s_lshl_b32 s21, s33, 3
s_add_u32 s20, s20, s21
s_lshl_b32 s21, s35, 2
s_add_u32 s20, s20, s21
v_lshrrev_b32 v80, 4, v250
v_add_u32 v200, s20, v80
v_mul_u32_u24 v81, 1280, v200
v_and_b32 v82, 15, v250
v_lshl_add_u32 v81, v82, 4, v81
buffer_load_dwordx4 v[10:13], v81, s[4:7], 0 offen offset:0
buffer_load_dwordx4 v[14:17], v81, s[4:7], 0 offen offset:256
buffer_load_dwordx4 v[18:21], v81, s[4:7], 0 offen offset:512
buffer_load_dwordx4 v[22:25], v81, s[4:7], 0 offen offset:768
buffer_load_dwordx4 v[26:29], v81, s[4:7], 0 offen offset:1024
s_waitcnt lgkmcnt(0)
s_mul_i32 s34, s34, 1664525
s_add_u32 s34, s34, 1013904223
s_barrier
v_mov_b32 v88, 0x3f803f80
v_mov_b32 v72, 0
v_mov_b32 v73, 0
v_mov_b32 v74, 0
v_mov_b32 v75, 0
s_waitcnt vmcnt(0)
v_dot2c_f32_bf16 v72, v10, v88
v_dot2c_f32_bf16 v74, v10, v10
v_dot2c_f32_bf16 v73, v11, v88
v_dot2c_f32_bf16 v75, v11, v11
v_dot2c_f32_bf16 v72, v12, v88
v_dot2c_f32_bf16 v74, v12, v12
v_dot2c_f32_bf16 v73, v13, v88
v_dot2c_f32_bf16 v75, v13, v13
v_dot2c_f32_bf16 v72, v14, v88
v_dot2c_f32_bf16 v74, v14, v14
v_dot2c_f32_bf16 v73, v15, v88
v_dot2c_f32_bf16 v75, v15, v15
v_dot2c_f32_bf16 v72, v16, v88
v_dot2c_f32_bf16 v74, v16, v16
v_dot2c_f32_bf16 v73, v17, v88
v_dot2c_f32_bf16 v75, v17, v17
v_dot2c_f32_bf16 v72, v18, v88
v_dot2c_f32_bf16 v74, v18, v18
v_dot2c_f32_bf16 v73, v19, v88
v_dot2c_f32_bf16 v75, v19, v19
v_dot2c_f32_bf16 v72, v20, v88
v_dot2c_f32_bf16 v74, v20, v20
v_dot2c_f32_bf16 v73, v21, v88
v_dot2c_f32_bf16 v75, v21, v21
v_dot2c_f32_bf16 v72, v22, v88
v_dot2c_f32_bf16 v74, v22, v22
v_dot2c_f32_bf16 v73, v23, v88
v_dot2c_f32_bf16 v75, v23, v23
v_dot2c_f32_bf16 v72, v24, v88
v_dot2c_f32_bf16 v74, v24, v24
v_dot2c_f32_bf16 v73, v25, v88
v_dot2c_f32_bf16 v75, v25, v25
v_dot2c_f32_bf16 v72, v26, v88
v_dot2c_f32_bf16 v74, v26, v26
v_dot2c_f32_bf16 v73, v27, v88
v_dot2c_f32_bf16 v75, v27, v27
v_dot2c_f32_bf16 v72, v28, v88
v_dot2c_f32_bf16 v74, v28, v28
v_dot2c_f32_bf16 v73, v29, v88
v_dot2c_f32_bf16 v75, v29, v29
s_nop 2
v_add_f32 v72, v72, v73
v_add_f32 v74, v74, v75
s_nop 0
v_add_f32_dpp v72, v72, v72 row_ror:8 row_mask:0xf bank_mask:0xf
v_add_f32_dpp v74, v74, v74 row_ror:8 row_mask:0xf bank_mask:0xf
s_nop 0
v_add_f32_dpp v72, v72, v72 row_ror:4 row_mask:0xf bank_mask:0xf
v_add_f32_dpp v74, v74, v74 row_ror:4 row_mask:0xf bank_mask:0xf
s_nop 0
v_add_f32_dpp v72, v72, v72 row_ror:2 row_mask:0xf bank_mask:0xf
v_add_f32_dpp v74, v74, v74 row_ror:2 row_mask:0xf bank_mask:0xf
s_nop 0
v_add_f32_dpp v72, v72, v72 row_ror:1 row_mask:0xf bank_mask:0xf
v_add_f32_dpp v74, v74, v74 row_ror:1 row_mask:0xf bank_mask:0xf
v_mul_f32 v72, 0x3acccccd, v72
v_mul_f32 v80, v72, v72
v_mov_b32 v81, 0x3acccccd
v_fma_f32 v82, v74, v81, -v80
v_max_f32 v82, 0, v82
v_add_f32 v82, 0x3727c5ac, v82
v_rsq_f32 v84, v82
v_mov_b32 v85, s34
v_mov_b32 v87, s34
v_mul_f32 v86, v72, v84
v_mul_f32 v86, -1.0, v86
v_lshlrev_b32 v80, 4, v200
v_add_u32 v80, 28835840, v80
v_and_b32 v81, 15, v250
v_cmp_eq_u32 vcc, 0, v81
v_mov_b32 v82, 0x40000000
s_nop 0
v_cndmask_b32 v80, v82, v80, vcc
buffer_store_dwordx4 v[84:87], v80, s[8:11], 0 offen sc1
v_lshrrev_b32 v80, 4, v250
v_bfe_u32 v81, v250, 2, 2
v_and_b32 v82, 1, v80
v_lshlrev_b32 v82, 2, v82
v_xor_b32 v82, v82, v81
v_bfe_u32 v83, v250, 1, 1
v_xor_b32 v82, v82, v83
v_lshl_add_u32 v84, v80, 3, v81
s_lshl_b32 s20, s35, 6
v_add_u32 v84, s20, v84
v_lshlrev_b32 v84, 7, v84
v_lshl_add_u32 v84, v82, 4, v84
v_and_b32 v83, 1, v250
v_lshl_add_u32 v84, v83, 3, v84
v_add_u32 v216, 131072, v84
v_xor_b32 v217, 32, v216
v_xor_b32 v218, 64, v216
v_xor_b32 v219, 96, v216
v_lshlrev_b32 v220, 4, v250
s_mul_i32 s38, s2, 52429
s_lshr_b32 s38, s38, 18
s_mul_i32 s20, s38, 5
s_sub_u32 s39, s2, s20
s_cmp_lt_u32 s38, 20
s_cselect_b32 s22, s68, s78
s_cselect_b32 s23, s69, s79
s_mov_b32 s24, 1105920
s_cselect_b32 s24, 819200, s24
s_cselect_b32 s25, 0, 20
s_cmp_lt_u32 s2, 235
s_cselect_b32 s24, s24, 0
s_cselect_b32 s38, s38, 20
s_mov_b32 s16, s22
s_mov_b32 s17, s23
s_mov_b32 s18, s24
s_mov_b32 s19, 0x20000
s_sub_u32 s25, s38, s25
s_mul_i32 s25, s25, 40960
s_lshl_b32 s20, s39, 8
s_lshl_b32 s21, s35, 7
s_add_u32 s20, s20, s21
s_add_u32 s25, s25, s20
v_lshrrev_b32 v80, 3, v250
v_and_b32 v81, 7, v250
v_xor_b32 v81, v81, v80
v_mul_u32_u24 v80, 1280, v80
v_lshl_add_u32 v82, v81, 4, v80
v_xor_b32 v83, 64, v82
s_lshl_b32 s20, s35, 13
s_add_u32 s20, s20, 131072
s_add_u32 m0, s20, 0
s_add_u32 s21, s25, 0
buffer_load_dwordx4 v82, s[16:19], s21 offen lds
s_add_u32 m0, s20, 1024
s_add_u32 s21, s25, 10240
buffer_load_dwordx4 v83, s[16:19], s21 offen lds
s_add_u32 m0, s20, 2048
s_add_u32 s21, s25, 20480
buffer_load_dwordx4 v82, s[16:19], s21 offen lds
s_add_u32 m0, s20, 3072
s_add_u32 s21, s25, 30720
buffer_load_dwordx4 v83, s[16:19], s21 offen lds
s_barrier
s_barrier
s_barrier
s_barrier
s_lshl_b32 s20, s32, 7
s_lshl_b32 s21, s35, 6
s_add_u32 s20, s20, s21
v_add_u32 v201, s20, v250
v_lshlrev_b32 v201, 4, v201
v_add_u32 v201, 28835840, v201
buffer_load_dwordx4 v[132:135], v201, s[8:11], 0 offen sc1
s_waitcnt vmcnt(1)
ds_read_b64_tr_b16 v[40:41], v216 offset:0
ds_read_b64_tr_b16 v[42:43], v218 offset:512
ds_read_b64_tr_b16 v[44:45], v217 offset:0
ds_read_b64_tr_b16 v[46:47], v219 offset:512
ds_read_b64_tr_b16 v[48:49], v218 offset:0
ds_read_b64_tr_b16 v[50:51], v216 offset:512
ds_read_b64_tr_b16 v[52:53], v219 offset:0
ds_read_b64_tr_b16 v[54:55], v217 offset:512
s_cmp_lt_u32 s2, 235
s_cselect_b32 s20, 0x10000000, 0
s_mov_b32 s16, s84
s_mov_b32 s17, s85
s_mov_b32 s18, s20
s_mov_b32 s19, 0x20000
s_mul_i32 s38, s38, 5120
s_add_u32 s38, s38, 25165824
s_lshl_b32 s39, s39, 3
s_lshl_b32 s20, s35, 2
s_add_u32 s39, s39, s20
s_add_u32 s20, s39, 0
s_mul_i32 s21, s20, 13
s_lshr_b32 s21, s21, 6
s_mul_i32 s22, s21, 5
s_sub_u32 s20, s20, s22
s_lshl_b32 s20, s20, 10
s_mul_i32 s21, s21, 245760
s_add_u32 s20, s20, s21
s_add_u32 s20, s20, s38
s_waitcnt lgkmcnt(6)
buffer_store_dwordx4 v[40:43], v220, s[16:19], s20 offen sc1
s_add_u32 s20, s39, 1
s_mul_i32 s21, s20, 13
s_lshr_b32 s21, s21, 6
s_mul_i32 s22, s21, 5
s_sub_u32 s20, s20, s22
s_lshl_b32 s20, s20, 10
s_mul_i32 s21, s21, 245760
s_add_u32 s20, s20, s21
s_add_u32 s20, s20, s38
s_waitcnt lgkmcnt(4)
buffer_store_dwordx4 v[44:47], v220, s[16:19], s20 offen sc1
s_add_u32 s20, s39, 2
s_mul_i32 s21, s20, 13
s_lshr_b32 s21, s21, 6
s_mul_i32 s22, s21, 5
s_sub_u32 s20, s20, s22
s_lshl_b32 s20, s20, 10
s_mul_i32 s21, s21, 245760
s_add_u32 s20, s20, s21
s_add_u32 s20, s20, s38
s_waitcnt lgkmcnt(2)
buffer_store_dwordx4 v[48:51], v220, s[16:19], s20 offen sc1
s_add_u32 s20, s39, 3
s_mul_i32 s21, s20, 13
s_lshr_b32 s21, s21, 6
s_mul_i32 s22, s21, 5
s_sub_u32 s20, s20, s22
s_lshl_b32 s20, s20, 10
s_mul_i32 s21, s21, 245760
s_add_u32 s20, s20, s21
s_add_u32 s20, s20, s38
s_waitcnt lgkmcnt(0)
buffer_store_dwordx4 v[52:55], v220, s[16:19], s20 offen sc1
s_barrier
s_barrier
s_waitcnt vmcnt(4)
s_mov_b32 s30, 0
LtA_83:
v_xor_b32 v80, s34, v133
v_xor_b32 v81, s34, v135
v_or_b32 v80, v80, v81
v_cmp_ne_u32 vcc, 0, v80
s_nop 3
s_cmp_eq_u64 vcc, 0
s_cbranch_scc1 LtAok_84
s_add_u32 s30, s30, 1
s_cmp_gt_u32 s30, 4000
s_cbranch_scc1 LtAok_84
buffer_load_dwordx4 v[132:135], v201, s[8:11], 0 offen sc1
s_waitcnt vmcnt(0)
s_branch LtA_83
LtAok_84:
s_barrier
s_lshl_b32 s20, s35, 9
s_add_u32 s20, s20, 147456
v_lshl_add_u32 v84, v250, 3, s20
v_mov_b32 v133, v134
ds_write_b64 v84, v[132:133]
s_waitcnt lgkmcnt(0)
s_barrier
s_waitcnt vmcnt(0)
s_barrier
s_lshl_b32 s20, s2, 2
s_add_u32 s20, s20, 31461376
s_cmp_eq_u32 s35, 0
s_cselect_b32 s20, s20, 0x40000000
v_mov_b32 v80, 0x40000000
v_mov_b32 v81, s20
v_cmp_eq_u32 vcc, 0, v250
v_mov_b32 v82, s34
s_nop 0
v_cndmask_b32 v80, v80, v81, vcc
buffer_store_dword v82, v80, s[8:11], 0 offen sc1
s_barrier
s_barrier
s_cmp_lt_u32 s33, 14
s_cselect_b32 s20, 0x10000000, 0
s_mov_b32 s60, s84
s_mov_b32 s61, s85
s_mov_b32 s62, s20
s_mov_b32 s63, 0x20000
s_lshl_b32 s20, s35, 6
v_add_u32 v203, s20, v250
v_lshlrev_b32 v80, 3, v203
v_add_u32 v81, 149504, v80
ds_read_b64 v[82:83], v81
ds_read_b64 v[88:89], v81 offset:1024
s_mul_i32 s20, s32, 14
s_add_u32 s20, s20, s33
s_lshl_b32 s20, s20, 11
s_add_u32 s20, s20, 28311552
v_lshlrev_b32 v80, 4, v203
v_add_u32 v80, s20, v80
v_mov_b32 v85, s34
v_mov_b32 v87, s34
s_waitcnt lgkmcnt(0)
v_add_f32 v84, v82, v88
v_add_f32 v86, v83, v89
buffer_store_dwordx4 v[84:87], v80, s[60:63], 0 offen sc1
s_barrier
s_mul_i32 s20, s32, 28672
s_add_u32 s20, s20, 28311552
v_lshlrev_b32 v204, 4, v203
v_add_u32 v204, s20, v204
s_mov_b32 s22, 0
buffer_load_dwordx4 v[136:139], v204, s[60:63], s22 offen offset:0 sc1
buffer_load_dwordx4 v[140:143], v204, s[60:63], s22 offen offset:2048 sc1
s_mov_b32 s22, 4096
buffer_load_dwordx4 v[144:147], v204, s[60:63], s22 offen offset:0 sc1
buffer_load_dwordx4 v[148:151], v204, s[60:63], s22 offen offset:2048 sc1
s_mov_b32 s22, 8192
buffer_load_dwordx4 v[152:155], v204, s[60:63], s22 offen offset:0 sc1
buffer_load_dwordx4 v[156:159], v204, s[60:63], s22 offen offset:2048 sc1
s_mov_b32 s22, 12288
buffer_load_dwordx4 v[160:163], v204, s[60:63], s22 offen offset:0 sc1
buffer_load_dwordx4 v[164:167], v204, s[60:63], s22 offen offset:2048 sc1
s_mov_b32 s22, 16384
buffer_load_dwordx4 v[168:171], v204, s[60:63], s22 offen offset:0 sc1
buffer_load_dwordx4 v[172:175], v204, s[60:63], s22 offen offset:2048 sc1
s_mov_b32 s22, 20480
buffer_load_dwordx4 v[176:179], v204, s[60:63], s22 offen offset:0 sc1
buffer_load_dwordx4 v[180:183], v204, s[60:63], s22 offen offset:2048 sc1
s_mov_b32 s22, 24576
buffer_load_dwordx4 v[184:187], v204, s[60:63], s22 offen offset:0 sc1
buffer_load_dwordx4 v[188:191], v204, s[60:63], s22 offen offset:2048 sc1
s_barrier
s_waitcnt vmcnt(0)
s_cmp_ge_u32 s33, 14
s_cbranch_scc1 Lxs_skip_85
s_mov_b32 s30, 0
Lxs_86:
v_xor_b32 v80, s34, v137
v_xor_b32 v81, s34, v141
v_or_b32 v80, v80, v81
v_xor_b32 v81, s34, v145
v_or_b32 v80, v80, v81
v_xor_b32 v81, s34, v149
v_or_b32 v80, v80, v81
v_xor_b32 v81, s34, v153
v_or_b32 v80, v80, v81
v_xor_b32 v81, s34, v157
v_or_b32 v80, v80, v81
v_xor_b32 v81, s34, v161
v_or_b32 v80, v80, v81
v_xor_b32 v81, s34, v165
v_or_b32 v80, v80, v81
v_xor_b32 v81, s34, v169
v_or_b32 v80, v80, v81
v_xor_b32 v81, s34, v173
v_or_b32 v80, v80, v81
v_xor_b32 v81, s34, v177
v_or_b32 v80, v80, v81
v_xor_b32 v81, s34, v181
v_or_b32 v80, v80, v81
v_xor_b32 v81, s34, v185
v_or_b32 v80, v80, v81
v_xor_b32 v81, s34, v189
v_or_b32 v80, v80, v81
v_xor_b32 v81, s34, v139
v_or_b32 v80, v80, v81
v_xor_b32 v81, s34, v143
v_or_b32 v80, v80, v81
v_xor_b32 v81, s34, v147
v_or_b32 v80, v80, v81
v_xor_b32 v81, s34, v151
v_or_b32 v80, v80, v81
v_xor_b32 v81, s34, v155
v_or_b32 v80, v80, v81
v_xor_b32 v81, s34, v159
v_or_b32 v80, v80, v81
v_xor_b32 v81, s34, v163
v_or_b32 v80, v80, v81
v_xor_b32 v81, s34, v167
v_or_b32 v80, v80, v81
v_xor_b32 v81, s34, v171
v_or_b32 v80, v80, v81
v_xor_b32 v81, s34, v175
v_or_b32 v80, v80, v81
v_xor_b32 v81, s34, v179
v_or_b32 v80, v80, v81
v_xor_b32 v81, s34, v183
v_or_b32 v80, v80, v81
v_xor_b32 v81, s34, v187
v_or_b32 v80, v80, v81
v_xor_b32 v81, s34, v191
v_or_b32 v80, v80, v81
v_cmp_ne_u32 vcc, 0, v80
s_nop 3
s_cmp_eq_u64 vcc, 0
s_cbranch_scc1 Lxsok_87
s_add_u32 s30, s30, 1
s_cmp_gt_u32 s30, 4000
s_cbranch_scc1 Lxsok_87
s_mov_b32 s22, 0
buffer_load_dwordx4 v[136:139], v204, s[60:63], s22 offen offset:0 sc1
buffer_load_dwordx4 v[140:143], v204, s[60:63], s22 offen offset:2048 sc1
s_mov_b32 s22, 4096
buffer_load_dwordx4 v[144:147], v204, s[60:63], s22 offen offset:0 sc1
buffer_load_dwordx4 v[148:151], v204, s[60:63], s22 offen offset:2048 sc1
s_mov_b32 s22, 8192
buffer_load_dwordx4 v[152:155], v204, s[60:63], s22 offen offset:0 sc1
buffer_load_dwordx4 v[156:159], v204, s[60:63], s22 offen offset:2048 sc1
s_mov_b32 s22, 12288
buffer_load_dwordx4 v[160:163], v204, s[60:63], s22 offen offset:0 sc1
buffer_load_dwordx4 v[164:167], v204, s[60:63], s22 offen offset:2048 sc1
s_mov_b32 s22, 16384
buffer_load_dwordx4 v[168:171], v204, s[60:63], s22 offen offset:0 sc1
buffer_load_dwordx4 v[172:175], v204, s[60:63], s22 offen offset:2048 sc1
s_mov_b32 s22, 20480
buffer_load_dwordx4 v[176:179], v204, s[60:63], s22 offen offset:0 sc1
buffer_load_dwordx4 v[180:183], v204, s[60:63], s22 offen offset:2048 sc1
s_mov_b32 s22, 24576
buffer_load_dwordx4 v[184:187], v204, s[60:63], s22 offen offset:0 sc1
buffer_load_dwordx4 v[188:191], v204, s[60:63], s22 offen offset:2048 sc1
s_waitcnt vmcnt(0)
s_branch Lxs_86
Lxsok_87:
Lxs_skip_85:
v_add_f32 v80, v136, v140
v_add_f32 v81, v138, v142
v_add_f32 v80, v80, v144
v_add_f32 v81, v81, v146
v_add_f32 v80, v80, v148
v_add_f32 v81, v81, v150
v_add_f32 v80, v80, v152
v_add_f32 v81, v81, v154
v_add_f32 v80, v80, v156
v_add_f32 v81, v81, v158
v_add_f32 v80, v80, v160
v_add_f32 v81, v81, v162
v_add_f32 v80, v80, v164
v_add_f32 v81, v81, v166
v_add_f32 v80, v80, v168
v_add_f32 v81, v81, v170
v_add_f32 v80, v80, v172
v_add_f32 v81, v81, v174
v_add_f32 v80, v80, v176
v_add_f32 v81, v81, v178
v_add_f32 v80, v80, v180
v_add_f32 v81, v81, v182
v_add_f32 v80, v80, v184
v_add_f32 v81, v81, v186
v_add_f32 v80, v80, v188
v_add_f32 v81, v81, v190
v_mul_f32 v80, 0x3a97b426, v80
v_mul_f32 v82, v80, v80
v_mov_b32 v83, 0x3a97b426
v_fma_f32 v81, v81, v83, -v82
v_max_f32 v81, 0, v81
v_add_f32 v81, 0x3727c5ac, v81
v_rsq_f32 v84, v81
v_lshlrev_b32 v86, 3, v203
v_mul_f32 v85, v80, v84
v_mul_f32 v85, -1.0, v85
v_add_u32 v86, 151552, v86
ds_write_b64 v86, v[84:85]
s_lshl_b32 s20, s35, 9
s_add_u32 s20, s20, 151552
v_lshrrev_b32 v80, 4, v250
v_lshl_add_u32 v205, v80, 6, s20
s_waitcnt lgkmcnt(0)
s_barrier
ds_read_b128 v[100:103], v205 offset:0
ds_read_b128 v[104:107], v205 offset:16
ds_read_b128 v[108:111], v205 offset:32
ds_read_b128 v[112:115], v205 offset:48
ds_read_b64_tr_b16 v[40:41], v216 offset:0
ds_read_b64_tr_b16 v[42:43], v218 offset:512
ds_read_b64_tr_b16 v[44:45], v217 offset:0
ds_read_b64_tr_b16 v[46:47], v219 offset:512
ds_read_b64_tr_b16 v[48:49], v218 offset:0
ds_read_b64_tr_b16 v[50:51], v216 offset:512
ds_read_b64_tr_b16 v[52:53], v219 offset:0
ds_read_b64_tr_b16 v[54:55], v217 offset:512
s_lshl_b32 s38, s32, 2
s_lshl_b32 s20, s35, 1
s_add_u32 s38, s38, s20
s_add_u32 s38, s38, 0
s_lshl_b32 s38, s38, 10
s_add_u32 s38, s38, 12582912
s_lshl_b32 s20, s33, 2
s_add_u32 s20, s20, 0
s_sub_u32 s20, s20, 2
s_cmp_lt_u32 s20, 54
s_cselect_b32 s62, 0x10000000, 0
s_cselect_b32 s20, s20, 0
s_lshl_b32 s20, s20, 16
s_add_u32 s39, s20, s38
s_waitcnt lgkmcnt(6)
v_lshlrev_b32 v88, 16, v40
v_and_b32 v89, 0xffff0000, v40
v_lshlrev_b32 v90, 16, v41
v_and_b32 v91, 0xffff0000, v41
v_lshlrev_b32 v92, 16, v42
v_and_b32 v93, 0xffff0000, v42
v_lshlrev_b32 v94, 16, v43
v_and_b32 v95, 0xffff0000, v43
v_fma_f32 v88, v88, v100, v101
v_fma_f32 v89, v89, v102, v103
v_fma_f32 v90, v90, v104, v105
v_fma_f32 v91, v91, v106, v107
v_fma_f32 v92, v92, v108, v109
v_fma_f32 v93, v93, v110, v111
v_fma_f32 v94, v94, v112, v113
v_fma_f32 v95, v95, v114, v115
v_cvt_pk_bf16_f32 v40, v88, v89
v_cvt_pk_bf16_f32 v41, v90, v91
v_cvt_pk_bf16_f32 v42, v92, v93
v_cvt_pk_bf16_f32 v43, v94, v95
buffer_store_dwordx4 v[40:43], v220, s[60:63], s39 offen sc1
s_lshl_b32 s20, s33, 2
s_add_u32 s20, s20, 1
s_sub_u32 s20, s20, 2
s_cmp_lt_u32 s20, 54
s_cselect_b32 s62, 0x10000000, 0
s_cselect_b32 s20, s20, 0
s_lshl_b32 s20, s20, 16
s_add_u32 s39, s20, s38
s_waitcnt lgkmcnt(4)
v_lshlrev_b32 v88, 16, v44
v_and_b32 v89, 0xffff0000, v44
v_lshlrev_b32 v90, 16, v45
v_and_b32 v91, 0xffff0000, v45
v_lshlrev_b32 v92, 16, v46
v_and_b32 v93, 0xffff0000, v46
v_lshlrev_b32 v94, 16, v47
v_and_b32 v95, 0xffff0000, v47
v_fma_f32 v88, v88, v100, v101
v_fma_f32 v89, v89, v102, v103
v_fma_f32 v90, v90, v104, v105
v_fma_f32 v91, v91, v106, v107
v_fma_f32 v92, v92, v108, v109
v_fma_f32 v93, v93, v110, v111
v_fma_f32 v94, v94, v112, v113
v_fma_f32 v95, v95, v114, v115
v_cvt_pk_bf16_f32 v44, v88, v89
v_cvt_pk_bf16_f32 v45, v90, v91
v_cvt_pk_bf16_f32 v46, v92, v93
v_cvt_pk_bf16_f32 v47, v94, v95
buffer_store_dwordx4 v[44:47], v220, s[60:63], s39 offen sc1
s_lshl_b32 s20, s33, 2
s_add_u32 s20, s20, 2
s_sub_u32 s20, s20, 2
s_cmp_lt_u32 s20, 54
s_cselect_b32 s62, 0x10000000, 0
s_cselect_b32 s20, s20, 0
s_lshl_b32 s20, s20, 16
s_add_u32 s39, s20, s38
s_waitcnt lgkmcnt(2)
v_lshlrev_b32 v88, 16, v48
v_and_b32 v89, 0xffff0000, v48
v_lshlrev_b32 v90, 16, v49
v_and_b32 v91, 0xffff0000, v49
v_lshlrev_b32 v92, 16, v50
v_and_b32 v93, 0xffff0000, v50
v_lshlrev_b32 v94, 16, v51
v_and_b32 v95, 0xffff0000, v51
v_fma_f32 v88, v88, v100, v101
v_fma_f32 v89, v89, v102, v103
v_fma_f32 v90, v90, v104, v105
v_fma_f32 v91, v91, v106, v107
v_fma_f32 v92, v92, v108, v109
v_fma_f32 v93, v93, v110, v111
v_fma_f32 v94, v94, v112, v113
v_fma_f32 v95, v95, v114, v115
v_cvt_pk_bf16_f32 v48, v88, v89
v_cvt_pk_bf16_f32 v49, v90, v91
v_cvt_pk_bf16_f32 v50, v92, v93
v_cvt_pk_bf16_f32 v51, v94, v95
buffer_store_dwordx4 v[48:51], v220, s[60:63], s39 offen sc1
s_lshl_b32 s20, s33, 2
s_add_u32 s20, s20, 3
s_sub_u32 s20, s20, 2
s_cmp_lt_u32 s20, 54
s_cselect_b32 s62, 0x10000000, 0
s_cselect_b32 s20, s20, 0
s_lshl_b32 s20, s20, 16
s_add_u32 s39, s20, s38
s_waitcnt lgkmcnt(0)
v_lshlrev_b32 v88, 16, v52
v_and_b32 v89, 0xffff0000, v52
v_lshlrev_b32 v90, 16, v53
v_and_b32 v91, 0xffff0000, v53
v_lshlrev_b32 v92, 16, v54
v_and_b32 v93, 0xffff0000, v54
v_lshlrev_b32 v94, 16, v55
v_and_b32 v95, 0xffff0000, v55
v_fma_f32 v88, v88, v100, v101
v_fma_f32 v89, v89, v102, v103
v_fma_f32 v90, v90, v104, v105
v_fma_f32 v91, v91, v106, v107
v_fma_f32 v92, v92, v108, v109
v_fma_f32 v93, v93, v110, v111
v_fma_f32 v94, v94, v112, v113
v_fma_f32 v95, v95, v114, v115
v_cvt_pk_bf16_f32 v52, v88, v89
v_cvt_pk_bf16_f32 v53, v90, v91
v_cvt_pk_bf16_f32 v54, v92, v93
v_cvt_pk_bf16_f32 v55, v94, v95
buffer_store_dwordx4 v[52:55], v220, s[60:63], s39 offen sc1
s_barrier
ds_read_b128 v[116:119], v205 offset:256
ds_read_b128 v[120:123], v205 offset:272
ds_read_b128 v[124:127], v205 offset:288
ds_read_b128 v[128:131], v205 offset:304
ds_read_b64_tr_b16 v[56:57], v216 offset:4096
ds_read_b64_tr_b16 v[58:59], v218 offset:4608
ds_read_b64_tr_b16 v[60:61], v217 offset:4096
ds_read_b64_tr_b16 v[62:63], v219 offset:4608
ds_read_b64_tr_b16 v[64:65], v218 offset:4096
ds_read_b64_tr_b16 v[66:67], v216 offset:4608
ds_read_b64_tr_b16 v[68:69], v219 offset:4096
ds_read_b64_tr_b16 v[70:71], v217 offset:4608
s_lshl_b32 s38, s32, 2
s_lshl_b32 s20, s35, 1
s_add_u32 s38, s38, s20
s_add_u32 s38, s38, 1
s_lshl_b32 s38, s38, 10
s_add_u32 s38, s38, 12582912
s_lshl_b32 s20, s33, 2
s_add_u32 s20, s20, 0
s_sub_u32 s20, s20, 2
s_cmp_lt_u32 s20, 54
s_cselect_b32 s62, 0x10000000, 0
s_cselect_b32 s20, s20, 0
s_lshl_b32 s20, s20, 16
s_add_u32 s39, s20, s38
s_waitcnt lgkmcnt(6)
v_lshlrev_b32 v88, 16, v56
v_and_b32 v89, 0xffff0000, v56
v_lshlrev_b32 v90, 16, v57
v_and_b32 v91, 0xffff0000, v57
v_lshlrev_b32 v92, 16, v58
v_and_b32 v93, 0xffff0000, v58
v_lshlrev_b32 v94, 16, v59
v_and_b32 v95, 0xffff0000, v59
v_fma_f32 v88, v88, v116, v117
v_fma_f32 v89, v89, v118, v119
v_fma_f32 v90, v90, v120, v121
v_fma_f32 v91, v91, v122, v123
v_fma_f32 v92, v92, v124, v125
v_fma_f32 v93, v93, v126, v127
v_fma_f32 v94, v94, v128, v129
v_fma_f32 v95, v95, v130, v131
v_cvt_pk_bf16_f32 v56, v88, v89
v_cvt_pk_bf16_f32 v57, v90, v91
v_cvt_pk_bf16_f32 v58, v92, v93
v_cvt_pk_bf16_f32 v59, v94, v95
buffer_store_dwordx4 v[56:59], v220, s[60:63], s39 offen sc1
s_lshl_b32 s20, s33, 2
s_add_u32 s20, s20, 1
s_sub_u32 s20, s20, 2
s_cmp_lt_u32 s20, 54
s_cselect_b32 s62, 0x10000000, 0
s_cselect_b32 s20, s20, 0
s_lshl_b32 s20, s20, 16
s_add_u32 s39, s20, s38
s_waitcnt lgkmcnt(4)
v_lshlrev_b32 v88, 16, v60
v_and_b32 v89, 0xffff0000, v60
v_lshlrev_b32 v90, 16, v61
v_and_b32 v91, 0xffff0000, v61
v_lshlrev_b32 v92, 16, v62
v_and_b32 v93, 0xffff0000, v62
v_lshlrev_b32 v94, 16, v63
v_and_b32 v95, 0xffff0000, v63
v_fma_f32 v88, v88, v116, v117
v_fma_f32 v89, v89, v118, v119
v_fma_f32 v90, v90, v120, v121
v_fma_f32 v91, v91, v122, v123
v_fma_f32 v92, v92, v124, v125
v_fma_f32 v93, v93, v126, v127
v_fma_f32 v94, v94, v128, v129
v_fma_f32 v95, v95, v130, v131
v_cvt_pk_bf16_f32 v60, v88, v89
v_cvt_pk_bf16_f32 v61, v90, v91
v_cvt_pk_bf16_f32 v62, v92, v93
v_cvt_pk_bf16_f32 v63, v94, v95
buffer_store_dwordx4 v[60:63], v220, s[60:63], s39 offen sc1
s_lshl_b32 s20, s33, 2
s_add_u32 s20, s20, 2
s_sub_u32 s20, s20, 2
s_cmp_lt_u32 s20, 54
s_cselect_b32 s62, 0x10000000, 0
s_cselect_b32 s20, s20, 0
s_lshl_b32 s20, s20, 16
s_add_u32 s39, s20, s38
s_waitcnt lgkmcnt(2)
v_lshlrev_b32 v88, 16, v64
v_and_b32 v89, 0xffff0000, v64
v_lshlrev_b32 v90, 16, v65
v_and_b32 v91, 0xffff0000, v65
v_lshlrev_b32 v92, 16, v66
v_and_b32 v93, 0xffff0000, v66
v_lshlrev_b32 v94, 16, v67
v_and_b32 v95, 0xffff0000, v67
v_fma_f32 v88, v88, v116, v117
v_fma_f32 v89, v89, v118, v119
v_fma_f32 v90, v90, v120, v121
v_fma_f32 v91, v91, v122, v123
v_fma_f32 v92, v92, v124, v125
v_fma_f32 v93, v93, v126, v127
v_fma_f32 v94, v94, v128, v129
v_fma_f32 v95, v95, v130, v131
v_cvt_pk_bf16_f32 v64, v88, v89
v_cvt_pk_bf16_f32 v65, v90, v91
v_cvt_pk_bf16_f32 v66, v92, v93
v_cvt_pk_bf16_f32 v67, v94, v95
buffer_store_dwordx4 v[64:67], v220, s[60:63], s39 offen sc1
s_lshl_b32 s20, s33, 2
s_add_u32 s20, s20, 3
s_sub_u32 s20, s20, 2
s_cmp_lt_u32 s20, 54
s_cselect_b32 s62, 0x10000000, 0
s_cselect_b32 s20, s20, 0
s_lshl_b32 s20, s20, 16
s_add_u32 s39, s20, s38
s_waitcnt lgkmcnt(0)
v_lshlrev_b32 v88, 16, v68
v_and_b32 v89, 0xffff0000, v68
v_lshlrev_b32 v90, 16, v69
v_and_b32 v91, 0xffff0000, v69
v_lshlrev_b32 v92, 16, v70
v_and_b32 v93, 0xffff0000, v70
v_lshlrev_b32 v94, 16, v71
v_and_b32 v95, 0xffff0000, v71
v_fma_f32 v88, v88, v116, v117
v_fma_f32 v89, v89, v118, v119
v_fma_f32 v90, v90, v120, v121
v_fma_f32 v91, v91, v122, v123
v_fma_f32 v92, v92, v124, v125
v_fma_f32 v93, v93, v126, v127
v_fma_f32 v94, v94, v128, v129
v_fma_f32 v95, v95, v130, v131
v_cvt_pk_bf16_f32 v68, v88, v89
v_cvt_pk_bf16_f32 v69, v90, v91
v_cvt_pk_bf16_f32 v70, v92, v93
v_cvt_pk_bf16_f32 v71, v94, v95
buffer_store_dwordx4 v[68:71], v220, s[60:63], s39 offen sc1
s_barrier
s_waitcnt vmcnt(0)
s_barrier
s_lshl_b32 s20, s32, 7
s_lshl_b32 s21, s33, 2
s_add_u32 s20, s20, s21
s_add_u32 s20, s20, 31469568
s_cmp_eq_u32 s35, 0
s_cselect_b32 s20, s20, 0x40000000
v_mov_b32 v80, 0x40000000
v_mov_b32 v81, s20
v_cmp_eq_u32 vcc, 0, v250
v_mov_b32 v82, s34
s_nop 0
v_cndmask_b32 v80, v80, v81, vcc
buffer_store_dword v82, v80, s[8:11], 0 offen sc1
s_barrier
s_barrier
s_mul_i32 s20, s37, 112
s_add_u32 s20, s20, 32
s_add_u32 s21, s20, 111
s_lshr_b32 s20, s20, 6
s_lshr_b32 s21, s21, 6
s_min_u32 s21, s21, 13
v_and_b32 v80, 3, v250
v_add_u32 v80, s20, v80
v_min_u32 v80, s21, v80
v_lshrrev_b32 v81, 2, v250
v_lshlrev_b32 v81, 7, v81
v_lshl_add_u32 v80, v80, 2, v81
v_add_u32 v221, 31469568, v80
buffer_load_dword v222, v221, s[8:11], 0 offen sc1
s_barrier
s_waitcnt vmcnt(0)
s_mov_b32 s30, 0
Lfz_88:
v_cmp_ne_u32 vcc, s34, v222
s_nop 3
s_cmp_eq_u64 vcc, 0
s_cbranch_scc1 Lfzok_89
s_add_u32 s30, s30, 1
s_cmp_gt_u32 s30, 4000
s_cbranch_scc1 Lfzok_89
buffer_load_dword v222, v221, s[8:11], 0 offen sc1
s_waitcnt vmcnt(0)
s_branch Lfz_88
Lfzok_89:
s_barrier
s_barrier
s_lshr_b32 s20, s36, 1
s_and_b32 s21, s36, 1
s_xor_b32 s21, s21, 1
s_sub_u32 s21, s20, s21
s_max_i32 s21, s21, 0
v_bfe_u32 v140, v250, 4, 1
v_cmp_eq_u32 vcc, 1, v140
v_mov_b32 v141, s20
v_mov_b32 v142, s21
v_cndmask_b32 v141, v141, v142, vcc
v_lshlrev_b32 v141, 7, v141
v_and_b32 v142, 15, v250
v_lshl_add_u32 v141, v142, 2, v141
v_add_u32 v152, 31473664, v141
v_lshlrev_b32 v10, 4, v250
v_cmp_gt_u32 vcc, 32, v250
v_add_u32 v140, 2048, v10
v_add_u32 v141, 60928, v10
v_cndmask_b32 v11, v141, v140, vcc
v_add_u32 v141, 19968, v10
v_cndmask_b32 v12, v141, v140, vcc
v_and_b32 v148, 15, v250
v_lshrrev_b32 v149, 4, v250
v_lshlrev_b32 v150, 4, v148
v_cmp_gt_u32 vcc, 3, v149
s_nop 1
v_cndmask_b32 v40, 0, -1, vcc
v_cmp_gt_u32 vcc, 2, v149
s_nop 1
v_cndmask_b32 v41, 0, -1, vcc
v_min_u32 v140, 2, v149
v_add_u32 v141, 1, v149
v_and_b32 v141, v41, v141
s_mul_i32 s20, s35, 5120
s_add_u32 s20, s20, 81920
s_mul_i32 s21, s35, 10240
s_add_u32 s21, s21, 92160
v_lshl_add_u32 v142, v140, 8, v150
v_add_u32 v14, s20, v142
v_add_u32 v16, s21, v142
v_lshl_add_u32 v142, v141, 8, v150
v_add_u32 v15, s20, v142
v_add_u32 v17, s21, v142
v_lshrrev_b32 v140, 2, v148
v_lshl_add_u32 v140, v149, 2, v140
v_lshlrev_b32 v140, 4, v140
v_and_b32 v141, 3, v148
s_add_u32 s22, s21, 2560
v_add_u32 v142, 0, v141
v_lshrrev_b32 v143, 1, v142
v_and_b32 v142, 1, v142
v_lshl_add_u32 v143, v143, 8, v140
v_lshl_add_u32 v143, v142, 3, v143
v_add_u32 v18, s22, v143
v_add_u32 v142, 1, v141
v_lshrrev_b32 v143, 1, v142
v_and_b32 v142, 1, v142
v_lshl_add_u32 v143, v143, 8, v140
v_lshl_add_u32 v143, v142, 3, v143
v_add_u32 v19, s22, v143
v_add_u32 v142, 0, v149
v_lshrrev_b32 v143, 1, v142
v_and_b32 v142, 1, v142
v_lshl_add_u32 v143, v143, 8, v150
v_lshl_add_u32 v143, v142, 3, v143
v_add_u32 v20, s20, v143
v_add_u32 v143, 512, v150
v_add_u32 v22, s20, v143
v_add_u32 v142, 1, v149
v_lshrrev_b32 v143, 1, v142
v_and_b32 v142, 1, v142
v_lshl_add_u32 v143, v143, 8, v150
v_lshl_add_u32 v143, v142, 3, v143
v_add_u32 v21, s20, v143
v_add_u32 v143, 520, v150
v_add_u32 v23, s20, v143
v_lshlrev_b32 v144, 2, v149
v_sub_u32 v144, v148, v144
v_mov_b32 v146, 0xce6e6b28
v_add_u32 v145, 16, v144
v_and_b32 v147, 0xfffffff1, v145
v_cmp_eq_u32 vcc, 0, v147
s_nop 0
s_nop 0
v_cndmask_b32 v24, v146, 0, vcc
v_add_u32 v145, 15, v144
v_and_b32 v147, 0xfffffff1, v145
v_cmp_eq_u32 vcc, 0, v147
s_nop 0
s_nop 0
v_cndmask_b32 v25, v146, 0, vcc
v_add_u32 v145, 14, v144
v_and_b32 v147, 0xfffffff1, v145
v_cmp_eq_u32 vcc, 0, v147
s_nop 0
s_nop 0
v_cndmask_b32 v26, v146, 0, vcc
v_add_u32 v145, 13, v144
v_and_b32 v147, 0xfffffff1, v145
v_cmp_eq_u32 vcc, 0, v147
s_nop 0
s_nop 0
v_cndmask_b32 v27, v146, 0, vcc
v_add_u32 v145, 0, v144
v_and_b32 v147, 0xfffffff1, v145
v_cmp_eq_u32 vcc, 0, v147
s_nop 0
s_nop 0
v_cndmask_b32 v28, v146, 0, vcc
v_add_u32 v145, -1, v144
v_and_b32 v147, 0xfffffff1, v145
v_cmp_eq_u32 vcc, 0, v147
s_nop 0
s_nop 0
v_cndmask_b32 v29, v146, 0, vcc
v_add_u32 v145, -2, v144
v_and_b32 v147, 0xfffffff1, v145
v_cmp_eq_u32 vcc, 0, v147
s_nop 0
s_nop 0
v_cndmask_b32 v30, v146, 0, vcc
v_add_u32 v145, -3, v144
v_and_b32 v147, 0xfffffff1, v145
v_cmp_eq_u32 vcc, 0, v147
s_nop 0
s_nop 0
v_cndmask_b32 v31, v146, 0, vcc
s_or_b32 s20, s36, s35
s_cmp_eq_u32 s20, 0
s_cselect_b64 vcc, -1, 0
v_cndmask_b32 v32, v24, v146, vcc
v_cndmask_b32 v33, v25, v146, vcc
v_cndmask_b32 v34, v26, v146, vcc
v_cndmask_b32 v35, v27, v146, vcc
v_mov_b32 v36, 0x3f803f80
v_mov_b32 v37, 0x3f803f80
v_mov_b32 v38, 0x3f803f80
v_mov_b32 v39, 0x3f803f80
v_mov_b32 v42, 0x3ea52b5c
v_lshlrev_b32 v154, 4, v250
v_add_u32 v154, 31461376, v154
buffer_load_dwordx4 v[156:159], v154, s[8:11], 0 offen sc1
s_barrier
s_waitcnt vmcnt(0)
s_mov_b32 s30, 0
Lfw_90:
v_xor_b32 v140, s34, v156
v_xor_b32 v141, s34, v157
v_or_b32 v140, v140, v141
v_xor_b32 v141, s34, v158
v_or_b32 v140, v140, v141
v_xor_b32 v141, s34, v159
v_or_b32 v140, v140, v141
v_cmp_ne_u32 vcc, 0, v140
s_nop 3
s_cmp_eq_u64 vcc, 0
s_cbranch_scc1 Lfwok_91
s_add_u32 s30, s30, 1
s_cmp_gt_u32 s30, 4000
s_cbranch_scc1 Lfwok_91
buffer_load_dwordx4 v[156:159], v154, s[8:11], 0 offen sc1
s_waitcnt vmcnt(0)
s_branch Lfw_90
Lfwok_91:
s_mov_b32 s21, 31457280
s_cmp_eq_u32 s2, 0
s_cselect_b32 s20, s21, 0x40000000
s_cmp_eq_u32 s35, 0
s_cselect_b32 s20, s20, 0x40000000
v_mov_b32 v80, 0x40000000
v_mov_b32 v81, s20
v_cmp_eq_u32 vcc, 0, v250
v_mov_b32 v82, s34
s_nop 0
v_cndmask_b32 v80, v80, v81, vcc
buffer_store_dword v82, v80, s[8:11], 0 offen sc1
s_barrier
s_lshl_b32 s20, s32, 7
s_lshl_b32 s21, s33, 2
s_add_u32 s20, s20, s21
s_add_u32 s20, s20, 31473664
s_cmp_eq_u32 s35, 0
s_cselect_b32 s20, s20, 0x40000000
v_mov_b32 v80, 0x40000000
v_mov_b32 v81, s20
v_cmp_eq_u32 vcc, 0, v250
v_mov_b32 v82, s34
s_nop 0
v_cndmask_b32 v80, v80, v81, vcc
buffer_store_dword v82, v80, s[8:11], 0 offen sc1
s_barrier
s_barrier
buffer_load_dword v153, v152, s[8:11], 0 offen sc1
s_waitcnt vmcnt(0)
s_mov_b32 s30, 0
Lfp_92:
v_cmp_ne_u32 vcc, s34, v153
s_nop 3
s_cmp_eq_u64 vcc, 0
s_cbranch_scc1 Lfpok_93
s_add_u32 s30, s30, 1
s_cmp_gt_u32 s30, 4000
s_cbranch_scc1 Lfpok_93
buffer_load_dword v153, v152, s[8:11], 0 offen sc1
s_waitcnt vmcnt(0)
s_branch Lfp_92
Lfpok_93:
s_lshl_b32 s40, s36, 2
s_lshl_b32 s20, s35, 1
s_add_u32 s40, s40, s20
s_mul_i32 s40, s40, 61440
s_mul_i32 s41, s37, 2560
s_add_u32 s40, s40, s41
s_mul_i32 s42, s35, 5120
s_add_u32 s42, s42, 81920
s_add_u32 m0, s42, 0
s_add_u32 s20, s40, 0
buffer_load_dwordx4 v10, s[8:11], s20 offen sc1 lds
s_add_u32 m0, s42, 1024
s_add_u32 s20, s40, 1024
buffer_load_dwordx4 v10, s[8:11], s20 offen sc1 lds
s_add_u32 m0, s42, 2048
s_add_u32 s20, s40, 0
buffer_load_dwordx4 v11, s[8:11], s20 offen sc1 lds
s_add_u32 m0, s42, 3072
s_add_u32 s20, s40, 61952
buffer_load_dwordx4 v10, s[8:11], s20 offen sc1 lds
s_add_u32 m0, s42, 4096
s_add_u32 s20, s40, 62976
buffer_load_dwordx4 v10, s[8:11], s20 offen sc1 lds
s_lshl_b32 s40, s36, 2
s_add_u32 s40, s40, s35
s_add_u32 s40, s40, 0
s_cmp_eq_u32 s40, 0
s_cselect_b32 s43, 0x40000000, 0
s_max_u32 s40, s40, 1
s_sub_u32 s40, s40, 1
s_mul_i32 s40, s40, 61440
s_add_u32 s40, s40, s41
s_add_u32 s40, s40, 20480
s_mul_i32 s42, s35, 5120
s_add_u32 s42, s42, 92160
s_add_u32 m0, s42, 0
s_add_u32 s20, s40, 0
v_or_b32 v140, s43, v10
buffer_load_dwordx4 v140, s[8:11], s20 offen sc1 lds
s_add_u32 m0, s42, 1024
s_add_u32 s20, s40, 1024
v_or_b32 v140, s43, v10
buffer_load_dwordx4 v140, s[8:11], s20 offen sc1 lds
s_add_u32 m0, s42, 2048
s_add_u32 s20, s40, 0
v_or_b32 v140, s43, v12
buffer_load_dwordx4 v140, s[8:11], s20 offen sc1 lds
s_add_u32 m0, s42, 3072
s_add_u32 s20, s40, 20992
v_or_b32 v140, s43, v10
buffer_load_dwordx4 v140, s[8:11], s20 offen sc1 lds
s_add_u32 m0, s42, 4096
s_add_u32 s20, s40, 22016
v_or_b32 v140, s43, v10
buffer_load_dwordx4 v140, s[8:11], s20 offen sc1 lds
s_lshl_b32 s40, s36, 2
s_add_u32 s40, s40, s35
s_add_u32 s40, s40, 2
s_sub_u32 s40, s40, 1
s_mul_i32 s40, s40, 61440
s_add_u32 s40, s40, s41
s_add_u32 s40, s40, 20480
s_mul_i32 s42, s35, 5120
s_add_u32 s42, s42, 102400
s_add_u32 m0, s42, 0
s_add_u32 s20, s40, 0
buffer_load_dwordx4 v10, s[8:11], s20 offen sc1 lds
s_add_u32 m0, s42, 1024
s_add_u32 s20, s40, 1024
buffer_load_dwordx4 v10, s[8:11], s20 offen sc1 lds
s_add_u32 m0, s42, 2048
s_add_u32 s20, s40, 0
buffer_load_dwordx4 v12, s[8:11], s20 offen sc1 lds
s_add_u32 m0, s42, 3072
s_add_u32 s20, s40, 20992
buffer_load_dwordx4 v10, s[8:11], s20 offen sc1 lds
s_add_u32 m0, s42, 4096
s_add_u32 s20, s40, 22016
buffer_load_dwordx4 v10, s[8:11], s20 offen sc1 lds
s_lshl_b32 s40, s36, 2
s_add_u32 s40, s40, s35
s_add_u32 s40, s40, 4
s_cmp_eq_u32 s35, 1
s_cselect_b32 s43, 0x40000000, 0
s_sub_u32 s40, s40, s35
s_sub_u32 s40, s40, 1
s_mul_i32 s40, s40, 61440
s_add_u32 s40, s40, s41
s_add_u32 s40, s40, 20480
s_mul_i32 s42, s35, 5120
s_add_u32 s42, s42, 112640
s_add_u32 m0, s42, 0
s_add_u32 s20, s40, 0
v_or_b32 v140, s43, v10
buffer_load_dwordx4 v140, s[8:11], s20 offen sc1 lds
s_add_u32 m0, s42, 1024
s_add_u32 s20, s40, 1024
v_or_b32 v140, s43, v10
buffer_load_dwordx4 v140, s[8:11], s20 offen sc1 lds
s_add_u32 m0, s42, 2048
s_add_u32 s20, s40, 0
v_or_b32 v140, s43, v12
buffer_load_dwordx4 v140, s[8:11], s20 offen sc1 lds
s_add_u32 m0, s42, 3072
s_add_u32 s20, s40, 20992
v_or_b32 v140, s43, v10
buffer_load_dwordx4 v140, s[8:11], s20 offen sc1 lds
s_add_u32 m0, s42, 4096
s_add_u32 s20, s40, 22016
v_or_b32 v140, s43, v10
buffer_load_dwordx4 v140, s[8:11], s20 offen sc1 lds
s_barrier
s_waitcnt vmcnt(0)
s_barrier
ds_read_b128 v[50:53], v14 offset:0
ds_read_b128 v[54:57], v16 offset:0
ds_read_b128 v[58:61], v16 offset:5120
ds_read_b128 v[94:97], v15 offset:512
ds_read_b128 v[98:101], v17 offset:512
ds_read_b128 v[102:105], v17 offset:5632
ds_read_b64_tr_b16 v[62:63], v18 offset:0
ds_read_b64_tr_b16 v[64:65], v18 offset:5120
ds_read_b64_tr_b16 v[66:67], v18 offset:512
ds_read_b64_tr_b16 v[68:69], v18 offset:5632
ds_read_b64_tr_b16 v[106:107], v19 offset:512
ds_read_b64_tr_b16 v[108:109], v19 offset:5632
ds_read_b64_tr_b16 v[110:111], v19 offset:1024
ds_read_b64_tr_b16 v[112:113], v19 offset:6144
s_waitcnt lgkmcnt(11)
v_and_b32 v50, v40, v50
v_and_b32 v51, v40, v51
v_and_b32 v52, v41, v52
v_and_b32 v53, v41, v53
s_nop 1
v_mfma_f32_16x16x32_bf16 v[70:73], v[54:57], v[50:53], v[32:35]
v_mfma_f32_16x16x32_bf16 v[74:77], v[58:61], v[50:53], v[28:31]
s_waitcnt lgkmcnt(8)
v_and_b32 v94, v41, v94
v_and_b32 v95, v41, v95
v_and_b32 v96, v40, v96
v_and_b32 v97, v40, v97
s_nop 1
v_mfma_f32_16x16x32_bf16 v[114:117], v[98:101], v[94:97], v[32:35]
v_mfma_f32_16x16x32_bf16 v[118:121], v[102:105], v[94:97], v[28:31]
s_nop 7
v_max3_f32 v140, v70, v71, v72
v_max3_f32 v141, v73, v74, v75
v_max3_f32 v140, v76, v77, v140
v_max_f32 v140, v140, v141
v_max3_f32 v144, v114, v115, v116
v_max3_f32 v145, v117, v118, v119
v_max3_f32 v144, v120, v121, v144
v_max_f32 v144, v144, v145
v_mov_b32 v141, v140
v_mov_b32 v145, v144
s_nop 1
v_permlane32_swap_b32 v140, v141
v_permlane32_swap_b32 v144, v145
s_nop 0
v_max_f32 v140, v140, v141
v_max_f32 v144, v144, v145
v_mov_b32 v141, v140
v_mov_b32 v145, v144
s_nop 1
v_permlane16_swap_b32 v140, v141
v_permlane16_swap_b32 v144, v145
s_nop 0
v_max_f32 v140, v140, v141
v_max_f32 v144, v144, v145
v_mul_f32 v140, v140, v42
v_mul_f32 v144, v144, v42
v_fma_f32 v70, v70, v42, -v140
v_fma_f32 v71, v71, v42, -v140
v_fma_f32 v72, v72, v42, -v140
v_fma_f32 v73, v73, v42, -v140
v_fma_f32 v74, v74, v42, -v140
v_fma_f32 v75, v75, v42, -v140
v_fma_f32 v76, v76, v42, -v140
v_fma_f32 v77, v77, v42, -v140
v_fma_f32 v114, v114, v42, -v144
v_fma_f32 v115, v115, v42, -v144
v_fma_f32 v116, v116, v42, -v144
v_fma_f32 v117, v117, v42, -v144
v_fma_f32 v118, v118, v42, -v144
v_fma_f32 v119, v119, v42, -v144
v_fma_f32 v120, v120, v42, -v144
v_fma_f32 v121, v121, v42, -v144
v_exp_f32 v70, v70
v_exp_f32 v71, v71
v_exp_f32 v72, v72
v_exp_f32 v73, v73
v_exp_f32 v74, v74
v_exp_f32 v75, v75
v_exp_f32 v76, v76
v_exp_f32 v77, v77
v_exp_f32 v114, v114
v_exp_f32 v115, v115
v_exp_f32 v116, v116
v_exp_f32 v117, v117
v_exp_f32 v118, v118
v_exp_f32 v119, v119
v_exp_f32 v120, v120
v_exp_f32 v121, v121
v_cvt_pk_bf16_f32 v78, v70, v71
v_cvt_pk_bf16_f32 v79, v72, v73
v_cvt_pk_bf16_f32 v80, v74, v75
v_cvt_pk_bf16_f32 v81, v76, v77
v_cvt_pk_bf16_f32 v122, v114, v115
v_cvt_pk_bf16_f32 v123, v116, v117
v_cvt_pk_bf16_f32 v124, v118, v119
s_barrier
v_cvt_pk_bf16_f32 v125, v120, v121
s_waitcnt lgkmcnt(0)
s_nop 1
v_mfma_f32_16x16x32_bf16 v[90:93], v[36:39], v[78:81], 0
v_mfma_f32_16x16x32_bf16 v[82:85], v[62:65], v[78:81], 0
v_mfma_f32_16x16x32_bf16 v[86:89], v[66:69], v[78:81], 0
v_mfma_f32_16x16x32_bf16 v[134:137], v[36:39], v[122:125], 0
v_mfma_f32_16x16x32_bf16 v[126:129], v[106:109], v[122:125], 0
v_mfma_f32_16x16x32_bf16 v[130:133], v[110:113], v[122:125], 0
s_nop 7
v_rcp_f32 v90, v90
v_rcp_f32 v134, v134
s_nop 0
v_mul_f32 v82, v82, v90
v_mul_f32 v83, v83, v90
v_mul_f32 v84, v84, v90
v_mul_f32 v85, v85, v90
v_mul_f32 v86, v86, v90
v_mul_f32 v87, v87, v90
v_mul_f32 v88, v88, v90
v_mul_f32 v89, v89, v90
v_cvt_pk_bf16_f32 v78, v82, v83
v_cvt_pk_bf16_f32 v79, v84, v85
v_cvt_pk_bf16_f32 v80, v86, v87
v_cvt_pk_bf16_f32 v81, v88, v89
ds_write_b64 v20, v[78:79] offset:0
s_mov_b64 exec, 0xffff
ds_write_b64 v22, v[80:81] offset:0
s_mov_b64 exec, -1
v_mul_f32 v126, v126, v134
v_mul_f32 v127, v127, v134
v_mul_f32 v128, v128, v134
v_mul_f32 v129, v129, v134
v_mul_f32 v130, v130, v134
v_mul_f32 v131, v131, v134
v_mul_f32 v132, v132, v134
v_mul_f32 v133, v133, v134
v_cvt_pk_bf16_f32 v122, v126, v127
v_cvt_pk_bf16_f32 v123, v128, v129
v_cvt_pk_bf16_f32 v124, v130, v131
v_cvt_pk_bf16_f32 v125, v132, v133
ds_write_b64 v21, v[122:123] offset:512
s_mov_b64 exec, 0xffff
ds_write_b64 v23, v[124:125] offset:512
s_mov_b64 exec, -1
ds_read_b128 v[50:53], v14 offset:1280
ds_read_b128 v[54:57], v16 offset:1280
ds_read_b128 v[58:61], v16 offset:6400
ds_read_b128 v[94:97], v15 offset:1792
ds_read_b128 v[98:101], v17 offset:1792
ds_read_b128 v[102:105], v17 offset:6912
ds_read_b64_tr_b16 v[62:63], v18 offset:1280
ds_read_b64_tr_b16 v[64:65], v18 offset:6400
ds_read_b64_tr_b16 v[66:67], v18 offset:1792
ds_read_b64_tr_b16 v[68:69], v18 offset:6912
ds_read_b64_tr_b16 v[106:107], v19 offset:1792
ds_read_b64_tr_b16 v[108:109], v19 offset:6912
ds_read_b64_tr_b16 v[110:111], v19 offset:2304
ds_read_b64_tr_b16 v[112:113], v19 offset:7424
s_waitcnt lgkmcnt(11)
v_and_b32 v50, v40, v50
v_and_b32 v51, v40, v51
v_and_b32 v52, v41, v52
v_and_b32 v53, v41, v53
s_nop 1
v_mfma_f32_16x16x32_bf16 v[70:73], v[54:57], v[50:53], v[32:35]
v_mfma_f32_16x16x32_bf16 v[74:77], v[58:61], v[50:53], v[28:31]
s_waitcnt lgkmcnt(8)
v_and_b32 v94, v41, v94
v_and_b32 v95, v41, v95
v_and_b32 v96, v40, v96
v_and_b32 v97, v40, v97
s_nop 1
v_mfma_f32_16x16x32_bf16 v[114:117], v[98:101], v[94:97], v[32:35]
v_mfma_f32_16x16x32_bf16 v[118:121], v[102:105], v[94:97], v[28:31]
s_nop 7
v_max3_f32 v140, v70, v71, v72
v_max3_f32 v141, v73, v74, v75
v_max3_f32 v140, v76, v77, v140
v_max_f32 v140, v140, v141
v_max3_f32 v144, v114, v115, v116
s_barrier
v_max3_f32 v145, v117, v118, v119
v_max3_f32 v144, v120, v121, v144
v_max_f32 v144, v144, v145
v_mov_b32 v141, v140
v_mov_b32 v145, v144
s_nop 1
v_permlane32_swap_b32 v140, v141
v_permlane32_swap_b32 v144, v145
s_nop 0
v_max_f32 v140, v140, v141
v_max_f32 v144, v144, v145
v_mov_b32 v141, v140
v_mov_b32 v145, v144
s_nop 1
v_permlane16_swap_b32 v140, v141
v_permlane16_swap_b32 v144, v145
s_nop 0
v_max_f32 v140, v140, v141
v_max_f32 v144, v144, v145
v_mul_f32 v140, v140, v42
v_mul_f32 v144, v144, v42
v_fma_f32 v70, v70, v42, -v140
v_fma_f32 v71, v71, v42, -v140
v_fma_f32 v72, v72, v42, -v140
v_fma_f32 v73, v73, v42, -v140
v_fma_f32 v74, v74, v42, -v140
v_fma_f32 v75, v75, v42, -v140
v_fma_f32 v76, v76, v42, -v140
v_fma_f32 v77, v77, v42, -v140
v_fma_f32 v114, v114, v42, -v144
v_fma_f32 v115, v115, v42, -v144
v_fma_f32 v116, v116, v42, -v144
v_fma_f32 v117, v117, v42, -v144
v_fma_f32 v118, v118, v42, -v144
v_fma_f32 v119, v119, v42, -v144
v_fma_f32 v120, v120, v42, -v144
v_fma_f32 v121, v121, v42, -v144
v_exp_f32 v70, v70
v_exp_f32 v71, v71
v_exp_f32 v72, v72
v_exp_f32 v73, v73
v_exp_f32 v74, v74
v_exp_f32 v75, v75
v_exp_f32 v76, v76
v_exp_f32 v77, v77
v_exp_f32 v114, v114
v_exp_f32 v115, v115
v_exp_f32 v116, v116
v_exp_f32 v117, v117
v_exp_f32 v118, v118
v_exp_f32 v119, v119
v_exp_f32 v120, v120
v_exp_f32 v121, v121
v_cvt_pk_bf16_f32 v78, v70, v71
v_cvt_pk_bf16_f32 v79, v72, v73
v_cvt_pk_bf16_f32 v80, v74, v75
v_cvt_pk_bf16_f32 v81, v76, v77
v_cvt_pk_bf16_f32 v122, v114, v115
v_cvt_pk_bf16_f32 v123, v116, v117
v_cvt_pk_bf16_f32 v124, v118, v119
v_cvt_pk_bf16_f32 v125, v120, v121
s_waitcnt lgkmcnt(0)
s_nop 1
v_mfma_f32_16x16x32_bf16 v[90:93], v[36:39], v[78:81], 0
v_mfma_f32_16x16x32_bf16 v[82:85], v[62:65], v[78:81], 0
v_mfma_f32_16x16x32_bf16 v[86:89], v[66:69], v[78:81], 0
v_mfma_f32_16x16x32_bf16 v[134:137], v[36:39], v[122:125], 0
v_mfma_f32_16x16x32_bf16 v[126:129], v[106:109], v[122:125], 0
v_mfma_f32_16x16x32_bf16 v[130:133], v[110:113], v[122:125], 0
s_nop 7
v_rcp_f32 v90, v90
v_rcp_f32 v134, v134
s_nop 0
v_mul_f32 v82, v82, v90
v_mul_f32 v83, v83, v90
v_mul_f32 v84, v84, v90
v_mul_f32 v85, v85, v90
v_mul_f32 v86, v86, v90
v_mul_f32 v87, v87, v90
v_mul_f32 v88, v88, v90
v_mul_f32 v89, v89, v90
v_cvt_pk_bf16_f32 v78, v82, v83
v_cvt_pk_bf16_f32 v79, v84, v85
v_cvt_pk_bf16_f32 v80, v86, v87
v_cvt_pk_bf16_f32 v81, v88, v89
ds_write_b64 v20, v[78:79] offset:1280
s_mov_b64 exec, 0xffff
ds_write_b64 v22, v[80:81] offset:1280
s_mov_b64 exec, -1
v_mul_f32 v126, v126, v134
v_mul_f32 v127, v127, v134
v_mul_f32 v128, v128, v134
v_mul_f32 v129, v129, v134
v_mul_f32 v130, v130, v134
v_mul_f32 v131, v131, v134
v_mul_f32 v132, v132, v134
v_mul_f32 v133, v133, v134
v_cvt_pk_bf16_f32 v122, v126, v127
v_cvt_pk_bf16_f32 v123, v128, v129
v_cvt_pk_bf16_f32 v124, v130, v131
v_cvt_pk_bf16_f32 v125, v132, v133
ds_write_b64 v21, v[122:123] offset:1792
s_mov_b64 exec, 0xffff
ds_write_b64 v23, v[124:125] offset:1792
s_mov_b64 exec, -1
s_barrier
ds_read_b128 v[50:53], v14 offset:2560
ds_read_b128 v[54:57], v16 offset:5120
ds_read_b128 v[58:61], v16 offset:10240
ds_read_b128 v[94:97], v15 offset:3072
ds_read_b128 v[98:101], v17 offset:5632
ds_read_b128 v[102:105], v17 offset:10752
ds_read_b64_tr_b16 v[62:63], v18 offset:5120
ds_read_b64_tr_b16 v[64:65], v18 offset:10240
ds_read_b64_tr_b16 v[66:67], v18 offset:5632
ds_read_b64_tr_b16 v[68:69], v18 offset:10752
ds_read_b64_tr_b16 v[106:107], v19 offset:5632
ds_read_b64_tr_b16 v[108:109], v19 offset:10752
ds_read_b64_tr_b16 v[110:111], v19 offset:6144
ds_read_b64_tr_b16 v[112:113], v19 offset:11264
s_waitcnt lgkmcnt(11)
v_and_b32 v50, v40, v50
v_and_b32 v51, v40, v51
v_and_b32 v52, v41, v52
v_and_b32 v53, v41, v53
s_nop 1
v_mfma_f32_16x16x32_bf16 v[70:73], v[54:57], v[50:53], v[24:27]
v_mfma_f32_16x16x32_bf16 v[74:77], v[58:61], v[50:53], v[28:31]
s_waitcnt lgkmcnt(8)
v_and_b32 v94, v41, v94
v_and_b32 v95, v41, v95
v_and_b32 v96, v40, v96
v_and_b32 v97, v40, v97
s_nop 1
v_mfma_f32_16x16x32_bf16 v[114:117], v[98:101], v[94:97], v[24:27]
v_mfma_f32_16x16x32_bf16 v[118:121], v[102:105], v[94:97], v[28:31]
s_nop 7
v_max3_f32 v140, v70, v71, v72
v_max3_f32 v141, v73, v74, v75
v_max3_f32 v140, v76, v77, v140
v_max_f32 v140, v140, v141
v_max3_f32 v144, v114, v115, v116
v_max3_f32 v145, v117, v118, v119
v_max3_f32 v144, v120, v121, v144
v_max_f32 v144, v144, v145
v_mov_b32 v141, v140
v_mov_b32 v145, v144
s_nop 1
v_permlane32_swap_b32 v140, v141
v_permlane32_swap_b32 v144, v145
s_nop 0
v_max_f32 v140, v140, v141
v_max_f32 v144, v144, v145
v_mov_b32 v141, v140
v_mov_b32 v145, v144
s_nop 1
v_permlane16_swap_b32 v140, v141
v_permlane16_swap_b32 v144, v145
s_nop 0
v_max_f32 v140, v140, v141
v_max_f32 v144, v144, v145
v_mul_f32 v140, v140, v42
v_mul_f32 v144, v144, v42
v_fma_f32 v70, v70, v42, -v140
v_fma_f32 v71, v71, v42, -v140
v_fma_f32 v72, v72, v42, -v140
v_fma_f32 v73, v73, v42, -v140
v_fma_f32 v74, v74, v42, -v140
v_fma_f32 v75, v75, v42, -v140
v_fma_f32 v76, v76, v42, -v140
v_fma_f32 v77, v77, v42, -v140
v_fma_f32 v114, v114, v42, -v144
v_fma_f32 v115, v115, v42, -v144
v_fma_f32 v116, v116, v42, -v144
v_fma_f32 v117, v117, v42, -v144
v_fma_f32 v118, v118, v42, -v144
v_fma_f32 v119, v119, v42, -v144
v_fma_f32 v120, v120, v42, -v144
v_fma_f32 v121, v121, v42, -v144
v_exp_f32 v70, v70
v_exp_f32 v71, v71
v_exp_f32 v72, v72
v_exp_f32 v73, v73
v_exp_f32 v74, v74
v_exp_f32 v75, v75
v_exp_f32 v76, v76
v_exp_f32 v77, v77
v_exp_f32 v114, v114
v_exp_f32 v115, v115
v_exp_f32 v116, v116
v_exp_f32 v117, v117
v_exp_f32 v118, v118
v_exp_f32 v119, v119
v_exp_f32 v120, v120
v_exp_f32 v121, v121
v_cvt_pk_bf16_f32 v78, v70, v71
v_cvt_pk_bf16_f32 v79, v72, v73
v_cvt_pk_bf16_f32 v80, v74, v75
v_cvt_pk_bf16_f32 v81, v76, v77
v_cvt_pk_bf16_f32 v122, v114, v115
v_cvt_pk_bf16_f32 v123, v116, v117
v_cvt_pk_bf16_f32 v124, v118, v119
s_barrier
v_cvt_pk_bf16_f32 v125, v120, v121
s_waitcnt lgkmcnt(0)
s_nop 1
v_mfma_f32_16x16x32_bf16 v[90:93], v[36:39], v[78:81], 0
v_mfma_f32_16x16x32_bf16 v[82:85], v[62:65], v[78:81], 0
v_mfma_f32_16x16x32_bf16 v[86:89], v[66:69], v[78:81], 0
v_mfma_f32_16x16x32_bf16 v[134:137], v[36:39], v[122:125], 0
v_mfma_f32_16x16x32_bf16 v[126:129], v[106:109], v[122:125], 0
v_mfma_f32_16x16x32_bf16 v[130:133], v[110:113], v[122:125], 0
s_nop 7
v_rcp_f32 v90, v90
v_rcp_f32 v134, v134
s_nop 0
v_mul_f32 v82, v82, v90
v_mul_f32 v83, v83, v90
v_mul_f32 v84, v84, v90
v_mul_f32 v85, v85, v90
v_mul_f32 v86, v86, v90
v_mul_f32 v87, v87, v90
v_mul_f32 v88, v88, v90
v_mul_f32 v89, v89, v90
v_cvt_pk_bf16_f32 v78, v82, v83
v_cvt_pk_bf16_f32 v79, v84, v85
v_cvt_pk_bf16_f32 v80, v86, v87
v_cvt_pk_bf16_f32 v81, v88, v89
ds_write_b64 v20, v[78:79] offset:2560
s_mov_b64 exec, 0xffff
ds_write_b64 v22, v[80:81] offset:2560
s_mov_b64 exec, -1
v_mul_f32 v126, v126, v134
v_mul_f32 v127, v127, v134
v_mul_f32 v128, v128, v134
v_mul_f32 v129, v129, v134
v_mul_f32 v130, v130, v134
v_mul_f32 v131, v131, v134
v_mul_f32 v132, v132, v134
v_mul_f32 v133, v133, v134
v_cvt_pk_bf16_f32 v122, v126, v127
v_cvt_pk_bf16_f32 v123, v128, v129
v_cvt_pk_bf16_f32 v124, v130, v131
v_cvt_pk_bf16_f32 v125, v132, v133
ds_write_b64 v21, v[122:123] offset:3072
s_mov_b64 exec, 0xffff
ds_write_b64 v23, v[124:125] offset:3072
s_mov_b64 exec, -1
ds_read_b128 v[50:53], v14 offset:3840
ds_read_b128 v[54:57], v16 offset:6400
ds_read_b128 v[58:61], v16 offset:11520
ds_read_b128 v[94:97], v15 offset:4352
ds_read_b128 v[98:101], v17 offset:6912
ds_read_b128 v[102:105], v17 offset:12032
ds_read_b64_tr_b16 v[62:63], v18 offset:6400
ds_read_b64_tr_b16 v[64:65], v18 offset:11520
ds_read_b64_tr_b16 v[66:67], v18 offset:6912
ds_read_b64_tr_b16 v[68:69], v18 offset:12032
ds_read_b64_tr_b16 v[106:107], v19 offset:6912
ds_read_b64_tr_b16 v[108:109], v19 offset:12032
ds_read_b64_tr_b16 v[110:111], v19 offset:7424
ds_read_b64_tr_b16 v[112:113], v19 offset:12544
s_waitcnt lgkmcnt(11)
v_and_b32 v50, v40, v50
v_and_b32 v51, v40, v51
v_and_b32 v52, v41, v52
v_and_b32 v53, v41, v53
s_nop 1
v_mfma_f32_16x16x32_bf16 v[70:73], v[54:57], v[50:53], v[24:27]
v_mfma_f32_16x16x32_bf16 v[74:77], v[58:61], v[50:53], v[28:31]
s_waitcnt lgkmcnt(8)
v_and_b32 v94, v41, v94
v_and_b32 v95, v41, v95
v_and_b32 v96, v40, v96
v_and_b32 v97, v40, v97
s_nop 1
v_mfma_f32_16x16x32_bf16 v[114:117], v[98:101], v[94:97], v[24:27]
v_mfma_f32_16x16x32_bf16 v[118:121], v[102:105], v[94:97], v[28:31]
s_nop 7
v_max3_f32 v140, v70, v71, v72
v_max3_f32 v141, v73, v74, v75
v_max3_f32 v140, v76, v77, v140
v_max_f32 v140, v140, v141
v_max3_f32 v144, v114, v115, v116
s_barrier
v_max3_f32 v145, v117, v118, v119
v_max3_f32 v144, v120, v121, v144
v_max_f32 v144, v144, v145
v_mov_b32 v141, v140
v_mov_b32 v145, v144
s_nop 1
v_permlane32_swap_b32 v140, v141
v_permlane32_swap_b32 v144, v145
s_nop 0
v_max_f32 v140, v140, v141
v_max_f32 v144, v144, v145
v_mov_b32 v141, v140
v_mov_b32 v145, v144
s_nop 1
v_permlane16_swap_b32 v140, v141
v_permlane16_swap_b32 v144, v145
s_nop 0
v_max_f32 v140, v140, v141
v_max_f32 v144, v144, v145
v_mul_f32 v140, v140, v42
v_mul_f32 v144, v144, v42
v_fma_f32 v70, v70, v42, -v140
v_fma_f32 v71, v71, v42, -v140
v_fma_f32 v72, v72, v42, -v140
v_fma_f32 v73, v73, v42, -v140
v_fma_f32 v74, v74, v42, -v140
v_fma_f32 v75, v75, v42, -v140
v_fma_f32 v76, v76, v42, -v140
v_fma_f32 v77, v77, v42, -v140
v_fma_f32 v114, v114, v42, -v144
v_fma_f32 v115, v115, v42, -v144
v_fma_f32 v116, v116, v42, -v144
v_fma_f32 v117, v117, v42, -v144
v_fma_f32 v118, v118, v42, -v144
v_fma_f32 v119, v119, v42, -v144
v_fma_f32 v120, v120, v42, -v144
v_fma_f32 v121, v121, v42, -v144
v_exp_f32 v70, v70
v_exp_f32 v71, v71
v_exp_f32 v72, v72
v_exp_f32 v73, v73
v_exp_f32 v74, v74
v_exp_f32 v75, v75
v_exp_f32 v76, v76
v_exp_f32 v77, v77
v_exp_f32 v114, v114
v_exp_f32 v115, v115
v_exp_f32 v116, v116
v_exp_f32 v117, v117
v_exp_f32 v118, v118
v_exp_f32 v119, v119
v_exp_f32 v120, v120
v_exp_f32 v121, v121
v_cvt_pk_bf16_f32 v78, v70, v71
v_cvt_pk_bf16_f32 v79, v72, v73
v_cvt_pk_bf16_f32 v80, v74, v75
v_cvt_pk_bf16_f32 v81, v76, v77
v_cvt_pk_bf16_f32 v122, v114, v115
v_cvt_pk_bf16_f32 v123, v116, v117
v_cvt_pk_bf16_f32 v124, v118, v119
v_cvt_pk_bf16_f32 v125, v120, v121
s_waitcnt lgkmcnt(0)
s_nop 1
v_mfma_f32_16x16x32_bf16 v[90:93], v[36:39], v[78:81], 0
v_mfma_f32_16x16x32_bf16 v[82:85], v[62:65], v[78:81], 0
v_mfma_f32_16x16x32_bf16 v[86:89], v[66:69], v[78:81], 0
v_mfma_f32_16x16x32_bf16 v[134:137], v[36:39], v[122:125], 0
v_mfma_f32_16x16x32_bf16 v[126:129], v[106:109], v[122:125], 0
v_mfma_f32_16x16x32_bf16 v[130:133], v[110:113], v[122:125], 0
s_nop 7
v_rcp_f32 v90, v90
v_rcp_f32 v134, v134
s_nop 0
v_mul_f32 v82, v82, v90
v_mul_f32 v83, v83, v90
v_mul_f32 v84, v84, v90
v_mul_f32 v85, v85, v90
v_mul_f32 v86, v86, v90
v_mul_f32 v87, v87, v90
v_mul_f32 v88, v88, v90
v_mul_f32 v89, v89, v90
v_cvt_pk_bf16_f32 v78, v82, v83
v_cvt_pk_bf16_f32 v79, v84, v85
v_cvt_pk_bf16_f32 v80, v86, v87
v_cvt_pk_bf16_f32 v81, v88, v89
ds_write_b64 v20, v[78:79] offset:3840
s_mov_b64 exec, 0xffff
ds_write_b64 v22, v[80:81] offset:3840
s_mov_b64 exec, -1
v_mul_f32 v126, v126, v134
v_mul_f32 v127, v127, v134
v_mul_f32 v128, v128, v134
v_mul_f32 v129, v129, v134
v_mul_f32 v130, v130, v134
v_mul_f32 v131, v131, v134
v_mul_f32 v132, v132, v134
v_mul_f32 v133, v133, v134
v_cvt_pk_bf16_f32 v122, v126, v127
v_cvt_pk_bf16_f32 v123, v128, v129
v_cvt_pk_bf16_f32 v124, v130, v131
v_cvt_pk_bf16_f32 v125, v132, v133
ds_write_b64 v21, v[122:123] offset:4352
s_mov_b64 exec, 0xffff
ds_write_b64 v23, v[124:125] offset:4352
s_mov_b64 exec, -1
s_barrier
s_mul_i32 s20, s35, 5120
s_add_u32 s20, s20, 81920
v_add_u32 v140, s20, v10
s_lshl_b32 s40, s36, 2
s_lshl_b32 s20, s35, 1
s_add_u32 s40, s40, s20
s_mul_i32 s40, s40, 20480
s_mul_i32 s20, s37, 2560
s_add_u32 s40, s40, s20
s_add_u32 s40, s40, 20971520
s_waitcnt lgkmcnt(0)
ds_read_b128 v[50:53], v140 offset:0
ds_read_b128 v[54:57], v140 offset:1024
ds_read_b128 v[58:61], v140 offset:2048
ds_read_b128 v[62:65], v140 offset:3072
ds_read_b128 v[66:69], v140 offset:4096
s_add_u32 s20, s40, 0
s_waitcnt lgkmcnt(4)
buffer_store_dwordx4 v[50:53], v10, s[8:11], s20 offen sc1
s_add_u32 s20, s40, 1024
s_waitcnt lgkmcnt(3)
buffer_store_dwordx4 v[54:57], v10, s[8:11], s20 offen sc1
s_add_u32 s20, s40, 0
s_waitcnt lgkmcnt(2)
buffer_store_dwordx4 v[58:61], v12, s[8:11], s20 offen sc1
s_add_u32 s20, s40, 20992
s_waitcnt lgkmcnt(1)
buffer_store_dwordx4 v[62:65], v10, s[8:11], s20 offen sc1
s_add_u32 s20, s40, 22016
s_waitcnt lgkmcnt(0)
buffer_store_dwordx4 v[66:69], v10, s[8:11], s20 offen sc1
s_barrier
s_waitcnt vmcnt(0)
s_barrier
s_lshl_b32 s20, s36, 7
s_lshl_b32 s21, s37, 2
s_add_u32 s20, s20, s21
s_add_u32 s20, s20, 31481856
s_cmp_eq_u32 s35, 0
s_cselect_b32 s20, s20, 0x40000000
v_mov_b32 v80, 0x40000000
v_mov_b32 v81, s20
v_cmp_eq_u32 vcc, 0, v250
v_mov_b32 v82, s34
s_nop 0
v_cndmask_b32 v80, v80, v81, vcc
buffer_store_dword v82, v80, s[8:11], 0 offen sc1
s_barrier
s_lshl_b32 s20, s36, 7
s_add_u32 s20, s20, 31481856
v_and_b32 v140, 7, v250
v_lshl_add_u32 v160, v140, 2, s20
buffer_load_dword v161, v160, s[8:11], 0 offen sc1
s_waitcnt vmcnt(0)
s_mov_b32 s30, 0
Lfo_94:
v_cmp_ne_u32 vcc, s34, v161
s_nop 3
s_cmp_eq_u64 vcc, 0
s_cbranch_scc1 Lfook_95
s_add_u32 s30, s30, 1
s_cmp_gt_u32 s30, 4000
s_cbranch_scc1 Lfook_95
buffer_load_dword v161, v160, s[8:11], 0 offen sc1
s_waitcnt vmcnt(0)
s_branch Lfo_94
Lfook_95:
s_barrier
s_barrier
s_barrier
s_barrier
s_barrier
s_lshl_b32 s20, s36, 7
s_add_u32 s20, s20, 31477760
v_and_b32 v140, 31, v250
v_lshl_add_u32 v160, v140, 2, s20
buffer_load_dword v161, v160, s[8:11], 0 offen sc1
s_waitcnt vmcnt(0)
s_mov_b32 s30, 0
Lfh_96:
v_cmp_ne_u32 vcc, s34, v161
s_nop 3
s_cmp_eq_u64 vcc, 0
s_cbranch_scc1 Lfhok_97
s_add_u32 s30, s30, 1
s_cmp_gt_u32 s30, 4000
s_cbranch_scc1 Lfhok_97
buffer_load_dword v161, v160, s[8:11], 0 offen sc1
s_waitcnt vmcnt(0)
s_branch Lfh_96
Lfhok_97:
s_barrier
s_barrier
s_barrier
s_barrier
s_barrier
s_barrier
s_barrier
L_end:
s_endpgm
.section .rodata,"a"
.p2align 6
.amdhsa_kernel recurrent_scan__sliding_local_dilated__mixer_gmlp__prompt_kernel
  .amdhsa_next_free_vgpr 256
  .amdhsa_next_free_sgpr 102
  .amdhsa_accum_offset 256
  .amdhsa_group_segment_fixed_size 0
  .amdhsa_kernarg_size 88
  .amdhsa_user_sgpr_count 2
  .amdhsa_user_sgpr_kernarg_segment_ptr 1
  .amdhsa_system_sgpr_workgroup_id_x 1
.end_amdhsa_kernel
```
